```python
import torch

def _softmax(x, axis=-1):
    return torch.softmax(x, dim=axis)
def _gelu(x):
    return torch.nn.functional.gelu(x, approximate="tanh")
def _silu(x):
    return torch.nn.functional.silu(x)
def _sigmoid(x):
    return torch.sigmoid(x)
def _layernorm(x, axis=-1, eps=1e-5):
    m = x.mean(dim=axis, keepdim=True)
    v = x.var(dim=axis, keepdim=True, unbiased=False)
    return (x - m) / torch.sqrt(v + eps)
def _scatter_add(tgt, idx, src, axis=0):
    return tgt.clone().index_add_(axis, idx, src)
def _segment_sum(src, seg, n):
    out = torch.zeros((n,) + src.shape[1:], dtype=src.dtype)
    return out.index_add_(0, seg, src)
def _pad(x, pw):
    flat = tuple(v for pair in reversed(pw) for v in pair)
    return torch.nn.functional.pad(x, flat)

kernel_name = 'recurrent_scan__sliding_block_cached__geglu_ffn__prompt'

def setup_inputs():

    _w = (lambda a: (lambda t: t.to(torch.bfloat16) if t.is_floating_point() else t)(torch.as_tensor(a)))
    def _A_setup():
        B, Sq, D = 1, 2048, 512
        Hq, Hkv, Sk, Dh = 32, 32, 2048, 128
        assert Hq % Hkv == 0, (Hq, Hkv)
        return {
            "x": _w((lambda *s: torch.randn(*s, dtype=torch.bfloat16) * 0.05)(B, Sq, D)),
            "k_cache": _w((lambda *s: torch.randn(*s, dtype=torch.bfloat16) * 0.8)(B, Hkv, Sk, Dh)),
            "v_cache": _w((lambda *s: torch.randn(*s, dtype=torch.bfloat16) * 0.2)(B, Hkv, Sk, Dh)),
            "wq": _w((lambda *s: torch.randn(*s, dtype=torch.bfloat16) * 0.8)(D, Hq * Dh) * (D ** -0.5)),
            "wo": _w((lambda *s: torch.randn(*s, dtype=torch.bfloat16) * 0.2)(Hq * Dh, D) * ((Hq * Dh) ** -0.5)),
        }
    _A_in = _A_setup()

    def _B_setup():
        B, S, D, F = 1, 2048, 512, 1376
        return {
            "x": _w((lambda *s: torch.randn(*s, dtype=torch.bfloat16) * 0.05)(B, S, D)),
            "w_gate": _w((lambda *s: torch.randn(*s, dtype=torch.bfloat16) * 0.1)(D, F)),
            "w_up": _w((lambda *s: torch.randn(*s, dtype=torch.bfloat16) * 0.1)(D, F)),
            "w_down": _w((lambda *s: torch.randn(*s, dtype=torch.bfloat16) * 0.1)(F, D)),
        }
    _B_in = _B_setup()

    return {
        "A_x": _A_in["x"],
        "A_k_cache": _A_in["k_cache"],
        "A_v_cache": _A_in["v_cache"],
        "A_wq": _A_in["wq"],
        "A_wo": _A_in["wo"],
        "B_x": _B_in["x"],
        "B_w_gate": _B_in["w_gate"],
        "B_w_up": _B_in["w_up"],
        "B_w_down": _B_in["w_down"],
    }

def reference(A_x, A_k_cache, A_v_cache, A_wq, A_wo, B_x, B_w_gate, B_w_up, B_w_down):
    def _A_ref(x, k_cache, v_cache, wq, wo):
        B, Sq, D = x.shape
        Hq, Dh = 32, 128
        Hkv, Sk = k_cache.shape[1], k_cache.shape[2]
        W = min(4096, max(256, Sk // 4))
        rep = Hq // Hkv
        q = (lambda x, *d: x.permute(*d))((x @ wq).reshape(B, Sq, Hq, Dh), 0, 2, 1, 3)
        k = (lambda x, n, axis: torch.repeat_interleave(x, n, dim=axis))(k_cache[:, :, Sk - W:, :], rep, axis=1)
        v = (lambda x, n, axis: torch.repeat_interleave(x, n, dim=axis))(v_cache[:, :, Sk - W:, :], rep, axis=1)
        scores = torch.einsum("bhqd,bhkd->bhqk", q, k) * (Dh ** -0.5)
        p = _softmax(scores, axis=-1)
        o = torch.einsum("bhqk,bhkd->bhqd", p, v)
        return (lambda x, *d: x.permute(*d))(o, 0, 2, 1, 3).reshape(B, Sq, Hq * Dh) @ wo

    def _B_ref(x, w_gate, w_up, w_down):
        return (_gelu(x @ w_gate) * (x @ w_up)) @ w_down

    x = A_x
    xn = _layernorm(x, axis=-1)
    s = _A_ref(xn, A_k_cache, A_v_cache, A_wq, A_wo)
    g = _silu(_B_ref(xn, B_w_gate, B_w_up, B_w_down))
    return x + s * g
```

```asm
; @launch kernel=attn_kernel grid=(256,1,1) block=(512,1,1) lds=163840
; @launch kernel=final_kernel grid=(256,1,1) block=(512,1,1) lds=133120
.amdgcn_target "amdgcn-amd-amdhsa--gfx950"
.text
.globl attn_kernel
.p2align 8
.type attn_kernel,@function
attn_kernel:
    s_cmp_ge_u32 s2, 256
    s_cbranch_scc1 L_attn_end
    s_load_dwordx16 s[16:31], s[0:1], 0
    s_load_dwordx8 s[32:39], s[0:1], 64
    v_and_b32 v240, 63, v0
    v_lshrrev_b32 v252, 6, v0
    s_nop 0
    v_readfirstlane_b32 s4, v252
    s_and_b32 s8, s2, 7
    s_lshr_b32 s9, s2, 3
    s_lshl_b32 s5, s8, 2
    s_and_b32 s8, s9, 3
    s_add_u32 s5, s5, s8
    s_lshr_b32 s6, s9, 2
    s_mul_i32 s8, s5, 3
    s_lshl_b32 s9, s5, 1
    s_add_u32 s9, s9, 22
    s_min_u32 s7, s8, s9
    s_mov_b32 s12, 1065369472
    s_mov_b32 s13, 0x3e0293ee
    s_lshl_b32 s10, s4, 10
    v_lshlrev_b32 v241, 4, v240
    v_lshrrev_b32 v252, 5, v240
    v_and_b32 v253, 31, v240
    v_xor_b32 v253, v253, v252
    v_lshlrev_b32 v253, 4, v253
    v_lshl_add_u32 v224, v252, 10, v253
    v_xor_b32 v225, 32, v224
    v_xor_b32 v226, 64, v224
    v_xor_b32 v227, 96, v224
    v_xor_b32 v228, 128, v224
    v_xor_b32 v229, 160, v224
    v_xor_b32 v230, 192, v224
    v_xor_b32 v231, 224, v224
    s_lshl_b32 s8, s6, 8
    s_lshl_b32 s9, s4, 5
    s_add_u32 s8, s8, s9
    s_lshl_b32 s85, s8, 10
    s_lshl_b32 s83, s4, 14
    s_add_u32 s83, s83, 32768
    s_waitcnt lgkmcnt(0)
    s_mov_b32 s40, s16
    s_and_b32 s41, s17, 65535
    s_mov_b32 s42, 2097152
    s_mov_b32 s43, 131072
    s_add_u32 s8, s85, 0
    s_add_u32 m0, s83, 0
    s_nop 0
    buffer_load_dwordx4 v224, s[40:43], s8 offen lds
    s_add_u32 s8, s85, 2048
    s_add_u32 m0, s83, 1024
    s_nop 0
    buffer_load_dwordx4 v225, s[40:43], s8 offen lds
    s_add_u32 s8, s85, 4096
    s_add_u32 m0, s83, 2048
    s_nop 0
    buffer_load_dwordx4 v226, s[40:43], s8 offen lds
    s_add_u32 s8, s85, 6144
    s_add_u32 m0, s83, 3072
    s_nop 0
    buffer_load_dwordx4 v227, s[40:43], s8 offen lds
    s_add_u32 s8, s85, 8192
    s_add_u32 m0, s83, 4096
    s_nop 0
    buffer_load_dwordx4 v228, s[40:43], s8 offen lds
    s_add_u32 s8, s85, 10240
    s_add_u32 m0, s83, 5120
    s_nop 0
    buffer_load_dwordx4 v229, s[40:43], s8 offen lds
    s_add_u32 s8, s85, 12288
    s_add_u32 m0, s83, 6144
    s_nop 0
    buffer_load_dwordx4 v230, s[40:43], s8 offen lds
    s_add_u32 s8, s85, 14336
    s_add_u32 m0, s83, 7168
    s_nop 0
    buffer_load_dwordx4 v231, s[40:43], s8 offen lds
    s_add_u32 s8, s85, 16384
    s_add_u32 m0, s83, 8192
    s_nop 0
    buffer_load_dwordx4 v224, s[40:43], s8 offen lds
    s_add_u32 s8, s85, 18432
    s_add_u32 m0, s83, 9216
    s_nop 0
    buffer_load_dwordx4 v225, s[40:43], s8 offen lds
    s_add_u32 s8, s85, 20480
    s_add_u32 m0, s83, 10240
    s_nop 0
    buffer_load_dwordx4 v226, s[40:43], s8 offen lds
    s_add_u32 s8, s85, 22528
    s_add_u32 m0, s83, 11264
    s_nop 0
    buffer_load_dwordx4 v227, s[40:43], s8 offen lds
    s_add_u32 s8, s85, 24576
    s_add_u32 m0, s83, 12288
    s_nop 0
    buffer_load_dwordx4 v228, s[40:43], s8 offen lds
    s_add_u32 s8, s85, 26624
    s_add_u32 m0, s83, 13312
    s_nop 0
    buffer_load_dwordx4 v229, s[40:43], s8 offen lds
    s_add_u32 s8, s85, 28672
    s_add_u32 m0, s83, 14336
    s_nop 0
    buffer_load_dwordx4 v230, s[40:43], s8 offen lds
    s_add_u32 s8, s85, 30720
    s_add_u32 m0, s83, 15360
    s_nop 0
    buffer_load_dwordx4 v231, s[40:43], s8 offen lds
    s_and_b32 s15, s4, 3
    s_lshl_b32 s8, s15, 5
    v_lshrrev_b32 v252, 2, v240
    v_add_u32 v252, s8, v252
    v_and_b32 v253, 3, v240
    v_lshlrev_b32 v254, 4, v253
    v_lshl_add_u32 v242, v252, 13, v254
    s_lshl_b32 s8, s15, 4
    v_lshrrev_b32 v252, 2, v240
    v_add_u32 v252, s8, v252
    v_lshl_add_u32 v251, v252, 8, v254
    v_bfe_u32 v254, v240, 4, 2
    v_xor_b32 v254, v254, v253
    v_lshlrev_b32 v254, 4, v254
    v_lshl_add_u32 v244, v252, 8, v254
    s_lshl_b32 s9, s15, 5
    v_lshrrev_b32 v252, 1, v240
    v_add_u32 v252, s9, v252
    s_mov_b32 s8, 2752
    v_mul_lo_u32 v252, v252, s8
    v_and_b32 v253, 1, v240
    v_lshl_add_u32 v243, v253, 4, v252
    s_lshl_b32 s11, s15, 10
    s_lshl_b32 s10, s15, 11
    s_mul_i32 s8, s5, 524288
    s_add_u32 s8, s8, 393216
    s_add_u32 s80, s18, s8
    s_addc_u32 s81, s19, 0
    s_mov_b32 s44, s80
    s_and_b32 s45, s81, 65535
    s_mov_b32 s46, 131072
    s_mov_b32 s47, 131072
    s_add_u32 s80, s20, s8
    s_addc_u32 s81, s21, 0
    s_mov_b32 s68, s80
    s_and_b32 s69, s81, 65535
    s_mov_b32 s70, 131072
    s_mov_b32 s71, 131072
    s_lshl_b32 s8, s5, 8
    s_add_u32 s80, s22, s8
    s_addc_u32 s81, s23, 0
    s_sub_u32 s82, 4194304, s8
    s_mov_b32 s48, s80
    s_and_b32 s49, s81, 65535
    s_mov_b32 s50, s82
    s_mov_b32 s51, 131072
    s_mov_b32 s52, s24
    s_and_b32 s53, s25, 65535
    s_mov_b32 s54, 4194304
    s_mov_b32 s55, 131072
    s_mov_b32 s56, s32
    s_and_b32 s57, s33, 65535
    s_mov_b32 s58, 1409024
    s_mov_b32 s59, 131072
    s_mov_b32 s60, s38
    s_and_b32 s61, s39, 65535
    s_mov_b32 s62, 268435456
    s_mov_b32 s63, 131072
    s_mov_b32 s64, s28
    s_and_b32 s65, s29, 65535
    s_mov_b32 s66, 1409024
    s_mov_b32 s67, 131072
    s_mov_b32 s72, s30
    s_and_b32 s73, s31, 65535
    s_mov_b32 s74, 1409024
    s_mov_b32 s75, 131072
    s_mul_i32 s8, s6, 2818048
    s_mul_i32 s9, s4, 352256
    s_add_u32 s84, s8, s9
    s_cmp_ge_u32 s4, 4
    s_cbranch_scc1 L_nd1
    s_mov_b32 s91, 0
    s_add_u32 m0, s10, 0
    s_nop 0
    buffer_load_dwordx4 v242, s[48:51], s91 offen lds
    s_mov_b32 s91, 0
    s_add_u32 m0, s10, 8128
    s_nop 0
    buffer_load_dwordx4 v242, s[48:51], s91 offen offset:64 lds
L_nd1:
    s_cmp_ge_u32 s4, 4
    s_cbranch_scc1 L_nd2
    s_mov_b32 s91, 0
    s_add_u32 m0, s10, 16256
    s_nop 0
    buffer_load_dwordx4 v242, s[48:51], s91 offen offset:128 lds
    s_mov_b32 s91, 0
    s_add_u32 m0, s10, 24384
    s_nop 0
    buffer_load_dwordx4 v242, s[48:51], s91 offen offset:192 lds
L_nd2:
    s_cmp_ge_u32 s4, 4
    s_cbranch_scc1 L_nd3
    s_mov_b32 s91, 131072
    s_add_u32 m0, s10, 1024
    s_nop 0
    buffer_load_dwordx4 v242, s[48:51], s91 offen lds
    s_mov_b32 s91, 131072
    s_add_u32 m0, s10, 9152
    s_nop 0
    buffer_load_dwordx4 v242, s[48:51], s91 offen offset:64 lds
L_nd3:
    s_cmp_ge_u32 s4, 4
    s_cbranch_scc1 L_nd4
    s_mov_b32 s91, 131072
    s_add_u32 m0, s10, 17280
    s_nop 0
    buffer_load_dwordx4 v242, s[48:51], s91 offen offset:128 lds
    s_mov_b32 s91, 131072
    s_add_u32 m0, s10, 25408
    s_nop 0
    buffer_load_dwordx4 v242, s[48:51], s91 offen offset:192 lds
L_nd4:
    v_and_b32 v252, 31, v240
    v_lshrrev_b32 v253, 5, v240
    v_and_b32 v254, 15, v240
    v_xor_b32 v253, v253, v254
    v_lshlrev_b32 v253, 4, v253
    v_lshl_add_u32 v247, v252, 9, v253
    v_add_u32 v247, s83, v247
    s_waitcnt vmcnt(0)
    ds_read_b128 v[0:3], v247
    v_xor_b32 v233, 32, v247
    ds_read_b128 v[4:7], v233
    v_xor_b32 v234, 64, v247
    ds_read_b128 v[8:11], v234
    v_xor_b32 v235, 96, v247
    ds_read_b128 v[12:15], v235
    v_xor_b32 v232, 128, v247
    ds_read_b128 v[16:19], v232
    v_xor_b32 v233, 160, v247
    ds_read_b128 v[20:23], v233
    v_xor_b32 v234, 192, v247
    ds_read_b128 v[24:27], v234
    v_xor_b32 v235, 224, v247
    ds_read_b128 v[28:31], v235
    v_xor_b32 v232, 256, v247
    ds_read_b128 v[32:35], v232
    v_xor_b32 v233, 288, v247
    ds_read_b128 v[36:39], v233
    v_xor_b32 v234, 320, v247
    ds_read_b128 v[40:43], v234
    v_xor_b32 v235, 352, v247
    ds_read_b128 v[44:47], v235
    v_xor_b32 v232, 384, v247
    ds_read_b128 v[48:51], v232
    v_xor_b32 v233, 416, v247
    ds_read_b128 v[52:55], v233
    v_xor_b32 v234, 448, v247
    ds_read_b128 v[56:59], v234
    v_xor_b32 v235, 480, v247
    s_waitcnt lgkmcnt(14)
    ds_read_b128 v[60:63], v235
    s_waitcnt lgkmcnt(0)
    s_add_u32 s8, s85, 0
    s_add_u32 m0, s83, -512
    s_nop 0
    buffer_load_dwordx4 v224, s[40:43], s8 offen offset:512 lds
    s_add_u32 s8, s85, 2048
    s_add_u32 m0, s83, 512
    s_nop 0
    buffer_load_dwordx4 v225, s[40:43], s8 offen offset:512 lds
    s_add_u32 s8, s85, 4096
    s_add_u32 m0, s83, 1536
    s_nop 0
    buffer_load_dwordx4 v226, s[40:43], s8 offen offset:512 lds
    s_add_u32 s8, s85, 6144
    s_add_u32 m0, s83, 2560
    s_nop 0
    buffer_load_dwordx4 v227, s[40:43], s8 offen offset:512 lds
    s_add_u32 s8, s85, 8192
    s_add_u32 m0, s83, 3584
    s_nop 0
    buffer_load_dwordx4 v228, s[40:43], s8 offen offset:512 lds
    s_add_u32 s8, s85, 10240
    s_add_u32 m0, s83, 4608
    s_nop 0
    buffer_load_dwordx4 v229, s[40:43], s8 offen offset:512 lds
    s_add_u32 s8, s85, 12288
    s_add_u32 m0, s83, 5632
    s_nop 0
    buffer_load_dwordx4 v230, s[40:43], s8 offen offset:512 lds
    s_add_u32 s8, s85, 14336
    s_add_u32 m0, s83, 6656
    s_nop 0
    buffer_load_dwordx4 v231, s[40:43], s8 offen offset:512 lds
    s_add_u32 s8, s85, 16384
    s_add_u32 m0, s83, 7680
    s_nop 0
    buffer_load_dwordx4 v224, s[40:43], s8 offen offset:512 lds
    s_add_u32 s8, s85, 18432
    s_add_u32 m0, s83, 8704
    s_nop 0
    buffer_load_dwordx4 v225, s[40:43], s8 offen offset:512 lds
    s_add_u32 s8, s85, 20480
    s_add_u32 m0, s83, 9728
    s_nop 0
    buffer_load_dwordx4 v226, s[40:43], s8 offen offset:512 lds
    s_add_u32 s8, s85, 22528
    s_add_u32 m0, s83, 10752
    s_nop 0
    buffer_load_dwordx4 v227, s[40:43], s8 offen offset:512 lds
    s_add_u32 s8, s85, 24576
    s_add_u32 m0, s83, 11776
    s_nop 0
    buffer_load_dwordx4 v228, s[40:43], s8 offen offset:512 lds
    s_add_u32 s8, s85, 26624
    s_add_u32 m0, s83, 12800
    s_nop 0
    buffer_load_dwordx4 v229, s[40:43], s8 offen offset:512 lds
    s_add_u32 s8, s85, 28672
    s_add_u32 m0, s83, 13824
    s_nop 0
    buffer_load_dwordx4 v230, s[40:43], s8 offen offset:512 lds
    s_add_u32 s8, s85, 30720
    s_add_u32 m0, s83, 14848
    s_nop 0
    buffer_load_dwordx4 v231, s[40:43], s8 offen offset:512 lds
    v_mov_b32 v192, 0
    v_mov_b32 v193, 0
    v_mov_b32 v194, 0
    v_mov_b32 v195, 0
    v_mov_b32 v196, 0
    v_mov_b32 v197, 0
    v_mov_b32 v198, 0
    v_mov_b32 v199, 0
    v_dot2_f32_bf16 v192, v0, s12, v192
    v_dot2_f32_bf16 v196, v0, v0, v196
    v_dot2_f32_bf16 v193, v1, s12, v193
    v_dot2_f32_bf16 v197, v1, v1, v197
    v_dot2_f32_bf16 v194, v2, s12, v194
    v_dot2_f32_bf16 v198, v2, v2, v198
    v_dot2_f32_bf16 v195, v3, s12, v195
    v_dot2_f32_bf16 v199, v3, v3, v199
    v_dot2_f32_bf16 v192, v4, s12, v192
    v_dot2_f32_bf16 v196, v4, v4, v196
    v_dot2_f32_bf16 v193, v5, s12, v193
    v_dot2_f32_bf16 v197, v5, v5, v197
    v_dot2_f32_bf16 v194, v6, s12, v194
    v_dot2_f32_bf16 v198, v6, v6, v198
    v_dot2_f32_bf16 v195, v7, s12, v195
    v_dot2_f32_bf16 v199, v7, v7, v199
    v_dot2_f32_bf16 v192, v8, s12, v192
    v_dot2_f32_bf16 v196, v8, v8, v196
    v_dot2_f32_bf16 v193, v9, s12, v193
    v_dot2_f32_bf16 v197, v9, v9, v197
    v_dot2_f32_bf16 v194, v10, s12, v194
    v_dot2_f32_bf16 v198, v10, v10, v198
    v_dot2_f32_bf16 v195, v11, s12, v195
    v_dot2_f32_bf16 v199, v11, v11, v199
    v_dot2_f32_bf16 v192, v12, s12, v192
    v_dot2_f32_bf16 v196, v12, v12, v196
    v_dot2_f32_bf16 v193, v13, s12, v193
    v_dot2_f32_bf16 v197, v13, v13, v197
    v_dot2_f32_bf16 v194, v14, s12, v194
    v_dot2_f32_bf16 v198, v14, v14, v198
    v_dot2_f32_bf16 v195, v15, s12, v195
    v_dot2_f32_bf16 v199, v15, v15, v199
    v_dot2_f32_bf16 v192, v16, s12, v192
    v_dot2_f32_bf16 v196, v16, v16, v196
    v_dot2_f32_bf16 v193, v17, s12, v193
    v_dot2_f32_bf16 v197, v17, v17, v197
    v_dot2_f32_bf16 v194, v18, s12, v194
    v_dot2_f32_bf16 v198, v18, v18, v198
    v_dot2_f32_bf16 v195, v19, s12, v195
    v_dot2_f32_bf16 v199, v19, v19, v199
    v_dot2_f32_bf16 v192, v20, s12, v192
    v_dot2_f32_bf16 v196, v20, v20, v196
    v_dot2_f32_bf16 v193, v21, s12, v193
    v_dot2_f32_bf16 v197, v21, v21, v197
    v_dot2_f32_bf16 v194, v22, s12, v194
    v_dot2_f32_bf16 v198, v22, v22, v198
    v_dot2_f32_bf16 v195, v23, s12, v195
    v_dot2_f32_bf16 v199, v23, v23, v199
    v_dot2_f32_bf16 v192, v24, s12, v192
    v_dot2_f32_bf16 v196, v24, v24, v196
    v_dot2_f32_bf16 v193, v25, s12, v193
    v_dot2_f32_bf16 v197, v25, v25, v197
    v_dot2_f32_bf16 v194, v26, s12, v194
    v_dot2_f32_bf16 v198, v26, v26, v198
    v_dot2_f32_bf16 v195, v27, s12, v195
    v_dot2_f32_bf16 v199, v27, v27, v199
    v_dot2_f32_bf16 v192, v28, s12, v192
    v_dot2_f32_bf16 v196, v28, v28, v196
    v_dot2_f32_bf16 v193, v29, s12, v193
    v_dot2_f32_bf16 v197, v29, v29, v197
    v_dot2_f32_bf16 v194, v30, s12, v194
    v_dot2_f32_bf16 v198, v30, v30, v198
    v_dot2_f32_bf16 v195, v31, s12, v195
    v_dot2_f32_bf16 v199, v31, v31, v199
    v_dot2_f32_bf16 v192, v32, s12, v192
    v_dot2_f32_bf16 v196, v32, v32, v196
    v_dot2_f32_bf16 v193, v33, s12, v193
    v_dot2_f32_bf16 v197, v33, v33, v197
    v_dot2_f32_bf16 v194, v34, s12, v194
    v_dot2_f32_bf16 v198, v34, v34, v198
    v_dot2_f32_bf16 v195, v35, s12, v195
    v_dot2_f32_bf16 v199, v35, v35, v199
    v_dot2_f32_bf16 v192, v36, s12, v192
    v_dot2_f32_bf16 v196, v36, v36, v196
    v_dot2_f32_bf16 v193, v37, s12, v193
    v_dot2_f32_bf16 v197, v37, v37, v197
    v_dot2_f32_bf16 v194, v38, s12, v194
    v_dot2_f32_bf16 v198, v38, v38, v198
    v_dot2_f32_bf16 v195, v39, s12, v195
    v_dot2_f32_bf16 v199, v39, v39, v199
    v_dot2_f32_bf16 v192, v40, s12, v192
    v_dot2_f32_bf16 v196, v40, v40, v196
    v_dot2_f32_bf16 v193, v41, s12, v193
    v_dot2_f32_bf16 v197, v41, v41, v197
    v_dot2_f32_bf16 v194, v42, s12, v194
    v_dot2_f32_bf16 v198, v42, v42, v198
    v_dot2_f32_bf16 v195, v43, s12, v195
    v_dot2_f32_bf16 v199, v43, v43, v199
    v_dot2_f32_bf16 v192, v44, s12, v192
    v_dot2_f32_bf16 v196, v44, v44, v196
    v_dot2_f32_bf16 v193, v45, s12, v193
    v_dot2_f32_bf16 v197, v45, v45, v197
    v_dot2_f32_bf16 v194, v46, s12, v194
    v_dot2_f32_bf16 v198, v46, v46, v198
    v_dot2_f32_bf16 v195, v47, s12, v195
    v_dot2_f32_bf16 v199, v47, v47, v199
    v_dot2_f32_bf16 v192, v48, s12, v192
    v_dot2_f32_bf16 v196, v48, v48, v196
    v_dot2_f32_bf16 v193, v49, s12, v193
    v_dot2_f32_bf16 v197, v49, v49, v197
    v_dot2_f32_bf16 v194, v50, s12, v194
    v_dot2_f32_bf16 v198, v50, v50, v198
    v_dot2_f32_bf16 v195, v51, s12, v195
    v_dot2_f32_bf16 v199, v51, v51, v199
    v_dot2_f32_bf16 v192, v52, s12, v192
    v_dot2_f32_bf16 v196, v52, v52, v196
    v_dot2_f32_bf16 v193, v53, s12, v193
    v_dot2_f32_bf16 v197, v53, v53, v197
    v_dot2_f32_bf16 v194, v54, s12, v194
    v_dot2_f32_bf16 v198, v54, v54, v198
    v_dot2_f32_bf16 v195, v55, s12, v195
    v_dot2_f32_bf16 v199, v55, v55, v199
    v_dot2_f32_bf16 v192, v56, s12, v192
    v_dot2_f32_bf16 v196, v56, v56, v196
    v_dot2_f32_bf16 v193, v57, s12, v193
    v_dot2_f32_bf16 v197, v57, v57, v197
    v_dot2_f32_bf16 v194, v58, s12, v194
    v_dot2_f32_bf16 v198, v58, v58, v198
    v_dot2_f32_bf16 v195, v59, s12, v195
    v_dot2_f32_bf16 v199, v59, v59, v199
    v_dot2_f32_bf16 v192, v60, s12, v192
    v_dot2_f32_bf16 v196, v60, v60, v196
    v_dot2_f32_bf16 v193, v61, s12, v193
    v_dot2_f32_bf16 v197, v61, v61, v197
    v_dot2_f32_bf16 v194, v62, s12, v194
    v_dot2_f32_bf16 v198, v62, v62, v198
    v_dot2_f32_bf16 v195, v63, s12, v195
    v_dot2_f32_bf16 v199, v63, v63, v199
    s_waitcnt vmcnt(0)
    ds_read_b128 v[64:67], v247
    v_xor_b32 v233, 32, v247
    ds_read_b128 v[68:71], v233
    v_xor_b32 v234, 64, v247
    ds_read_b128 v[72:75], v234
    v_xor_b32 v235, 96, v247
    ds_read_b128 v[76:79], v235
    v_xor_b32 v232, 128, v247
    ds_read_b128 v[80:83], v232
    v_xor_b32 v233, 160, v247
    ds_read_b128 v[84:87], v233
    v_xor_b32 v234, 192, v247
    ds_read_b128 v[88:91], v234
    v_xor_b32 v235, 224, v247
    ds_read_b128 v[92:95], v235
    v_xor_b32 v232, 256, v247
    ds_read_b128 v[96:99], v232
    v_xor_b32 v233, 288, v247
    ds_read_b128 v[100:103], v233
    v_xor_b32 v234, 320, v247
    ds_read_b128 v[104:107], v234
    v_xor_b32 v235, 352, v247
    ds_read_b128 v[108:111], v235
    v_xor_b32 v232, 384, v247
    ds_read_b128 v[112:115], v232
    v_xor_b32 v233, 416, v247
    ds_read_b128 v[116:119], v233
    v_xor_b32 v234, 448, v247
    ds_read_b128 v[120:123], v234
    v_xor_b32 v235, 480, v247
    s_waitcnt lgkmcnt(14)
    ds_read_b128 v[124:127], v235
    v_dot2_f32_bf16 v192, v64, s12, v192
    v_dot2_f32_bf16 v196, v64, v64, v196
    v_dot2_f32_bf16 v193, v65, s12, v193
    v_dot2_f32_bf16 v197, v65, v65, v197
    v_dot2_f32_bf16 v194, v66, s12, v194
    v_dot2_f32_bf16 v198, v66, v66, v198
    v_dot2_f32_bf16 v195, v67, s12, v195
    v_dot2_f32_bf16 v199, v67, v67, v199
    s_waitcnt lgkmcnt(14)
    v_dot2_f32_bf16 v192, v68, s12, v192
    v_dot2_f32_bf16 v196, v68, v68, v196
    v_dot2_f32_bf16 v193, v69, s12, v193
    v_dot2_f32_bf16 v197, v69, v69, v197
    v_dot2_f32_bf16 v194, v70, s12, v194
    v_dot2_f32_bf16 v198, v70, v70, v198
    v_dot2_f32_bf16 v195, v71, s12, v195
    v_dot2_f32_bf16 v199, v71, v71, v199
    s_waitcnt lgkmcnt(13)
    v_dot2_f32_bf16 v192, v72, s12, v192
    v_dot2_f32_bf16 v196, v72, v72, v196
    v_dot2_f32_bf16 v193, v73, s12, v193
    v_dot2_f32_bf16 v197, v73, v73, v197
    v_dot2_f32_bf16 v194, v74, s12, v194
    v_dot2_f32_bf16 v198, v74, v74, v198
    v_dot2_f32_bf16 v195, v75, s12, v195
    v_dot2_f32_bf16 v199, v75, v75, v199
    s_waitcnt lgkmcnt(12)
    v_dot2_f32_bf16 v192, v76, s12, v192
    v_dot2_f32_bf16 v196, v76, v76, v196
    v_dot2_f32_bf16 v193, v77, s12, v193
    v_dot2_f32_bf16 v197, v77, v77, v197
    v_dot2_f32_bf16 v194, v78, s12, v194
    v_dot2_f32_bf16 v198, v78, v78, v198
    v_dot2_f32_bf16 v195, v79, s12, v195
    v_dot2_f32_bf16 v199, v79, v79, v199
    s_waitcnt lgkmcnt(11)
    v_dot2_f32_bf16 v192, v80, s12, v192
    v_dot2_f32_bf16 v196, v80, v80, v196
    v_dot2_f32_bf16 v193, v81, s12, v193
    v_dot2_f32_bf16 v197, v81, v81, v197
    v_dot2_f32_bf16 v194, v82, s12, v194
    v_dot2_f32_bf16 v198, v82, v82, v198
    v_dot2_f32_bf16 v195, v83, s12, v195
    v_dot2_f32_bf16 v199, v83, v83, v199
    s_waitcnt lgkmcnt(10)
    v_dot2_f32_bf16 v192, v84, s12, v192
    v_dot2_f32_bf16 v196, v84, v84, v196
    v_dot2_f32_bf16 v193, v85, s12, v193
    v_dot2_f32_bf16 v197, v85, v85, v197
    v_dot2_f32_bf16 v194, v86, s12, v194
    v_dot2_f32_bf16 v198, v86, v86, v198
    v_dot2_f32_bf16 v195, v87, s12, v195
    v_dot2_f32_bf16 v199, v87, v87, v199
    s_waitcnt lgkmcnt(9)
    v_dot2_f32_bf16 v192, v88, s12, v192
    v_dot2_f32_bf16 v196, v88, v88, v196
    v_dot2_f32_bf16 v193, v89, s12, v193
    v_dot2_f32_bf16 v197, v89, v89, v197
    v_dot2_f32_bf16 v194, v90, s12, v194
    v_dot2_f32_bf16 v198, v90, v90, v198
    v_dot2_f32_bf16 v195, v91, s12, v195
    v_dot2_f32_bf16 v199, v91, v91, v199
    s_waitcnt lgkmcnt(8)
    v_dot2_f32_bf16 v192, v92, s12, v192
    v_dot2_f32_bf16 v196, v92, v92, v196
    v_dot2_f32_bf16 v193, v93, s12, v193
    v_dot2_f32_bf16 v197, v93, v93, v197
    v_dot2_f32_bf16 v194, v94, s12, v194
    v_dot2_f32_bf16 v198, v94, v94, v198
    v_dot2_f32_bf16 v195, v95, s12, v195
    v_dot2_f32_bf16 v199, v95, v95, v199
    s_waitcnt lgkmcnt(7)
    v_dot2_f32_bf16 v192, v96, s12, v192
    v_dot2_f32_bf16 v196, v96, v96, v196
    v_dot2_f32_bf16 v193, v97, s12, v193
    v_dot2_f32_bf16 v197, v97, v97, v197
    v_dot2_f32_bf16 v194, v98, s12, v194
    v_dot2_f32_bf16 v198, v98, v98, v198
    v_dot2_f32_bf16 v195, v99, s12, v195
    v_dot2_f32_bf16 v199, v99, v99, v199
    s_waitcnt lgkmcnt(6)
    v_dot2_f32_bf16 v192, v100, s12, v192
    v_dot2_f32_bf16 v196, v100, v100, v196
    v_dot2_f32_bf16 v193, v101, s12, v193
    v_dot2_f32_bf16 v197, v101, v101, v197
    v_dot2_f32_bf16 v194, v102, s12, v194
    v_dot2_f32_bf16 v198, v102, v102, v198
    v_dot2_f32_bf16 v195, v103, s12, v195
    v_dot2_f32_bf16 v199, v103, v103, v199
    s_waitcnt lgkmcnt(5)
    v_dot2_f32_bf16 v192, v104, s12, v192
    v_dot2_f32_bf16 v196, v104, v104, v196
    v_dot2_f32_bf16 v193, v105, s12, v193
    v_dot2_f32_bf16 v197, v105, v105, v197
    v_dot2_f32_bf16 v194, v106, s12, v194
    v_dot2_f32_bf16 v198, v106, v106, v198
    v_dot2_f32_bf16 v195, v107, s12, v195
    v_dot2_f32_bf16 v199, v107, v107, v199
    s_waitcnt lgkmcnt(4)
    v_dot2_f32_bf16 v192, v108, s12, v192
    v_dot2_f32_bf16 v196, v108, v108, v196
    v_dot2_f32_bf16 v193, v109, s12, v193
    v_dot2_f32_bf16 v197, v109, v109, v197
    v_dot2_f32_bf16 v194, v110, s12, v194
    v_dot2_f32_bf16 v198, v110, v110, v198
    v_dot2_f32_bf16 v195, v111, s12, v195
    v_dot2_f32_bf16 v199, v111, v111, v199
    s_waitcnt lgkmcnt(3)
    v_dot2_f32_bf16 v192, v112, s12, v192
    v_dot2_f32_bf16 v196, v112, v112, v196
    v_dot2_f32_bf16 v193, v113, s12, v193
    v_dot2_f32_bf16 v197, v113, v113, v197
    v_dot2_f32_bf16 v194, v114, s12, v194
    v_dot2_f32_bf16 v198, v114, v114, v198
    v_dot2_f32_bf16 v195, v115, s12, v195
    v_dot2_f32_bf16 v199, v115, v115, v199
    s_waitcnt lgkmcnt(2)
    v_dot2_f32_bf16 v192, v116, s12, v192
    v_dot2_f32_bf16 v196, v116, v116, v196
    v_dot2_f32_bf16 v193, v117, s12, v193
    v_dot2_f32_bf16 v197, v117, v117, v197
    v_dot2_f32_bf16 v194, v118, s12, v194
    v_dot2_f32_bf16 v198, v118, v118, v198
    v_dot2_f32_bf16 v195, v119, s12, v195
    v_dot2_f32_bf16 v199, v119, v119, v199
    s_waitcnt lgkmcnt(1)
    v_dot2_f32_bf16 v192, v120, s12, v192
    v_dot2_f32_bf16 v196, v120, v120, v196
    v_dot2_f32_bf16 v193, v121, s12, v193
    v_dot2_f32_bf16 v197, v121, v121, v197
    v_dot2_f32_bf16 v194, v122, s12, v194
    v_dot2_f32_bf16 v198, v122, v122, v198
    v_dot2_f32_bf16 v195, v123, s12, v195
    v_dot2_f32_bf16 v199, v123, v123, v199
    s_waitcnt lgkmcnt(0)
    v_dot2_f32_bf16 v192, v124, s12, v192
    v_dot2_f32_bf16 v196, v124, v124, v196
    v_dot2_f32_bf16 v193, v125, s12, v193
    v_dot2_f32_bf16 v197, v125, v125, v197
    v_dot2_f32_bf16 v194, v126, s12, v194
    v_dot2_f32_bf16 v198, v126, v126, v198
    v_dot2_f32_bf16 v195, v127, s12, v195
    v_dot2_f32_bf16 v199, v127, v127, v199
    v_add_f32 v192, v192, v193
    s_nop 0
    v_add_f32 v194, v194, v195
    v_add_f32 v196, v196, v197
    v_add_f32 v198, v198, v199
    v_add_f32 v192, v192, v194
    v_add_f32 v196, v196, v198
    v_mov_b32 v193, v192
    v_mov_b32 v197, v196
    s_nop 0
    v_permlane32_swap_b32 v192, v193
    v_permlane32_swap_b32 v196, v197
    v_add_f32 v192, v192, v193
    v_add_f32 v196, v196, v197
    v_mul_f32 v192, 0x3b000000, v192
    v_mul_f32 v196, 0x3b000000, v196
    v_fma_f32 v196, -v192, v192, v196
    v_max_f32 v196, 0, v196
    v_cvt_pk_bf16_f32 v193, v192, v196
    v_lshlrev_b32 v245, 16, v193
    v_and_b32 v194, 4294901760, v193
    v_add_f32 v194, 0x3727c5ac, v194
    v_cvt_pk_bf16_f32 v194, v194, v194
    v_and_b32 v194, 4294901760, v194
    v_sqrt_f32 v194, v194
    s_nop 0
    v_cvt_pk_bf16_f32 v194, v194, v194
    v_and_b32 v194, 4294901760, v194
    v_rcp_f32 v246, v194
    s_nop 0
    v_mul_f32 v245, v245, v246
    v_lshlrev_b32 v192, 16, v0
    v_lshlrev_b32 v194, 16, v1
    v_lshlrev_b32 v196, 16, v2
    v_lshlrev_b32 v198, 16, v3
    v_and_b32 v193, 4294901760, v0
    v_and_b32 v195, 4294901760, v1
    v_and_b32 v197, 4294901760, v2
    v_and_b32 v199, 4294901760, v3
    v_fma_f32 v192, v192, v246, -v245
    v_fma_f32 v194, v194, v246, -v245
    v_fma_f32 v196, v196, v246, -v245
    v_fma_f32 v198, v198, v246, -v245
    v_fma_f32 v193, v193, v246, -v245
    v_fma_f32 v195, v195, v246, -v245
    v_fma_f32 v197, v197, v246, -v245
    v_fma_f32 v199, v199, v246, -v245
    v_cvt_pk_bf16_f32 v0, v192, v193
    v_cvt_pk_bf16_f32 v1, v194, v195
    v_cvt_pk_bf16_f32 v2, v196, v197
    v_cvt_pk_bf16_f32 v3, v198, v199
    v_lshrrev_b32 v252, 5, v240
    v_mul_u32_u24 v252, 8, v252
    v_bfe_u32 v253, v240, 2, 2
    v_add_u32 v252, v252, v253
    v_mul_u32_u24 v252, 64, v252
    v_bfe_u32 v253, v240, 4, 1
    v_mul_u32_u24 v253, 32, v253
    v_add_u32 v252, v252, v253
    v_and_b32 v253, 3, v240
    v_lshl_add_u32 v247, v253, 3, v252
    v_add_u32 v248, 65536, v247
    v_lshrrev_b32 v252, 5, v240
    v_mul_u32_u24 v252, 8, v252
    v_bfe_u32 v253, v240, 2, 2
    v_add_u32 v252, v252, v253
    v_mul_u32_u24 v252, 32, v252
    v_bfe_u32 v253, v240, 4, 1
    v_mul_u32_u24 v253, 12416, v253
    v_add_u32 v252, v252, v253
    v_and_b32 v253, 3, v240
    v_lshl_add_u32 v249, v253, 3, v252
    v_add_u32 v250, 65536, v249
    s_barrier
    ds_read_b64_tr_b16 v[208:209], v247
    ds_read_b64_tr_b16 v[210:211], v247 offset:256
    ds_read_b64_tr_b16 v[212:213], v247 offset:8192
    ds_read_b64_tr_b16 v[214:215], v247 offset:8448
    ds_read_b64_tr_b16 v[216:217], v247 offset:16384
    ds_read_b64_tr_b16 v[218:219], v247 offset:16640
    ds_read_b64_tr_b16 v[220:221], v247 offset:24576
    ds_read_b64_tr_b16 v[222:223], v247 offset:24832
    ds_read_b64_tr_b16 v[224:225], v247 offset:1024
    ds_read_b64_tr_b16 v[226:227], v247 offset:1280
    ds_read_b64_tr_b16 v[228:229], v247 offset:9216
    ds_read_b64_tr_b16 v[230:231], v247 offset:9472
    ds_read_b64_tr_b16 v[232:233], v247 offset:17408
    ds_read_b64_tr_b16 v[234:235], v247 offset:17664
    ds_read_b64_tr_b16 v[236:237], v247 offset:25600
    s_waitcnt lgkmcnt(14)
    ds_read_b64_tr_b16 v[238:239], v247 offset:25856
    s_waitcnt lgkmcnt(8)
    v_mfma_f32_32x32x16_bf16 v[128:143], v[208:211], v[0:3], 0
    ds_read_b64_tr_b16 v[208:209], v247 offset:2048
    ds_read_b64_tr_b16 v[210:211], v247 offset:2304
    s_cmp_ge_u32 s4, 4
    s_cbranch_scc1 L_nd5
    s_mov_b32 s91, 1048576
    s_add_u32 m0, s10, 32768
    s_nop 0
    buffer_load_dwordx4 v242, s[48:51], s91 offen lds
    s_mov_b32 s91, 1048576
    s_add_u32 m0, s10, 40896
    s_nop 0
    buffer_load_dwordx4 v242, s[48:51], s91 offen offset:64 lds
L_nd5:
    v_lshlrev_b32 v192, 16, v4
    v_lshlrev_b32 v194, 16, v5
    v_lshlrev_b32 v196, 16, v6
    v_lshlrev_b32 v198, 16, v7
    v_and_b32 v193, 4294901760, v4
    v_mfma_f32_32x32x16_bf16 v[144:159], v[212:215], v[0:3], 0
    ds_read_b64_tr_b16 v[212:213], v247 offset:10240
    ds_read_b64_tr_b16 v[214:215], v247 offset:10496
    v_and_b32 v195, 4294901760, v5
    v_and_b32 v197, 4294901760, v6
    v_and_b32 v199, 4294901760, v7
    v_fma_f32 v192, v192, v246, -v245
    v_fma_f32 v194, v194, v246, -v245
    v_mfma_f32_32x32x16_bf16 v[160:175], v[216:219], v[0:3], 0
    ds_read_b64_tr_b16 v[216:217], v247 offset:18432
    ds_read_b64_tr_b16 v[218:219], v247 offset:18688
    s_cmp_ge_u32 s4, 4
    s_cbranch_scc1 L_nd6
    s_mov_b32 s91, 1048576
    s_add_u32 m0, s10, 49024
    s_nop 0
    buffer_load_dwordx4 v242, s[48:51], s91 offen offset:128 lds
    s_mov_b32 s91, 1048576
    s_add_u32 m0, s10, 57152
    s_nop 0
    buffer_load_dwordx4 v242, s[48:51], s91 offen offset:192 lds
L_nd6:
    v_fma_f32 v196, v196, v246, -v245
    v_fma_f32 v198, v198, v246, -v245
    v_fma_f32 v193, v193, v246, -v245
    v_fma_f32 v195, v195, v246, -v245
    v_fma_f32 v197, v197, v246, -v245
    v_mfma_f32_32x32x16_bf16 v[176:191], v[220:223], v[0:3], 0
    ds_read_b64_tr_b16 v[220:221], v247 offset:26624
    s_waitcnt lgkmcnt(14)
    ds_read_b64_tr_b16 v[222:223], v247 offset:26880
    v_fma_f32 v199, v199, v246, -v245
    v_cvt_pk_bf16_f32 v4, v192, v193
    v_cvt_pk_bf16_f32 v5, v194, v195
    v_cvt_pk_bf16_f32 v6, v196, v197
    v_cvt_pk_bf16_f32 v7, v198, v199
    s_waitcnt lgkmcnt(8)
    s_nop 0
    v_mfma_f32_32x32x16_bf16 v[128:143], v[224:227], v[4:7], v[128:143]
    ds_read_b64_tr_b16 v[224:225], v247 offset:3072
    ds_read_b64_tr_b16 v[226:227], v247 offset:3328
    s_cmp_ge_u32 s4, 4
    s_cbranch_scc1 L_nd7
    s_mov_b32 s91, 1179648
    s_add_u32 m0, s10, 33792
    s_nop 0
    buffer_load_dwordx4 v242, s[48:51], s91 offen lds
    s_mov_b32 s91, 1179648
    s_add_u32 m0, s10, 41920
    s_nop 0
    buffer_load_dwordx4 v242, s[48:51], s91 offen offset:64 lds
L_nd7:
    v_lshlrev_b32 v192, 16, v8
    v_lshlrev_b32 v194, 16, v9
    v_lshlrev_b32 v196, 16, v10
    v_lshlrev_b32 v198, 16, v11
    v_and_b32 v193, 4294901760, v8
    v_mfma_f32_32x32x16_bf16 v[144:159], v[228:231], v[4:7], v[144:159]
    ds_read_b64_tr_b16 v[228:229], v247 offset:11264
    ds_read_b64_tr_b16 v[230:231], v247 offset:11520
    v_and_b32 v195, 4294901760, v9
    v_and_b32 v197, 4294901760, v10
    v_and_b32 v199, 4294901760, v11
    v_fma_f32 v192, v192, v246, -v245
    v_fma_f32 v194, v194, v246, -v245
    v_mfma_f32_32x32x16_bf16 v[160:175], v[232:235], v[4:7], v[160:175]
    ds_read_b64_tr_b16 v[232:233], v247 offset:19456
    ds_read_b64_tr_b16 v[234:235], v247 offset:19712
    s_cmp_ge_u32 s4, 4
    s_cbranch_scc1 L_nd8
    s_mov_b32 s91, 1179648
    s_add_u32 m0, s10, 50048
    s_nop 0
    buffer_load_dwordx4 v242, s[48:51], s91 offen offset:128 lds
    s_mov_b32 s91, 1179648
    s_add_u32 m0, s10, 58176
    s_nop 0
    buffer_load_dwordx4 v242, s[48:51], s91 offen offset:192 lds
L_nd8:
    v_fma_f32 v196, v196, v246, -v245
    v_fma_f32 v198, v198, v246, -v245
    v_fma_f32 v193, v193, v246, -v245
    v_fma_f32 v195, v195, v246, -v245
    v_fma_f32 v197, v197, v246, -v245
    v_mfma_f32_32x32x16_bf16 v[176:191], v[236:239], v[4:7], v[176:191]
    ds_read_b64_tr_b16 v[236:237], v247 offset:27648
    s_waitcnt lgkmcnt(14)
    ds_read_b64_tr_b16 v[238:239], v247 offset:27904
    v_fma_f32 v199, v199, v246, -v245
    v_cvt_pk_bf16_f32 v8, v192, v193
    v_cvt_pk_bf16_f32 v9, v194, v195
    v_cvt_pk_bf16_f32 v10, v196, v197
    v_cvt_pk_bf16_f32 v11, v198, v199
    s_waitcnt lgkmcnt(8)
    s_nop 0
    v_mfma_f32_32x32x16_bf16 v[128:143], v[208:211], v[8:11], v[128:143]
    ds_read_b64_tr_b16 v[208:209], v247 offset:4096
    ds_read_b64_tr_b16 v[210:211], v247 offset:4352
    s_cmp_ge_u32 s4, 4
    s_cbranch_scc1 L_nd9
    s_mov_b32 s91, 2097152
    s_add_u32 m0, s10, 65536
    s_nop 0
    buffer_load_dwordx4 v242, s[48:51], s91 offen lds
    s_mov_b32 s91, 2097152
    s_add_u32 m0, s10, 73664
    s_nop 0
    buffer_load_dwordx4 v242, s[48:51], s91 offen offset:64 lds
L_nd9:
    v_lshlrev_b32 v192, 16, v12
    v_lshlrev_b32 v194, 16, v13
    v_lshlrev_b32 v196, 16, v14
    v_lshlrev_b32 v198, 16, v15
    v_and_b32 v193, 4294901760, v12
    v_mfma_f32_32x32x16_bf16 v[144:159], v[212:215], v[8:11], v[144:159]
    ds_read_b64_tr_b16 v[212:213], v247 offset:12288
    ds_read_b64_tr_b16 v[214:215], v247 offset:12544
    v_and_b32 v195, 4294901760, v13
    v_and_b32 v197, 4294901760, v14
    v_and_b32 v199, 4294901760, v15
    v_fma_f32 v192, v192, v246, -v245
    v_fma_f32 v194, v194, v246, -v245
    v_mfma_f32_32x32x16_bf16 v[160:175], v[216:219], v[8:11], v[160:175]
    ds_read_b64_tr_b16 v[216:217], v247 offset:20480
    ds_read_b64_tr_b16 v[218:219], v247 offset:20736
    s_cmp_ge_u32 s4, 4
    s_cbranch_scc1 L_nd10
    s_mov_b32 s91, 2097152
    s_add_u32 m0, s10, 81792
    s_nop 0
    buffer_load_dwordx4 v242, s[48:51], s91 offen offset:128 lds
    s_mov_b32 s91, 2097152
    s_add_u32 m0, s10, 89920
    s_nop 0
    buffer_load_dwordx4 v242, s[48:51], s91 offen offset:192 lds
L_nd10:
    v_fma_f32 v196, v196, v246, -v245
    v_fma_f32 v198, v198, v246, -v245
    v_fma_f32 v193, v193, v246, -v245
    v_fma_f32 v195, v195, v246, -v245
    v_fma_f32 v197, v197, v246, -v245
    v_mfma_f32_32x32x16_bf16 v[176:191], v[220:223], v[8:11], v[176:191]
    ds_read_b64_tr_b16 v[220:221], v247 offset:28672
    s_waitcnt lgkmcnt(14)
    ds_read_b64_tr_b16 v[222:223], v247 offset:28928
    v_fma_f32 v199, v199, v246, -v245
    v_cvt_pk_bf16_f32 v12, v192, v193
    v_cvt_pk_bf16_f32 v13, v194, v195
    v_cvt_pk_bf16_f32 v14, v196, v197
    v_cvt_pk_bf16_f32 v15, v198, v199
    s_waitcnt lgkmcnt(8)
    s_nop 0
    v_mfma_f32_32x32x16_bf16 v[128:143], v[224:227], v[12:15], v[128:143]
    ds_read_b64_tr_b16 v[224:225], v247 offset:5120
    ds_read_b64_tr_b16 v[226:227], v247 offset:5376
    s_cmp_ge_u32 s4, 4
    s_cbranch_scc1 L_nd11
    s_mov_b32 s91, 2228224
    s_add_u32 m0, s10, 66560
    s_nop 0
    buffer_load_dwordx4 v242, s[48:51], s91 offen lds
    s_mov_b32 s91, 2228224
    s_add_u32 m0, s10, 74688
    s_nop 0
    buffer_load_dwordx4 v242, s[48:51], s91 offen offset:64 lds
L_nd11:
    v_lshlrev_b32 v192, 16, v16
    v_lshlrev_b32 v194, 16, v17
    v_lshlrev_b32 v196, 16, v18
    v_lshlrev_b32 v198, 16, v19
    v_and_b32 v193, 4294901760, v16
    v_mfma_f32_32x32x16_bf16 v[144:159], v[228:231], v[12:15], v[144:159]
    ds_read_b64_tr_b16 v[228:229], v247 offset:13312
    ds_read_b64_tr_b16 v[230:231], v247 offset:13568
    v_and_b32 v195, 4294901760, v17
    v_and_b32 v197, 4294901760, v18
    v_and_b32 v199, 4294901760, v19
    v_fma_f32 v192, v192, v246, -v245
    v_fma_f32 v194, v194, v246, -v245
    v_mfma_f32_32x32x16_bf16 v[160:175], v[232:235], v[12:15], v[160:175]
    ds_read_b64_tr_b16 v[232:233], v247 offset:21504
    ds_read_b64_tr_b16 v[234:235], v247 offset:21760
    s_cmp_ge_u32 s4, 4
    s_cbranch_scc1 L_nd12
    s_mov_b32 s91, 2228224
    s_add_u32 m0, s10, 82816
    s_nop 0
    buffer_load_dwordx4 v242, s[48:51], s91 offen offset:128 lds
    s_mov_b32 s91, 2228224
    s_add_u32 m0, s10, 90944
    s_nop 0
    buffer_load_dwordx4 v242, s[48:51], s91 offen offset:192 lds
L_nd12:
    v_fma_f32 v196, v196, v246, -v245
    v_fma_f32 v198, v198, v246, -v245
    v_fma_f32 v193, v193, v246, -v245
    v_fma_f32 v195, v195, v246, -v245
    v_fma_f32 v197, v197, v246, -v245
    v_mfma_f32_32x32x16_bf16 v[176:191], v[236:239], v[12:15], v[176:191]
    ds_read_b64_tr_b16 v[236:237], v247 offset:29696
    s_waitcnt lgkmcnt(14)
    ds_read_b64_tr_b16 v[238:239], v247 offset:29952
    v_fma_f32 v199, v199, v246, -v245
    v_cvt_pk_bf16_f32 v16, v192, v193
    v_cvt_pk_bf16_f32 v17, v194, v195
    v_cvt_pk_bf16_f32 v18, v196, v197
    v_cvt_pk_bf16_f32 v19, v198, v199
    s_waitcnt lgkmcnt(8)
    s_nop 0
    v_mfma_f32_32x32x16_bf16 v[128:143], v[208:211], v[16:19], v[128:143]
    ds_read_b64_tr_b16 v[208:209], v247 offset:6144
    ds_read_b64_tr_b16 v[210:211], v247 offset:6400
    s_cmp_ge_u32 s4, 4
    s_cbranch_scc1 L_nd13
    s_lshl_b32 s91, s4, 12
    s_add_u32 m0, s91, 131072
    s_lshl_b32 s15, s2, 14
    s_add_u32 s91, s91, s15
    buffer_load_dwordx4 v241, s[52:55], s91 offen lds
    s_lshl_b32 s91, s4, 12
    s_add_u32 m0, s91, 131072
    s_lshl_b32 s15, s2, 14
    s_add_u32 s91, s91, s15
    buffer_load_dwordx4 v241, s[52:55], s91 offen offset:1024 lds
L_nd13:
    v_lshlrev_b32 v192, 16, v20
    v_lshlrev_b32 v194, 16, v21
    v_lshlrev_b32 v196, 16, v22
    v_lshlrev_b32 v198, 16, v23
    v_and_b32 v193, 4294901760, v20
    v_mfma_f32_32x32x16_bf16 v[144:159], v[212:215], v[16:19], v[144:159]
    ds_read_b64_tr_b16 v[212:213], v247 offset:14336
    ds_read_b64_tr_b16 v[214:215], v247 offset:14592
    v_and_b32 v195, 4294901760, v21
    v_and_b32 v197, 4294901760, v22
    v_and_b32 v199, 4294901760, v23
    v_fma_f32 v192, v192, v246, -v245
    v_fma_f32 v194, v194, v246, -v245
    v_mfma_f32_32x32x16_bf16 v[160:175], v[216:219], v[16:19], v[160:175]
    ds_read_b64_tr_b16 v[216:217], v247 offset:22528
    ds_read_b64_tr_b16 v[218:219], v247 offset:22784
    s_cmp_ge_u32 s4, 4
    s_cbranch_scc1 L_nd14
    s_lshl_b32 s91, s4, 12
    s_add_u32 m0, s91, 131072
    s_lshl_b32 s15, s2, 14
    s_add_u32 s91, s91, s15
    buffer_load_dwordx4 v241, s[52:55], s91 offen offset:2048 lds
    s_lshl_b32 s91, s4, 12
    s_add_u32 m0, s91, 131072
    s_lshl_b32 s15, s2, 14
    s_add_u32 s91, s91, s15
    buffer_load_dwordx4 v241, s[52:55], s91 offen offset:3072 lds
L_nd14:
    v_fma_f32 v196, v196, v246, -v245
    v_fma_f32 v198, v198, v246, -v245
    v_fma_f32 v193, v193, v246, -v245
    v_fma_f32 v195, v195, v246, -v245
    v_fma_f32 v197, v197, v246, -v245
    v_mfma_f32_32x32x16_bf16 v[176:191], v[220:223], v[16:19], v[176:191]
    ds_read_b64_tr_b16 v[220:221], v247 offset:30720
    s_waitcnt lgkmcnt(14)
    ds_read_b64_tr_b16 v[222:223], v247 offset:30976
    v_fma_f32 v199, v199, v246, -v245
    v_cvt_pk_bf16_f32 v20, v192, v193
    v_cvt_pk_bf16_f32 v21, v194, v195
    v_cvt_pk_bf16_f32 v22, v196, v197
    v_cvt_pk_bf16_f32 v23, v198, v199
    s_waitcnt lgkmcnt(8)
    s_nop 0
    v_mfma_f32_32x32x16_bf16 v[128:143], v[224:227], v[20:23], v[128:143]
    ds_read_b64_tr_b16 v[224:225], v247 offset:7168
    ds_read_b64_tr_b16 v[226:227], v247 offset:7424
    s_cmp_ge_u32 s4, 4
    s_cbranch_scc1 L_nd15
    s_lshl_b32 s91, s4, 12
    s_add_u32 m0, s91, 147456
    s_lshl_b32 s15, s2, 14
    s_add_u32 s91, s91, s15
    buffer_load_dwordx4 v241, s[56:59], s91 offen lds
    s_lshl_b32 s91, s4, 12
    s_add_u32 m0, s91, 147456
    s_lshl_b32 s15, s2, 14
    s_add_u32 s91, s91, s15
    buffer_load_dwordx4 v241, s[56:59], s91 offen offset:1024 lds
L_nd15:
    v_lshlrev_b32 v192, 16, v24
    v_lshlrev_b32 v194, 16, v25
    v_lshlrev_b32 v196, 16, v26
    v_lshlrev_b32 v198, 16, v27
    v_and_b32 v193, 4294901760, v24
    v_mfma_f32_32x32x16_bf16 v[144:159], v[228:231], v[20:23], v[144:159]
    ds_read_b64_tr_b16 v[228:229], v247 offset:15360
    ds_read_b64_tr_b16 v[230:231], v247 offset:15616
    v_and_b32 v195, 4294901760, v25
    v_and_b32 v197, 4294901760, v26
    v_and_b32 v199, 4294901760, v27
    v_fma_f32 v192, v192, v246, -v245
    v_fma_f32 v194, v194, v246, -v245
    v_mfma_f32_32x32x16_bf16 v[160:175], v[232:235], v[20:23], v[160:175]
    ds_read_b64_tr_b16 v[232:233], v247 offset:23552
    ds_read_b64_tr_b16 v[234:235], v247 offset:23808
    s_cmp_ge_u32 s4, 4
    s_cbranch_scc1 L_nd16
    s_lshl_b32 s91, s4, 12
    s_add_u32 m0, s91, 147456
    s_lshl_b32 s15, s2, 14
    s_add_u32 s91, s91, s15
    buffer_load_dwordx4 v241, s[56:59], s91 offen offset:2048 lds
    s_lshl_b32 s91, s4, 12
    s_add_u32 m0, s91, 147456
    s_lshl_b32 s15, s2, 14
    s_add_u32 s91, s91, s15
    buffer_load_dwordx4 v241, s[56:59], s91 offen offset:3072 lds
L_nd16:
    v_fma_f32 v196, v196, v246, -v245
    v_fma_f32 v198, v198, v246, -v245
    v_fma_f32 v193, v193, v246, -v245
    v_fma_f32 v195, v195, v246, -v245
    v_fma_f32 v197, v197, v246, -v245
    v_mfma_f32_32x32x16_bf16 v[176:191], v[236:239], v[20:23], v[176:191]
    ds_read_b64_tr_b16 v[236:237], v247 offset:31744
    s_waitcnt lgkmcnt(14)
    ds_read_b64_tr_b16 v[238:239], v247 offset:32000
    v_fma_f32 v199, v199, v246, -v245
    v_cvt_pk_bf16_f32 v24, v192, v193
    v_cvt_pk_bf16_f32 v25, v194, v195
    v_cvt_pk_bf16_f32 v26, v196, v197
    v_cvt_pk_bf16_f32 v27, v198, v199
    s_waitcnt lgkmcnt(8)
    s_nop 0
    v_mfma_f32_32x32x16_bf16 v[128:143], v[208:211], v[24:27], v[128:143]
    s_waitcnt vmcnt(16)
    s_barrier
    ds_read_b64_tr_b16 v[208:209], v247 offset:32768
    ds_read_b64_tr_b16 v[210:211], v247 offset:33024
    s_cmp_ge_u32 s4, 4
    s_cbranch_scc1 L_nd17
    s_mov_b32 s91, 3145728
    s_add_u32 m0, s10, 98304
    s_nop 0
    buffer_load_dwordx4 v242, s[48:51], s91 offen lds
    s_mov_b32 s91, 3145728
    s_add_u32 m0, s10, 106432
    s_nop 0
    buffer_load_dwordx4 v242, s[48:51], s91 offen offset:64 lds
L_nd17:
    v_lshlrev_b32 v192, 16, v28
    v_lshlrev_b32 v194, 16, v29
    v_lshlrev_b32 v196, 16, v30
    v_lshlrev_b32 v198, 16, v31
    v_and_b32 v193, 4294901760, v28
    v_mfma_f32_32x32x16_bf16 v[144:159], v[212:215], v[24:27], v[144:159]
    ds_read_b64_tr_b16 v[212:213], v247 offset:40960
    ds_read_b64_tr_b16 v[214:215], v247 offset:41216
    v_and_b32 v195, 4294901760, v29
    v_and_b32 v197, 4294901760, v30
    v_and_b32 v199, 4294901760, v31
    v_fma_f32 v192, v192, v246, -v245
    v_fma_f32 v194, v194, v246, -v245
    v_mfma_f32_32x32x16_bf16 v[160:175], v[216:219], v[24:27], v[160:175]
    ds_read_b64_tr_b16 v[216:217], v247 offset:49152
    ds_read_b64_tr_b16 v[218:219], v247 offset:49408
    s_cmp_ge_u32 s4, 4
    s_cbranch_scc1 L_nd18
    s_mov_b32 s91, 3145728
    s_add_u32 m0, s10, 114560
    s_nop 0
    buffer_load_dwordx4 v242, s[48:51], s91 offen offset:128 lds
    s_mov_b32 s91, 3145728
    s_add_u32 m0, s10, 122688
    s_nop 0
    buffer_load_dwordx4 v242, s[48:51], s91 offen offset:192 lds
L_nd18:
    v_fma_f32 v196, v196, v246, -v245
    v_fma_f32 v198, v198, v246, -v245
    v_fma_f32 v193, v193, v246, -v245
    v_fma_f32 v195, v195, v246, -v245
    v_fma_f32 v197, v197, v246, -v245
    v_mfma_f32_32x32x16_bf16 v[176:191], v[220:223], v[24:27], v[176:191]
    ds_read_b64_tr_b16 v[220:221], v247 offset:57344
    s_waitcnt lgkmcnt(14)
    ds_read_b64_tr_b16 v[222:223], v247 offset:57600
    v_fma_f32 v199, v199, v246, -v245
    v_cvt_pk_bf16_f32 v28, v192, v193
    v_cvt_pk_bf16_f32 v29, v194, v195
    v_cvt_pk_bf16_f32 v30, v196, v197
    v_cvt_pk_bf16_f32 v31, v198, v199
    s_waitcnt lgkmcnt(8)
    s_nop 0
    v_mfma_f32_32x32x16_bf16 v[128:143], v[224:227], v[28:31], v[128:143]
    ds_read_b64_tr_b16 v[224:225], v247 offset:33792
    ds_read_b64_tr_b16 v[226:227], v247 offset:34048
    s_cmp_ge_u32 s4, 4
    s_cbranch_scc1 L_nd19
    s_mov_b32 s91, 3276800
    s_add_u32 m0, s10, 99328
    s_nop 0
    buffer_load_dwordx4 v242, s[48:51], s91 offen lds
    s_mov_b32 s91, 3276800
    s_add_u32 m0, s10, 107456
    s_nop 0
    buffer_load_dwordx4 v242, s[48:51], s91 offen offset:64 lds
L_nd19:
    v_lshlrev_b32 v192, 16, v32
    v_lshlrev_b32 v194, 16, v33
    v_lshlrev_b32 v196, 16, v34
    v_lshlrev_b32 v198, 16, v35
    v_and_b32 v193, 4294901760, v32
    v_mfma_f32_32x32x16_bf16 v[144:159], v[228:231], v[28:31], v[144:159]
    ds_read_b64_tr_b16 v[228:229], v247 offset:41984
    ds_read_b64_tr_b16 v[230:231], v247 offset:42240
    v_and_b32 v195, 4294901760, v33
    v_and_b32 v197, 4294901760, v34
    v_and_b32 v199, 4294901760, v35
    v_fma_f32 v192, v192, v246, -v245
    v_fma_f32 v194, v194, v246, -v245
    v_mfma_f32_32x32x16_bf16 v[160:175], v[232:235], v[28:31], v[160:175]
    ds_read_b64_tr_b16 v[232:233], v247 offset:50176
    ds_read_b64_tr_b16 v[234:235], v247 offset:50432
    s_cmp_ge_u32 s4, 4
    s_cbranch_scc1 L_nd20
    s_mov_b32 s91, 3276800
    s_add_u32 m0, s10, 115584
    s_nop 0
    buffer_load_dwordx4 v242, s[48:51], s91 offen offset:128 lds
    s_mov_b32 s91, 3276800
    s_add_u32 m0, s10, 123712
    s_nop 0
    buffer_load_dwordx4 v242, s[48:51], s91 offen offset:192 lds
L_nd20:
    v_fma_f32 v196, v196, v246, -v245
    v_fma_f32 v198, v198, v246, -v245
    v_fma_f32 v193, v193, v246, -v245
    v_fma_f32 v195, v195, v246, -v245
    v_fma_f32 v197, v197, v246, -v245
    v_mfma_f32_32x32x16_bf16 v[176:191], v[236:239], v[28:31], v[176:191]
    ds_read_b64_tr_b16 v[236:237], v247 offset:58368
    s_waitcnt lgkmcnt(14)
    ds_read_b64_tr_b16 v[238:239], v247 offset:58624
    v_fma_f32 v199, v199, v246, -v245
    v_cvt_pk_bf16_f32 v32, v192, v193
    v_cvt_pk_bf16_f32 v33, v194, v195
    v_cvt_pk_bf16_f32 v34, v196, v197
    v_cvt_pk_bf16_f32 v35, v198, v199
    s_waitcnt lgkmcnt(8)
    s_nop 0
    v_mfma_f32_32x32x16_bf16 v[128:143], v[208:211], v[32:35], v[128:143]
    ds_read_b64_tr_b16 v[208:209], v247 offset:34816
    ds_read_b64_tr_b16 v[210:211], v247 offset:35072
    v_lshlrev_b32 v192, 16, v36
    v_lshlrev_b32 v194, 16, v37
    v_lshlrev_b32 v196, 16, v38
    v_lshlrev_b32 v198, 16, v39
    v_and_b32 v193, 4294901760, v36
    v_mfma_f32_32x32x16_bf16 v[144:159], v[212:215], v[32:35], v[144:159]
    ds_read_b64_tr_b16 v[212:213], v247 offset:43008
    ds_read_b64_tr_b16 v[214:215], v247 offset:43264
    v_and_b32 v195, 4294901760, v37
    v_and_b32 v197, 4294901760, v38
    v_and_b32 v199, 4294901760, v39
    v_fma_f32 v192, v192, v246, -v245
    v_fma_f32 v194, v194, v246, -v245
    v_mfma_f32_32x32x16_bf16 v[160:175], v[216:219], v[32:35], v[160:175]
    ds_read_b64_tr_b16 v[216:217], v247 offset:51200
    ds_read_b64_tr_b16 v[218:219], v247 offset:51456
    v_fma_f32 v196, v196, v246, -v245
    v_fma_f32 v198, v198, v246, -v245
    v_fma_f32 v193, v193, v246, -v245
    v_fma_f32 v195, v195, v246, -v245
    v_fma_f32 v197, v197, v246, -v245
    v_mfma_f32_32x32x16_bf16 v[176:191], v[220:223], v[32:35], v[176:191]
    ds_read_b64_tr_b16 v[220:221], v247 offset:59392
    s_waitcnt lgkmcnt(14)
    ds_read_b64_tr_b16 v[222:223], v247 offset:59648
    v_fma_f32 v199, v199, v246, -v245
    v_cvt_pk_bf16_f32 v36, v192, v193
    v_cvt_pk_bf16_f32 v37, v194, v195
    v_cvt_pk_bf16_f32 v38, v196, v197
    v_cvt_pk_bf16_f32 v39, v198, v199
    s_waitcnt lgkmcnt(8)
    s_nop 0
    v_mfma_f32_32x32x16_bf16 v[128:143], v[224:227], v[36:39], v[128:143]
    ds_read_b64_tr_b16 v[224:225], v247 offset:35840
    ds_read_b64_tr_b16 v[226:227], v247 offset:36096
    v_lshlrev_b32 v192, 16, v40
    v_lshlrev_b32 v194, 16, v41
    v_lshlrev_b32 v196, 16, v42
    v_lshlrev_b32 v198, 16, v43
    v_and_b32 v193, 4294901760, v40
    v_mfma_f32_32x32x16_bf16 v[144:159], v[228:231], v[36:39], v[144:159]
    ds_read_b64_tr_b16 v[228:229], v247 offset:44032
    ds_read_b64_tr_b16 v[230:231], v247 offset:44288
    v_and_b32 v195, 4294901760, v41
    v_and_b32 v197, 4294901760, v42
    v_and_b32 v199, 4294901760, v43
    v_fma_f32 v192, v192, v246, -v245
    v_fma_f32 v194, v194, v246, -v245
    v_mfma_f32_32x32x16_bf16 v[160:175], v[232:235], v[36:39], v[160:175]
    ds_read_b64_tr_b16 v[232:233], v247 offset:52224
    ds_read_b64_tr_b16 v[234:235], v247 offset:52480
    v_fma_f32 v196, v196, v246, -v245
    v_fma_f32 v198, v198, v246, -v245
    v_fma_f32 v193, v193, v246, -v245
    v_fma_f32 v195, v195, v246, -v245
    v_fma_f32 v197, v197, v246, -v245
    v_mfma_f32_32x32x16_bf16 v[176:191], v[236:239], v[36:39], v[176:191]
    ds_read_b64_tr_b16 v[236:237], v247 offset:60416
    s_waitcnt lgkmcnt(14)
    ds_read_b64_tr_b16 v[238:239], v247 offset:60672
    v_fma_f32 v199, v199, v246, -v245
    v_cvt_pk_bf16_f32 v40, v192, v193
    v_cvt_pk_bf16_f32 v41, v194, v195
    v_cvt_pk_bf16_f32 v42, v196, v197
    v_cvt_pk_bf16_f32 v43, v198, v199
    s_waitcnt lgkmcnt(8)
    s_nop 0
    v_mfma_f32_32x32x16_bf16 v[128:143], v[208:211], v[40:43], v[128:143]
    ds_read_b64_tr_b16 v[208:209], v247 offset:36864
    ds_read_b64_tr_b16 v[210:211], v247 offset:37120
    v_lshlrev_b32 v192, 16, v44
    v_lshlrev_b32 v194, 16, v45
    v_lshlrev_b32 v196, 16, v46
    v_lshlrev_b32 v198, 16, v47
    v_and_b32 v193, 4294901760, v44
    v_mfma_f32_32x32x16_bf16 v[144:159], v[212:215], v[40:43], v[144:159]
    ds_read_b64_tr_b16 v[212:213], v247 offset:45056
    ds_read_b64_tr_b16 v[214:215], v247 offset:45312
    v_and_b32 v195, 4294901760, v45
    v_and_b32 v197, 4294901760, v46
    v_and_b32 v199, 4294901760, v47
    v_fma_f32 v192, v192, v246, -v245
    v_fma_f32 v194, v194, v246, -v245
    v_mfma_f32_32x32x16_bf16 v[160:175], v[216:219], v[40:43], v[160:175]
    ds_read_b64_tr_b16 v[216:217], v247 offset:53248
    ds_read_b64_tr_b16 v[218:219], v247 offset:53504
    v_fma_f32 v196, v196, v246, -v245
    v_fma_f32 v198, v198, v246, -v245
    v_fma_f32 v193, v193, v246, -v245
    v_fma_f32 v195, v195, v246, -v245
    v_fma_f32 v197, v197, v246, -v245
    v_mfma_f32_32x32x16_bf16 v[176:191], v[220:223], v[40:43], v[176:191]
    ds_read_b64_tr_b16 v[220:221], v247 offset:61440
    s_waitcnt lgkmcnt(14)
    ds_read_b64_tr_b16 v[222:223], v247 offset:61696
    v_fma_f32 v199, v199, v246, -v245
    v_cvt_pk_bf16_f32 v44, v192, v193
    v_cvt_pk_bf16_f32 v45, v194, v195
    v_cvt_pk_bf16_f32 v46, v196, v197
    v_cvt_pk_bf16_f32 v47, v198, v199
    s_waitcnt lgkmcnt(8)
    s_nop 0
    v_mfma_f32_32x32x16_bf16 v[128:143], v[224:227], v[44:47], v[128:143]
    ds_read_b64_tr_b16 v[224:225], v247 offset:37888
    ds_read_b64_tr_b16 v[226:227], v247 offset:38144
    v_lshlrev_b32 v192, 16, v48
    v_lshlrev_b32 v194, 16, v49
    v_lshlrev_b32 v196, 16, v50
    v_lshlrev_b32 v198, 16, v51
    v_and_b32 v193, 4294901760, v48
    v_mfma_f32_32x32x16_bf16 v[144:159], v[228:231], v[44:47], v[144:159]
    ds_read_b64_tr_b16 v[228:229], v247 offset:46080
    ds_read_b64_tr_b16 v[230:231], v247 offset:46336
    v_and_b32 v195, 4294901760, v49
    v_and_b32 v197, 4294901760, v50
    v_and_b32 v199, 4294901760, v51
    v_fma_f32 v192, v192, v246, -v245
    v_fma_f32 v194, v194, v246, -v245
    v_mfma_f32_32x32x16_bf16 v[160:175], v[232:235], v[44:47], v[160:175]
    ds_read_b64_tr_b16 v[232:233], v247 offset:54272
    ds_read_b64_tr_b16 v[234:235], v247 offset:54528
    v_fma_f32 v196, v196, v246, -v245
    v_fma_f32 v198, v198, v246, -v245
    v_fma_f32 v193, v193, v246, -v245
    v_fma_f32 v195, v195, v246, -v245
    v_fma_f32 v197, v197, v246, -v245
    v_mfma_f32_32x32x16_bf16 v[176:191], v[236:239], v[44:47], v[176:191]
    ds_read_b64_tr_b16 v[236:237], v247 offset:62464
    s_waitcnt lgkmcnt(14)
    ds_read_b64_tr_b16 v[238:239], v247 offset:62720
    v_fma_f32 v199, v199, v246, -v245
    v_cvt_pk_bf16_f32 v48, v192, v193
    v_cvt_pk_bf16_f32 v49, v194, v195
    v_cvt_pk_bf16_f32 v50, v196, v197
    v_cvt_pk_bf16_f32 v51, v198, v199
    s_waitcnt lgkmcnt(8)
    s_nop 0
    v_mfma_f32_32x32x16_bf16 v[128:143], v[208:211], v[48:51], v[128:143]
    ds_read_b64_tr_b16 v[208:209], v247 offset:38912
    ds_read_b64_tr_b16 v[210:211], v247 offset:39168
    v_lshlrev_b32 v192, 16, v52
    v_lshlrev_b32 v194, 16, v53
    v_lshlrev_b32 v196, 16, v54
    v_lshlrev_b32 v198, 16, v55
    v_and_b32 v193, 4294901760, v52
    v_mfma_f32_32x32x16_bf16 v[144:159], v[212:215], v[48:51], v[144:159]
    ds_read_b64_tr_b16 v[212:213], v247 offset:47104
    ds_read_b64_tr_b16 v[214:215], v247 offset:47360
    v_and_b32 v195, 4294901760, v53
    v_and_b32 v197, 4294901760, v54
    v_and_b32 v199, 4294901760, v55
    v_fma_f32 v192, v192, v246, -v245
    v_fma_f32 v194, v194, v246, -v245
    v_mfma_f32_32x32x16_bf16 v[160:175], v[216:219], v[48:51], v[160:175]
    ds_read_b64_tr_b16 v[216:217], v247 offset:55296
    ds_read_b64_tr_b16 v[218:219], v247 offset:55552
    v_fma_f32 v196, v196, v246, -v245
    v_fma_f32 v198, v198, v246, -v245
    v_fma_f32 v193, v193, v246, -v245
    v_fma_f32 v195, v195, v246, -v245
    v_fma_f32 v197, v197, v246, -v245
    v_mfma_f32_32x32x16_bf16 v[176:191], v[220:223], v[48:51], v[176:191]
    ds_read_b64_tr_b16 v[220:221], v247 offset:63488
    s_waitcnt lgkmcnt(14)
    ds_read_b64_tr_b16 v[222:223], v247 offset:63744
    v_fma_f32 v199, v199, v246, -v245
    v_cvt_pk_bf16_f32 v52, v192, v193
    v_cvt_pk_bf16_f32 v53, v194, v195
    v_cvt_pk_bf16_f32 v54, v196, v197
    v_cvt_pk_bf16_f32 v55, v198, v199
    s_waitcnt lgkmcnt(8)
    s_nop 0
    v_mfma_f32_32x32x16_bf16 v[128:143], v[224:227], v[52:55], v[128:143]
    ds_read_b64_tr_b16 v[224:225], v247 offset:39936
    ds_read_b64_tr_b16 v[226:227], v247 offset:40192
    v_lshlrev_b32 v192, 16, v56
    v_lshlrev_b32 v194, 16, v57
    v_lshlrev_b32 v196, 16, v58
    v_lshlrev_b32 v198, 16, v59
    v_and_b32 v193, 4294901760, v56
    v_mfma_f32_32x32x16_bf16 v[144:159], v[228:231], v[52:55], v[144:159]
    ds_read_b64_tr_b16 v[228:229], v247 offset:48128
    ds_read_b64_tr_b16 v[230:231], v247 offset:48384
    v_and_b32 v195, 4294901760, v57
    v_and_b32 v197, 4294901760, v58
    v_and_b32 v199, 4294901760, v59
    v_fma_f32 v192, v192, v246, -v245
    v_fma_f32 v194, v194, v246, -v245
    v_mfma_f32_32x32x16_bf16 v[160:175], v[232:235], v[52:55], v[160:175]
    ds_read_b64_tr_b16 v[232:233], v247 offset:56320
    ds_read_b64_tr_b16 v[234:235], v247 offset:56576
    v_fma_f32 v196, v196, v246, -v245
    v_fma_f32 v198, v198, v246, -v245
    v_fma_f32 v193, v193, v246, -v245
    v_fma_f32 v195, v195, v246, -v245
    v_fma_f32 v197, v197, v246, -v245
    v_mfma_f32_32x32x16_bf16 v[176:191], v[236:239], v[52:55], v[176:191]
    ds_read_b64_tr_b16 v[236:237], v247 offset:64512
    s_waitcnt lgkmcnt(14)
    ds_read_b64_tr_b16 v[238:239], v247 offset:64768
    v_fma_f32 v199, v199, v246, -v245
    v_cvt_pk_bf16_f32 v56, v192, v193
    v_cvt_pk_bf16_f32 v57, v194, v195
    v_cvt_pk_bf16_f32 v58, v196, v197
    v_cvt_pk_bf16_f32 v59, v198, v199
    s_waitcnt lgkmcnt(8)
    s_nop 0
    v_mfma_f32_32x32x16_bf16 v[128:143], v[208:211], v[56:59], v[128:143]
    s_waitcnt vmcnt(16)
    s_barrier
    ds_read_b64_tr_b16 v[208:209], v248
    ds_read_b64_tr_b16 v[210:211], v248 offset:256
    s_cmp_ge_u32 s4, 4
    s_cbranch_scc1 L_nd21
    s_lshl_b32 s91, s7, 5
    s_add_u32 s91, s91, 0
    s_add_u32 m0, s11, 0
    s_nop 0
    buffer_load_dwordx4 v243, s[64:67], s91 offen lds
    s_lshl_b32 s91, s7, 5
    s_add_u32 s91, s91, 0
    s_add_u32 m0, s11, 4064
    s_nop 0
    buffer_load_dwordx4 v243, s[64:67], s91 offen offset:32 lds
L_nd21:
    v_lshlrev_b32 v192, 16, v60
    v_lshlrev_b32 v194, 16, v61
    v_lshlrev_b32 v196, 16, v62
    v_lshlrev_b32 v198, 16, v63
    v_and_b32 v193, 4294901760, v60
    v_mfma_f32_32x32x16_bf16 v[144:159], v[212:215], v[56:59], v[144:159]
    ds_read_b64_tr_b16 v[212:213], v248 offset:8192
    ds_read_b64_tr_b16 v[214:215], v248 offset:8448
    v_and_b32 v195, 4294901760, v61
    v_and_b32 v197, 4294901760, v62
    v_and_b32 v199, 4294901760, v63
    v_fma_f32 v192, v192, v246, -v245
    v_fma_f32 v194, v194, v246, -v245
    v_mfma_f32_32x32x16_bf16 v[160:175], v[216:219], v[56:59], v[160:175]
    ds_read_b64_tr_b16 v[216:217], v248 offset:16384
    ds_read_b64_tr_b16 v[218:219], v248 offset:16640
    s_cmp_ge_u32 s4, 4
    s_cbranch_scc1 L_nd22
    s_lshl_b32 s91, s7, 5
    s_add_u32 s91, s91, 0
    s_add_u32 m0, s11, 8128
    s_nop 0
    buffer_load_dwordx4 v243, s[64:67], s91 offen offset:64 lds
    s_lshl_b32 s91, s7, 5
    s_add_u32 s91, s91, 0
    s_add_u32 m0, s11, 12416
    s_nop 0
    buffer_load_dwordx4 v243, s[72:75], s91 offen lds
L_nd22:
    v_fma_f32 v196, v196, v246, -v245
    v_fma_f32 v198, v198, v246, -v245
    v_fma_f32 v193, v193, v246, -v245
    v_fma_f32 v195, v195, v246, -v245
    v_fma_f32 v197, v197, v246, -v245
    v_mfma_f32_32x32x16_bf16 v[176:191], v[220:223], v[56:59], v[176:191]
    ds_read_b64_tr_b16 v[220:221], v248 offset:24576
    s_waitcnt lgkmcnt(14)
    ds_read_b64_tr_b16 v[222:223], v248 offset:24832
    v_fma_f32 v199, v199, v246, -v245
    v_cvt_pk_bf16_f32 v60, v192, v193
    v_cvt_pk_bf16_f32 v61, v194, v195
    v_cvt_pk_bf16_f32 v62, v196, v197
    v_cvt_pk_bf16_f32 v63, v198, v199
    s_waitcnt lgkmcnt(8)
    s_nop 0
    v_mfma_f32_32x32x16_bf16 v[128:143], v[224:227], v[60:63], v[128:143]
    ds_read_b64_tr_b16 v[224:225], v248 offset:1024
    ds_read_b64_tr_b16 v[226:227], v248 offset:1280
    s_cmp_ge_u32 s4, 4
    s_cbranch_scc1 L_nd23
    s_lshl_b32 s91, s7, 5
    s_add_u32 s91, s91, 0
    s_add_u32 m0, s11, 16480
    s_nop 0
    buffer_load_dwordx4 v243, s[72:75], s91 offen offset:32 lds
    s_lshl_b32 s91, s7, 5
    s_add_u32 s91, s91, 0
    s_add_u32 m0, s11, 20544
    s_nop 0
    buffer_load_dwordx4 v243, s[72:75], s91 offen offset:64 lds
L_nd23:
    v_lshlrev_b32 v192, 16, v64
    v_lshlrev_b32 v194, 16, v65
    v_lshlrev_b32 v196, 16, v66
    v_lshlrev_b32 v198, 16, v67
    v_and_b32 v193, 4294901760, v64
    v_mfma_f32_32x32x16_bf16 v[144:159], v[228:231], v[60:63], v[144:159]
    ds_read_b64_tr_b16 v[228:229], v248 offset:9216
    ds_read_b64_tr_b16 v[230:231], v248 offset:9472
    v_and_b32 v195, 4294901760, v65
    v_and_b32 v197, 4294901760, v66
    v_and_b32 v199, 4294901760, v67
    v_fma_f32 v192, v192, v246, -v245
    v_fma_f32 v194, v194, v246, -v245
    v_mfma_f32_32x32x16_bf16 v[160:175], v[232:235], v[60:63], v[160:175]
    ds_read_b64_tr_b16 v[232:233], v248 offset:17408
    ds_read_b64_tr_b16 v[234:235], v248 offset:17664
    v_fma_f32 v196, v196, v246, -v245
    v_fma_f32 v198, v198, v246, -v245
    v_fma_f32 v193, v193, v246, -v245
    v_fma_f32 v195, v195, v246, -v245
    v_fma_f32 v197, v197, v246, -v245
    v_mfma_f32_32x32x16_bf16 v[176:191], v[236:239], v[60:63], v[176:191]
    ds_read_b64_tr_b16 v[236:237], v248 offset:25600
    s_waitcnt lgkmcnt(14)
    ds_read_b64_tr_b16 v[238:239], v248 offset:25856
    v_fma_f32 v199, v199, v246, -v245
    v_cvt_pk_bf16_f32 v64, v192, v193
    v_cvt_pk_bf16_f32 v65, v194, v195
    v_cvt_pk_bf16_f32 v66, v196, v197
    v_cvt_pk_bf16_f32 v67, v198, v199
    s_waitcnt lgkmcnt(8)
    s_nop 0
    v_mfma_f32_32x32x16_bf16 v[128:143], v[208:211], v[64:67], v[128:143]
    ds_read_b64_tr_b16 v[208:209], v248 offset:2048
    ds_read_b64_tr_b16 v[210:211], v248 offset:2304
    v_lshlrev_b32 v192, 16, v68
    v_lshlrev_b32 v194, 16, v69
    v_lshlrev_b32 v196, 16, v70
    v_lshlrev_b32 v198, 16, v71
    v_and_b32 v193, 4294901760, v68
    v_mfma_f32_32x32x16_bf16 v[144:159], v[212:215], v[64:67], v[144:159]
    ds_read_b64_tr_b16 v[212:213], v248 offset:10240
    ds_read_b64_tr_b16 v[214:215], v248 offset:10496
    v_and_b32 v195, 4294901760, v69
    v_and_b32 v197, 4294901760, v70
    v_and_b32 v199, 4294901760, v71
    v_fma_f32 v192, v192, v246, -v245
    v_fma_f32 v194, v194, v246, -v245
    v_mfma_f32_32x32x16_bf16 v[160:175], v[216:219], v[64:67], v[160:175]
    ds_read_b64_tr_b16 v[216:217], v248 offset:18432
    ds_read_b64_tr_b16 v[218:219], v248 offset:18688
    v_fma_f32 v196, v196, v246, -v245
    v_fma_f32 v198, v198, v246, -v245
    v_fma_f32 v193, v193, v246, -v245
    v_fma_f32 v195, v195, v246, -v245
    v_fma_f32 v197, v197, v246, -v245
    v_mfma_f32_32x32x16_bf16 v[176:191], v[220:223], v[64:67], v[176:191]
    ds_read_b64_tr_b16 v[220:221], v248 offset:26624
    s_waitcnt lgkmcnt(14)
    ds_read_b64_tr_b16 v[222:223], v248 offset:26880
    v_fma_f32 v199, v199, v246, -v245
    v_cvt_pk_bf16_f32 v68, v192, v193
    v_cvt_pk_bf16_f32 v69, v194, v195
    v_cvt_pk_bf16_f32 v70, v196, v197
    v_cvt_pk_bf16_f32 v71, v198, v199
    s_waitcnt lgkmcnt(8)
    s_nop 0
    v_mfma_f32_32x32x16_bf16 v[128:143], v[224:227], v[68:71], v[128:143]
    ds_read_b64_tr_b16 v[224:225], v248 offset:3072
    ds_read_b64_tr_b16 v[226:227], v248 offset:3328
    v_lshlrev_b32 v192, 16, v72
    v_lshlrev_b32 v194, 16, v73
    v_lshlrev_b32 v196, 16, v74
    v_lshlrev_b32 v198, 16, v75
    v_and_b32 v193, 4294901760, v72
    v_mfma_f32_32x32x16_bf16 v[144:159], v[228:231], v[68:71], v[144:159]
    ds_read_b64_tr_b16 v[228:229], v248 offset:11264
    ds_read_b64_tr_b16 v[230:231], v248 offset:11520
    v_and_b32 v195, 4294901760, v73
    v_and_b32 v197, 4294901760, v74
    v_and_b32 v199, 4294901760, v75
    v_fma_f32 v192, v192, v246, -v245
    v_fma_f32 v194, v194, v246, -v245
    v_mfma_f32_32x32x16_bf16 v[160:175], v[232:235], v[68:71], v[160:175]
    ds_read_b64_tr_b16 v[232:233], v248 offset:19456
    ds_read_b64_tr_b16 v[234:235], v248 offset:19712
    v_fma_f32 v196, v196, v246, -v245
    v_fma_f32 v198, v198, v246, -v245
    v_fma_f32 v193, v193, v246, -v245
    v_fma_f32 v195, v195, v246, -v245
    v_fma_f32 v197, v197, v246, -v245
    v_mfma_f32_32x32x16_bf16 v[176:191], v[236:239], v[68:71], v[176:191]
    ds_read_b64_tr_b16 v[236:237], v248 offset:27648
    s_waitcnt lgkmcnt(14)
    ds_read_b64_tr_b16 v[238:239], v248 offset:27904
    v_fma_f32 v199, v199, v246, -v245
    v_cvt_pk_bf16_f32 v72, v192, v193
    v_cvt_pk_bf16_f32 v73, v194, v195
    v_cvt_pk_bf16_f32 v74, v196, v197
    v_cvt_pk_bf16_f32 v75, v198, v199
    s_waitcnt lgkmcnt(8)
    s_nop 0
    v_mfma_f32_32x32x16_bf16 v[128:143], v[208:211], v[72:75], v[128:143]
    ds_read_b64_tr_b16 v[208:209], v248 offset:4096
    ds_read_b64_tr_b16 v[210:211], v248 offset:4352
    v_lshlrev_b32 v192, 16, v76
    v_lshlrev_b32 v194, 16, v77
    v_lshlrev_b32 v196, 16, v78
    v_lshlrev_b32 v198, 16, v79
    v_and_b32 v193, 4294901760, v76
    v_mfma_f32_32x32x16_bf16 v[144:159], v[212:215], v[72:75], v[144:159]
    ds_read_b64_tr_b16 v[212:213], v248 offset:12288
    ds_read_b64_tr_b16 v[214:215], v248 offset:12544
    v_and_b32 v195, 4294901760, v77
    v_and_b32 v197, 4294901760, v78
    v_and_b32 v199, 4294901760, v79
    v_fma_f32 v192, v192, v246, -v245
    v_fma_f32 v194, v194, v246, -v245
    v_mfma_f32_32x32x16_bf16 v[160:175], v[216:219], v[72:75], v[160:175]
    ds_read_b64_tr_b16 v[216:217], v248 offset:20480
    ds_read_b64_tr_b16 v[218:219], v248 offset:20736
    v_fma_f32 v196, v196, v246, -v245
    v_fma_f32 v198, v198, v246, -v245
    v_fma_f32 v193, v193, v246, -v245
    v_fma_f32 v195, v195, v246, -v245
    v_fma_f32 v197, v197, v246, -v245
    v_mfma_f32_32x32x16_bf16 v[176:191], v[220:223], v[72:75], v[176:191]
    ds_read_b64_tr_b16 v[220:221], v248 offset:28672
    s_waitcnt lgkmcnt(14)
    ds_read_b64_tr_b16 v[222:223], v248 offset:28928
    v_fma_f32 v199, v199, v246, -v245
    v_cvt_pk_bf16_f32 v76, v192, v193
    v_cvt_pk_bf16_f32 v77, v194, v195
    v_cvt_pk_bf16_f32 v78, v196, v197
    v_cvt_pk_bf16_f32 v79, v198, v199
    s_waitcnt lgkmcnt(8)
    s_nop 0
    v_mfma_f32_32x32x16_bf16 v[128:143], v[224:227], v[76:79], v[128:143]
    ds_read_b64_tr_b16 v[224:225], v248 offset:5120
    ds_read_b64_tr_b16 v[226:227], v248 offset:5376
    v_lshlrev_b32 v192, 16, v80
    v_lshlrev_b32 v194, 16, v81
    v_lshlrev_b32 v196, 16, v82
    v_lshlrev_b32 v198, 16, v83
    v_and_b32 v193, 4294901760, v80
    v_mfma_f32_32x32x16_bf16 v[144:159], v[228:231], v[76:79], v[144:159]
    ds_read_b64_tr_b16 v[228:229], v248 offset:13312
    ds_read_b64_tr_b16 v[230:231], v248 offset:13568
    v_and_b32 v195, 4294901760, v81
    v_and_b32 v197, 4294901760, v82
    v_and_b32 v199, 4294901760, v83
    v_fma_f32 v192, v192, v246, -v245
    v_fma_f32 v194, v194, v246, -v245
    v_mfma_f32_32x32x16_bf16 v[160:175], v[232:235], v[76:79], v[160:175]
    ds_read_b64_tr_b16 v[232:233], v248 offset:21504
    ds_read_b64_tr_b16 v[234:235], v248 offset:21760
    v_fma_f32 v196, v196, v246, -v245
    v_fma_f32 v198, v198, v246, -v245
    v_fma_f32 v193, v193, v246, -v245
    v_fma_f32 v195, v195, v246, -v245
    v_fma_f32 v197, v197, v246, -v245
    v_mfma_f32_32x32x16_bf16 v[176:191], v[236:239], v[76:79], v[176:191]
    ds_read_b64_tr_b16 v[236:237], v248 offset:29696
    s_waitcnt lgkmcnt(14)
    ds_read_b64_tr_b16 v[238:239], v248 offset:29952
    v_fma_f32 v199, v199, v246, -v245
    v_cvt_pk_bf16_f32 v80, v192, v193
    v_cvt_pk_bf16_f32 v81, v194, v195
    v_cvt_pk_bf16_f32 v82, v196, v197
    v_cvt_pk_bf16_f32 v83, v198, v199
    s_waitcnt lgkmcnt(8)
    s_nop 0
    v_mfma_f32_32x32x16_bf16 v[128:143], v[208:211], v[80:83], v[128:143]
    ds_read_b64_tr_b16 v[208:209], v248 offset:6144
    ds_read_b64_tr_b16 v[210:211], v248 offset:6400
    v_lshlrev_b32 v192, 16, v84
    v_lshlrev_b32 v194, 16, v85
    v_lshlrev_b32 v196, 16, v86
    v_lshlrev_b32 v198, 16, v87
    v_and_b32 v193, 4294901760, v84
    v_mfma_f32_32x32x16_bf16 v[144:159], v[212:215], v[80:83], v[144:159]
    ds_read_b64_tr_b16 v[212:213], v248 offset:14336
    ds_read_b64_tr_b16 v[214:215], v248 offset:14592
    v_and_b32 v195, 4294901760, v85
    v_and_b32 v197, 4294901760, v86
    v_and_b32 v199, 4294901760, v87
    v_fma_f32 v192, v192, v246, -v245
    v_fma_f32 v194, v194, v246, -v245
    v_mfma_f32_32x32x16_bf16 v[160:175], v[216:219], v[80:83], v[160:175]
    ds_read_b64_tr_b16 v[216:217], v248 offset:22528
    ds_read_b64_tr_b16 v[218:219], v248 offset:22784
    v_fma_f32 v196, v196, v246, -v245
    v_fma_f32 v198, v198, v246, -v245
    v_fma_f32 v193, v193, v246, -v245
    v_fma_f32 v195, v195, v246, -v245
    v_fma_f32 v197, v197, v246, -v245
    v_mfma_f32_32x32x16_bf16 v[176:191], v[220:223], v[80:83], v[176:191]
    ds_read_b64_tr_b16 v[220:221], v248 offset:30720
    s_waitcnt lgkmcnt(14)
    ds_read_b64_tr_b16 v[222:223], v248 offset:30976
    v_fma_f32 v199, v199, v246, -v245
    v_cvt_pk_bf16_f32 v84, v192, v193
    v_cvt_pk_bf16_f32 v85, v194, v195
    v_cvt_pk_bf16_f32 v86, v196, v197
    v_cvt_pk_bf16_f32 v87, v198, v199
    s_waitcnt lgkmcnt(8)
    s_nop 0
    v_mfma_f32_32x32x16_bf16 v[128:143], v[224:227], v[84:87], v[128:143]
    ds_read_b64_tr_b16 v[224:225], v248 offset:7168
    ds_read_b64_tr_b16 v[226:227], v248 offset:7424
    v_lshlrev_b32 v192, 16, v88
    v_lshlrev_b32 v194, 16, v89
    v_lshlrev_b32 v196, 16, v90
    v_lshlrev_b32 v198, 16, v91
    v_and_b32 v193, 4294901760, v88
    v_mfma_f32_32x32x16_bf16 v[144:159], v[228:231], v[84:87], v[144:159]
    ds_read_b64_tr_b16 v[228:229], v248 offset:15360
    ds_read_b64_tr_b16 v[230:231], v248 offset:15616
    v_and_b32 v195, 4294901760, v89
    v_and_b32 v197, 4294901760, v90
    v_and_b32 v199, 4294901760, v91
    v_fma_f32 v192, v192, v246, -v245
    v_fma_f32 v194, v194, v246, -v245
    v_mfma_f32_32x32x16_bf16 v[160:175], v[232:235], v[84:87], v[160:175]
    ds_read_b64_tr_b16 v[232:233], v248 offset:23552
    ds_read_b64_tr_b16 v[234:235], v248 offset:23808
    v_fma_f32 v196, v196, v246, -v245
    v_fma_f32 v198, v198, v246, -v245
    v_fma_f32 v193, v193, v246, -v245
    v_fma_f32 v195, v195, v246, -v245
    v_fma_f32 v197, v197, v246, -v245
    v_mfma_f32_32x32x16_bf16 v[176:191], v[236:239], v[84:87], v[176:191]
    ds_read_b64_tr_b16 v[236:237], v248 offset:31744
    s_waitcnt lgkmcnt(14)
    ds_read_b64_tr_b16 v[238:239], v248 offset:32000
    v_fma_f32 v199, v199, v246, -v245
    v_cvt_pk_bf16_f32 v88, v192, v193
    v_cvt_pk_bf16_f32 v89, v194, v195
    v_cvt_pk_bf16_f32 v90, v196, v197
    v_cvt_pk_bf16_f32 v91, v198, v199
    s_waitcnt lgkmcnt(8)
    s_nop 0
    v_mfma_f32_32x32x16_bf16 v[128:143], v[208:211], v[88:91], v[128:143]
    s_waitcnt vmcnt(6)
    s_barrier
    ds_read_b64_tr_b16 v[208:209], v248 offset:32768
    ds_read_b64_tr_b16 v[210:211], v248 offset:33024
    s_cmp_ge_u32 s4, 4
    s_cbranch_scc1 L_nd24
    s_lshl_b32 s91, s7, 5
    s_add_u32 s91, s91, 352256
    s_add_u32 m0, s11, 32768
    s_nop 0
    buffer_load_dwordx4 v243, s[64:67], s91 offen lds
    s_lshl_b32 s91, s7, 5
    s_add_u32 s91, s91, 352256
    s_add_u32 m0, s11, 36832
    s_nop 0
    buffer_load_dwordx4 v243, s[64:67], s91 offen offset:32 lds
L_nd24:
    v_lshlrev_b32 v192, 16, v92
    v_lshlrev_b32 v194, 16, v93
    v_lshlrev_b32 v196, 16, v94
    v_lshlrev_b32 v198, 16, v95
    v_and_b32 v193, 4294901760, v92
    v_mfma_f32_32x32x16_bf16 v[144:159], v[212:215], v[88:91], v[144:159]
    ds_read_b64_tr_b16 v[212:213], v248 offset:40960
    ds_read_b64_tr_b16 v[214:215], v248 offset:41216
    v_and_b32 v195, 4294901760, v93
    v_and_b32 v197, 4294901760, v94
    v_and_b32 v199, 4294901760, v95
    v_fma_f32 v192, v192, v246, -v245
    v_fma_f32 v194, v194, v246, -v245
    v_mfma_f32_32x32x16_bf16 v[160:175], v[216:219], v[88:91], v[160:175]
    ds_read_b64_tr_b16 v[216:217], v248 offset:49152
    ds_read_b64_tr_b16 v[218:219], v248 offset:49408
    s_cmp_ge_u32 s4, 4
    s_cbranch_scc1 L_nd25
    s_lshl_b32 s91, s7, 5
    s_add_u32 s91, s91, 352256
    s_add_u32 m0, s11, 40896
    s_nop 0
    buffer_load_dwordx4 v243, s[64:67], s91 offen offset:64 lds
    s_lshl_b32 s91, s7, 5
    s_add_u32 s91, s91, 352256
    s_add_u32 m0, s11, 45184
    s_nop 0
    buffer_load_dwordx4 v243, s[72:75], s91 offen lds
L_nd25:
    v_fma_f32 v196, v196, v246, -v245
    v_fma_f32 v198, v198, v246, -v245
    v_fma_f32 v193, v193, v246, -v245
    v_fma_f32 v195, v195, v246, -v245
    v_fma_f32 v197, v197, v246, -v245
    v_mfma_f32_32x32x16_bf16 v[176:191], v[220:223], v[88:91], v[176:191]
    ds_read_b64_tr_b16 v[220:221], v248 offset:57344
    s_waitcnt lgkmcnt(14)
    ds_read_b64_tr_b16 v[222:223], v248 offset:57600
    v_fma_f32 v199, v199, v246, -v245
    v_cvt_pk_bf16_f32 v92, v192, v193
    v_cvt_pk_bf16_f32 v93, v194, v195
    v_cvt_pk_bf16_f32 v94, v196, v197
    v_cvt_pk_bf16_f32 v95, v198, v199
    s_waitcnt lgkmcnt(8)
    s_nop 0
    v_mfma_f32_32x32x16_bf16 v[128:143], v[224:227], v[92:95], v[128:143]
    ds_read_b64_tr_b16 v[224:225], v248 offset:33792
    ds_read_b64_tr_b16 v[226:227], v248 offset:34048
    s_cmp_ge_u32 s4, 4
    s_cbranch_scc1 L_nd26
    s_lshl_b32 s91, s7, 5
    s_add_u32 s91, s91, 352256
    s_add_u32 m0, s11, 49248
    s_nop 0
    buffer_load_dwordx4 v243, s[72:75], s91 offen offset:32 lds
    s_lshl_b32 s91, s7, 5
    s_add_u32 s91, s91, 352256
    s_add_u32 m0, s11, 53312
    s_nop 0
    buffer_load_dwordx4 v243, s[72:75], s91 offen offset:64 lds
L_nd26:
    v_lshlrev_b32 v192, 16, v96
    v_lshlrev_b32 v194, 16, v97
    v_lshlrev_b32 v196, 16, v98
    v_lshlrev_b32 v198, 16, v99
    v_and_b32 v193, 4294901760, v96
    v_mfma_f32_32x32x16_bf16 v[144:159], v[228:231], v[92:95], v[144:159]
    ds_read_b64_tr_b16 v[228:229], v248 offset:41984
    ds_read_b64_tr_b16 v[230:231], v248 offset:42240
    v_and_b32 v195, 4294901760, v97
    v_and_b32 v197, 4294901760, v98
    v_and_b32 v199, 4294901760, v99
    v_fma_f32 v192, v192, v246, -v245
    v_fma_f32 v194, v194, v246, -v245
    v_mfma_f32_32x32x16_bf16 v[160:175], v[232:235], v[92:95], v[160:175]
    ds_read_b64_tr_b16 v[232:233], v248 offset:50176
    ds_read_b64_tr_b16 v[234:235], v248 offset:50432
    v_fma_f32 v196, v196, v246, -v245
    v_fma_f32 v198, v198, v246, -v245
    v_fma_f32 v193, v193, v246, -v245
    v_fma_f32 v195, v195, v246, -v245
    v_fma_f32 v197, v197, v246, -v245
    v_mfma_f32_32x32x16_bf16 v[176:191], v[236:239], v[92:95], v[176:191]
    ds_read_b64_tr_b16 v[236:237], v248 offset:58368
    s_waitcnt lgkmcnt(14)
    ds_read_b64_tr_b16 v[238:239], v248 offset:58624
    v_fma_f32 v199, v199, v246, -v245
    v_cvt_pk_bf16_f32 v96, v192, v193
    v_cvt_pk_bf16_f32 v97, v194, v195
    v_cvt_pk_bf16_f32 v98, v196, v197
    v_cvt_pk_bf16_f32 v99, v198, v199
    s_waitcnt lgkmcnt(8)
    s_nop 0
    v_mfma_f32_32x32x16_bf16 v[128:143], v[208:211], v[96:99], v[128:143]
    ds_read_b64_tr_b16 v[208:209], v248 offset:34816
    ds_read_b64_tr_b16 v[210:211], v248 offset:35072
    v_lshlrev_b32 v192, 16, v100
    v_lshlrev_b32 v194, 16, v101
    v_lshlrev_b32 v196, 16, v102
    v_lshlrev_b32 v198, 16, v103
    v_and_b32 v193, 4294901760, v100
    v_mfma_f32_32x32x16_bf16 v[144:159], v[212:215], v[96:99], v[144:159]
    ds_read_b64_tr_b16 v[212:213], v248 offset:43008
    ds_read_b64_tr_b16 v[214:215], v248 offset:43264
    v_and_b32 v195, 4294901760, v101
    v_and_b32 v197, 4294901760, v102
    v_and_b32 v199, 4294901760, v103
    v_fma_f32 v192, v192, v246, -v245
    v_fma_f32 v194, v194, v246, -v245
    v_mfma_f32_32x32x16_bf16 v[160:175], v[216:219], v[96:99], v[160:175]
    ds_read_b64_tr_b16 v[216:217], v248 offset:51200
    ds_read_b64_tr_b16 v[218:219], v248 offset:51456
    v_fma_f32 v196, v196, v246, -v245
    v_fma_f32 v198, v198, v246, -v245
    v_fma_f32 v193, v193, v246, -v245
    v_fma_f32 v195, v195, v246, -v245
    v_fma_f32 v197, v197, v246, -v245
    v_mfma_f32_32x32x16_bf16 v[176:191], v[220:223], v[96:99], v[176:191]
    ds_read_b64_tr_b16 v[220:221], v248 offset:59392
    s_waitcnt lgkmcnt(14)
    ds_read_b64_tr_b16 v[222:223], v248 offset:59648
    v_fma_f32 v199, v199, v246, -v245
    v_cvt_pk_bf16_f32 v100, v192, v193
    v_cvt_pk_bf16_f32 v101, v194, v195
    v_cvt_pk_bf16_f32 v102, v196, v197
    v_cvt_pk_bf16_f32 v103, v198, v199
    s_waitcnt lgkmcnt(8)
    s_nop 0
    v_mfma_f32_32x32x16_bf16 v[128:143], v[224:227], v[100:103], v[128:143]
    ds_read_b64_tr_b16 v[224:225], v248 offset:35840
    ds_read_b64_tr_b16 v[226:227], v248 offset:36096
    v_lshlrev_b32 v192, 16, v104
    v_lshlrev_b32 v194, 16, v105
    v_lshlrev_b32 v196, 16, v106
    v_lshlrev_b32 v198, 16, v107
    v_and_b32 v193, 4294901760, v104
    v_mfma_f32_32x32x16_bf16 v[144:159], v[228:231], v[100:103], v[144:159]
    ds_read_b64_tr_b16 v[228:229], v248 offset:44032
    ds_read_b64_tr_b16 v[230:231], v248 offset:44288
    v_and_b32 v195, 4294901760, v105
    v_and_b32 v197, 4294901760, v106
    v_and_b32 v199, 4294901760, v107
    v_fma_f32 v192, v192, v246, -v245
    v_fma_f32 v194, v194, v246, -v245
    v_mfma_f32_32x32x16_bf16 v[160:175], v[232:235], v[100:103], v[160:175]
    ds_read_b64_tr_b16 v[232:233], v248 offset:52224
    ds_read_b64_tr_b16 v[234:235], v248 offset:52480
    v_fma_f32 v196, v196, v246, -v245
    v_fma_f32 v198, v198, v246, -v245
    v_fma_f32 v193, v193, v246, -v245
    v_fma_f32 v195, v195, v246, -v245
    v_fma_f32 v197, v197, v246, -v245
    v_mfma_f32_32x32x16_bf16 v[176:191], v[236:239], v[100:103], v[176:191]
    ds_read_b64_tr_b16 v[236:237], v248 offset:60416
    s_waitcnt lgkmcnt(14)
    ds_read_b64_tr_b16 v[238:239], v248 offset:60672
    v_fma_f32 v199, v199, v246, -v245
    v_cvt_pk_bf16_f32 v104, v192, v193
    v_cvt_pk_bf16_f32 v105, v194, v195
    v_cvt_pk_bf16_f32 v106, v196, v197
    v_cvt_pk_bf16_f32 v107, v198, v199
    s_waitcnt lgkmcnt(8)
    s_nop 0
    v_mfma_f32_32x32x16_bf16 v[128:143], v[208:211], v[104:107], v[128:143]
    ds_read_b64_tr_b16 v[208:209], v248 offset:36864
    ds_read_b64_tr_b16 v[210:211], v248 offset:37120
    v_lshlrev_b32 v192, 16, v108
    v_lshlrev_b32 v194, 16, v109
    v_lshlrev_b32 v196, 16, v110
    v_lshlrev_b32 v198, 16, v111
    v_and_b32 v193, 4294901760, v108
    v_mfma_f32_32x32x16_bf16 v[144:159], v[212:215], v[104:107], v[144:159]
    ds_read_b64_tr_b16 v[212:213], v248 offset:45056
    ds_read_b64_tr_b16 v[214:215], v248 offset:45312
    v_and_b32 v195, 4294901760, v109
    v_and_b32 v197, 4294901760, v110
    v_and_b32 v199, 4294901760, v111
    v_fma_f32 v192, v192, v246, -v245
    v_fma_f32 v194, v194, v246, -v245
    v_mfma_f32_32x32x16_bf16 v[160:175], v[216:219], v[104:107], v[160:175]
    ds_read_b64_tr_b16 v[216:217], v248 offset:53248
    ds_read_b64_tr_b16 v[218:219], v248 offset:53504
    v_fma_f32 v196, v196, v246, -v245
    v_fma_f32 v198, v198, v246, -v245
    v_fma_f32 v193, v193, v246, -v245
    v_fma_f32 v195, v195, v246, -v245
    v_fma_f32 v197, v197, v246, -v245
    v_mfma_f32_32x32x16_bf16 v[176:191], v[220:223], v[104:107], v[176:191]
    ds_read_b64_tr_b16 v[220:221], v248 offset:61440
    s_waitcnt lgkmcnt(14)
    ds_read_b64_tr_b16 v[222:223], v248 offset:61696
    v_fma_f32 v199, v199, v246, -v245
    v_cvt_pk_bf16_f32 v108, v192, v193
    v_cvt_pk_bf16_f32 v109, v194, v195
    v_cvt_pk_bf16_f32 v110, v196, v197
    v_cvt_pk_bf16_f32 v111, v198, v199
    s_waitcnt lgkmcnt(8)
    s_nop 0
    v_mfma_f32_32x32x16_bf16 v[128:143], v[224:227], v[108:111], v[128:143]
    ds_read_b64_tr_b16 v[224:225], v248 offset:37888
    ds_read_b64_tr_b16 v[226:227], v248 offset:38144
    v_lshlrev_b32 v192, 16, v112
    v_lshlrev_b32 v194, 16, v113
    v_lshlrev_b32 v196, 16, v114
    v_lshlrev_b32 v198, 16, v115
    v_and_b32 v193, 4294901760, v112
    v_mfma_f32_32x32x16_bf16 v[144:159], v[228:231], v[108:111], v[144:159]
    ds_read_b64_tr_b16 v[228:229], v248 offset:46080
    ds_read_b64_tr_b16 v[230:231], v248 offset:46336
    v_and_b32 v195, 4294901760, v113
    v_and_b32 v197, 4294901760, v114
    v_and_b32 v199, 4294901760, v115
    v_fma_f32 v192, v192, v246, -v245
    v_fma_f32 v194, v194, v246, -v245
    v_mfma_f32_32x32x16_bf16 v[160:175], v[232:235], v[108:111], v[160:175]
    ds_read_b64_tr_b16 v[232:233], v248 offset:54272
    ds_read_b64_tr_b16 v[234:235], v248 offset:54528
    v_fma_f32 v196, v196, v246, -v245
    v_fma_f32 v198, v198, v246, -v245
    v_fma_f32 v193, v193, v246, -v245
    v_fma_f32 v195, v195, v246, -v245
    v_fma_f32 v197, v197, v246, -v245
    v_lshrrev_b32 v252, 5, v240
    v_mul_u32_u24 v252, 4, v252
    v_bfe_u32 v253, v240, 2, 2
    v_add_u32 v252, v252, v253
    v_mul_u32_u24 v252, 1024, v252
    v_bfe_u32 v253, v240, 4, 1
    v_mul_u32_u24 v253, 32, v253
    v_add_u32 v252, v252, v253
    v_and_b32 v253, 3, v240
    v_lshl_add_u32 v200, v253, 3, v252
    s_lshl_b32 s8, s4, 7
    s_add_u32 s8, s8, 131072
    v_add_u32 v200, s8, v200
    s_mul_i32 s8, s4, 700416
    s_lshl_b32 s9, s2, 10
    s_add_u32 s8, s8, s9
    s_add_u32 s8, s8, 33554432
    s_add_u32 s9, s8, 350208
    ds_read_b64_tr_b16 v[204:205], v200
    s_waitcnt lgkmcnt(14)
    ds_read_b64_tr_b16 v[206:207], v200 offset:8192
    s_waitcnt lgkmcnt(0)
    buffer_store_dwordx4 v[204:207], v241, s[60:63], s8 offen
    s_nop 1
    ds_read_b64_tr_b16 v[204:205], v200 offset:64
    ds_read_b64_tr_b16 v[206:207], v200 offset:8256
    s_waitcnt lgkmcnt(0)
    buffer_store_dwordx4 v[204:207], v241, s[60:63], s9 offen
    s_add_u32 s8, s8, 262144
    s_add_u32 s9, s9, 262144
    s_cmp_ge_u32 s2, 86
    s_cselect_b32 s8, 1073741824, s8
    s_cselect_b32 s9, 1073741824, s9
    ds_read_b64_tr_b16 v[204:205], v200 offset:16384
    ds_read_b64_tr_b16 v[206:207], v200 offset:24576
    s_waitcnt lgkmcnt(0)
    buffer_store_dwordx4 v[204:207], v241, s[60:63], s8 offen
    s_nop 1
    ds_read_b64_tr_b16 v[204:205], v200 offset:16448
    ds_read_b64_tr_b16 v[206:207], v200 offset:24640
    s_waitcnt lgkmcnt(0)
    buffer_store_dwordx4 v[204:207], v241, s[60:63], s9 offen
    v_mfma_f32_32x32x16_bf16 v[176:191], v[236:239], v[108:111], v[176:191]
    ds_read_b64_tr_b16 v[236:237], v248 offset:62464
    ds_read_b64_tr_b16 v[238:239], v248 offset:62720
    v_fma_f32 v199, v199, v246, -v245
    v_cvt_pk_bf16_f32 v112, v192, v193
    v_cvt_pk_bf16_f32 v113, v194, v195
    v_cvt_pk_bf16_f32 v114, v196, v197
    v_cvt_pk_bf16_f32 v115, v198, v199
    s_nop 1
    v_mfma_f32_32x32x16_bf16 v[128:143], v[208:211], v[112:115], v[128:143]
    ds_read_b64_tr_b16 v[208:209], v248 offset:38912
    ds_read_b64_tr_b16 v[210:211], v248 offset:39168
    v_lshlrev_b32 v192, 16, v116
    v_lshlrev_b32 v194, 16, v117
    v_lshlrev_b32 v196, 16, v118
    v_lshlrev_b32 v198, 16, v119
    v_and_b32 v193, 4294901760, v116
    v_mfma_f32_32x32x16_bf16 v[144:159], v[212:215], v[112:115], v[144:159]
    ds_read_b64_tr_b16 v[212:213], v248 offset:47104
    ds_read_b64_tr_b16 v[214:215], v248 offset:47360
    v_and_b32 v195, 4294901760, v117
    v_and_b32 v197, 4294901760, v118
    v_and_b32 v199, 4294901760, v119
    v_fma_f32 v192, v192, v246, -v245
    v_fma_f32 v194, v194, v246, -v245
    v_mfma_f32_32x32x16_bf16 v[160:175], v[216:219], v[112:115], v[160:175]
    ds_read_b64_tr_b16 v[216:217], v248 offset:55296
    ds_read_b64_tr_b16 v[218:219], v248 offset:55552
    v_fma_f32 v196, v196, v246, -v245
    v_fma_f32 v198, v198, v246, -v245
    v_fma_f32 v193, v193, v246, -v245
    v_fma_f32 v195, v195, v246, -v245
    v_fma_f32 v197, v197, v246, -v245
    v_mfma_f32_32x32x16_bf16 v[176:191], v[220:223], v[112:115], v[176:191]
    ds_read_b64_tr_b16 v[220:221], v248 offset:63488
    ds_read_b64_tr_b16 v[222:223], v248 offset:63744
    v_fma_f32 v199, v199, v246, -v245
    v_cvt_pk_bf16_f32 v116, v192, v193
    v_cvt_pk_bf16_f32 v117, v194, v195
    v_cvt_pk_bf16_f32 v118, v196, v197
    v_cvt_pk_bf16_f32 v119, v198, v199
    s_waitcnt lgkmcnt(8)
    s_nop 0
    v_mfma_f32_32x32x16_bf16 v[128:143], v[224:227], v[116:119], v[128:143]
    ds_read_b64_tr_b16 v[224:225], v248 offset:39936
    ds_read_b64_tr_b16 v[226:227], v248 offset:40192
    v_lshlrev_b32 v192, 16, v120
    v_lshlrev_b32 v194, 16, v121
    v_lshlrev_b32 v196, 16, v122
    v_lshlrev_b32 v198, 16, v123
    v_and_b32 v193, 4294901760, v120
    v_mfma_f32_32x32x16_bf16 v[144:159], v[228:231], v[116:119], v[144:159]
    ds_read_b64_tr_b16 v[228:229], v248 offset:48128
    ds_read_b64_tr_b16 v[230:231], v248 offset:48384
    v_and_b32 v195, 4294901760, v121
    v_and_b32 v197, 4294901760, v122
    v_and_b32 v199, 4294901760, v123
    v_fma_f32 v192, v192, v246, -v245
    v_fma_f32 v194, v194, v246, -v245
    v_mfma_f32_32x32x16_bf16 v[160:175], v[232:235], v[116:119], v[160:175]
    ds_read_b64_tr_b16 v[232:233], v248 offset:56320
    ds_read_b64_tr_b16 v[234:235], v248 offset:56576
    v_fma_f32 v196, v196, v246, -v245
    v_fma_f32 v198, v198, v246, -v245
    v_fma_f32 v193, v193, v246, -v245
    v_fma_f32 v195, v195, v246, -v245
    v_fma_f32 v197, v197, v246, -v245
    v_mfma_f32_32x32x16_bf16 v[176:191], v[236:239], v[116:119], v[176:191]
    ds_read_b64_tr_b16 v[236:237], v248 offset:64512
    s_waitcnt lgkmcnt(14)
    ds_read_b64_tr_b16 v[238:239], v248 offset:64768
    v_fma_f32 v199, v199, v246, -v245
    v_cvt_pk_bf16_f32 v120, v192, v193
    v_cvt_pk_bf16_f32 v121, v194, v195
    v_cvt_pk_bf16_f32 v122, v196, v197
    v_cvt_pk_bf16_f32 v123, v198, v199
    s_waitcnt lgkmcnt(8)
    s_nop 0
    v_mfma_f32_32x32x16_bf16 v[128:143], v[208:211], v[120:123], v[128:143]
    s_waitcnt vmcnt(10)
    s_barrier
    ds_read_b64_tr_b16 v[208:209], v249
    ds_read_b64_tr_b16 v[210:211], v249 offset:128
    s_cmp_ge_u32 s4, 4
    s_cbranch_scc1 L_nd27
    s_lshl_b32 s91, s7, 5
    s_add_u32 s91, s91, 704512
    s_add_u32 m0, s11, 65536
    s_nop 0
    buffer_load_dwordx4 v243, s[64:67], s91 offen lds
    s_lshl_b32 s91, s7, 5
    s_add_u32 s91, s91, 704512
    s_add_u32 m0, s11, 69600
    s_nop 0
    buffer_load_dwordx4 v243, s[64:67], s91 offen offset:32 lds
L_nd27:
    v_lshlrev_b32 v192, 16, v124
    v_lshlrev_b32 v194, 16, v125
    v_lshlrev_b32 v196, 16, v126
    v_lshlrev_b32 v198, 16, v127
    v_and_b32 v193, 4294901760, v124
    v_mfma_f32_32x32x16_bf16 v[144:159], v[212:215], v[120:123], v[144:159]
    ds_read_b64_tr_b16 v[212:213], v249 offset:4096
    ds_read_b64_tr_b16 v[214:215], v249 offset:4224
    v_and_b32 v195, 4294901760, v125
    v_and_b32 v197, 4294901760, v126
    v_and_b32 v199, 4294901760, v127
    v_fma_f32 v192, v192, v246, -v245
    v_fma_f32 v194, v194, v246, -v245
    v_mfma_f32_32x32x16_bf16 v[160:175], v[216:219], v[120:123], v[160:175]
    ds_read_b64_tr_b16 v[216:217], v249 offset:8192
    ds_read_b64_tr_b16 v[218:219], v249 offset:8320
    s_cmp_ge_u32 s4, 4
    s_cbranch_scc1 L_nd28
    s_lshl_b32 s91, s7, 5
    s_add_u32 s91, s91, 704512
    s_add_u32 m0, s11, 73664
    s_nop 0
    buffer_load_dwordx4 v243, s[64:67], s91 offen offset:64 lds
    s_lshl_b32 s91, s7, 5
    s_add_u32 s91, s91, 704512
    s_add_u32 m0, s11, 77952
    s_nop 0
    buffer_load_dwordx4 v243, s[72:75], s91 offen lds
L_nd28:
    v_fma_f32 v196, v196, v246, -v245
    v_fma_f32 v198, v198, v246, -v245
    v_fma_f32 v193, v193, v246, -v245
    v_fma_f32 v195, v195, v246, -v245
    v_fma_f32 v197, v197, v246, -v245
    v_mfma_f32_32x32x16_bf16 v[176:191], v[220:223], v[120:123], v[176:191]
    ds_read_b64_tr_b16 v[220:221], v249 offset:512
    s_waitcnt lgkmcnt(14)
    ds_read_b64_tr_b16 v[222:223], v249 offset:640
    v_fma_f32 v199, v199, v246, -v245
    v_cvt_pk_bf16_f32 v124, v192, v193
    v_cvt_pk_bf16_f32 v125, v194, v195
    v_cvt_pk_bf16_f32 v126, v196, v197
    v_cvt_pk_bf16_f32 v127, v198, v199
    s_waitcnt lgkmcnt(8)
    s_nop 0
    v_mfma_f32_32x32x16_bf16 v[128:143], v[224:227], v[124:127], v[128:143]
    ds_read_b64_tr_b16 v[224:225], v249 offset:4608
    ds_read_b64_tr_b16 v[226:227], v249 offset:4736
    s_cmp_ge_u32 s4, 4
    s_cbranch_scc1 L_nd29
    s_lshl_b32 s91, s7, 5
    s_add_u32 s91, s91, 704512
    s_add_u32 m0, s11, 82016
    s_nop 0
    buffer_load_dwordx4 v243, s[72:75], s91 offen offset:32 lds
    s_lshl_b32 s91, s7, 5
    s_add_u32 s91, s91, 704512
    s_add_u32 m0, s11, 86080
    s_nop 0
    buffer_load_dwordx4 v243, s[72:75], s91 offen offset:64 lds
L_nd29:
    v_mfma_f32_32x32x16_bf16 v[144:159], v[228:231], v[124:127], v[144:159]
    ds_read_b64_tr_b16 v[228:229], v249 offset:8704
    ds_read_b64_tr_b16 v[230:231], v249 offset:8832
    v_mfma_f32_32x32x16_bf16 v[160:175], v[232:235], v[124:127], v[160:175]
    ds_read_b64_tr_b16 v[232:233], v249 offset:1024
    ds_read_b64_tr_b16 v[234:235], v249 offset:1152
    v_mfma_f32_32x32x16_bf16 v[176:191], v[236:239], v[124:127], v[176:191]
    ds_read_b64_tr_b16 v[236:237], v249 offset:5120
    s_waitcnt lgkmcnt(14)
    ds_read_b64_tr_b16 v[238:239], v249 offset:5248
    v_mul_f32 v128, s13, v128
    v_mul_f32 v129, s13, v129
    v_mul_f32 v130, s13, v130
    v_mul_f32 v131, s13, v131
    v_mul_f32 v132, s13, v132
    v_mul_f32 v133, s13, v133
    v_mul_f32 v134, s13, v134
    v_mul_f32 v135, s13, v135
    v_mul_f32 v136, s13, v136
    v_mul_f32 v137, s13, v137
    v_mul_f32 v138, s13, v138
    v_mul_f32 v139, s13, v139
    v_mul_f32 v140, s13, v140
    v_mul_f32 v141, s13, v141
    v_mul_f32 v142, s13, v142
    v_mul_f32 v143, s13, v143
    v_mul_f32 v144, s13, v144
    v_mul_f32 v145, s13, v145
    v_mul_f32 v146, s13, v146
    v_mul_f32 v147, s13, v147
    v_mul_f32 v148, s13, v148
    v_mul_f32 v149, s13, v149
    v_mul_f32 v150, s13, v150
    v_mul_f32 v151, s13, v151
    v_mul_f32 v152, s13, v152
    v_mul_f32 v153, s13, v153
    v_mul_f32 v154, s13, v154
    v_mul_f32 v155, s13, v155
    v_mul_f32 v156, s13, v156
    v_mul_f32 v157, s13, v157
    v_mul_f32 v158, s13, v158
    v_mul_f32 v159, s13, v159
    v_mul_f32 v160, s13, v160
    v_mul_f32 v161, s13, v161
    v_mul_f32 v162, s13, v162
    v_mul_f32 v163, s13, v163
    v_mul_f32 v164, s13, v164
    v_mul_f32 v165, s13, v165
    v_mul_f32 v166, s13, v166
    v_mul_f32 v167, s13, v167
    v_mul_f32 v168, s13, v168
    v_mul_f32 v169, s13, v169
    v_mul_f32 v170, s13, v170
    v_mul_f32 v171, s13, v171
    v_mul_f32 v172, s13, v172
    v_mul_f32 v173, s13, v173
    v_mul_f32 v174, s13, v174
    v_mul_f32 v175, s13, v175
    v_mul_f32 v176, s13, v176
    v_mul_f32 v177, s13, v177
    v_mul_f32 v178, s13, v178
    v_mul_f32 v179, s13, v179
    v_mul_f32 v180, s13, v180
    v_mul_f32 v181, s13, v181
    v_mul_f32 v182, s13, v182
    v_mul_f32 v183, s13, v183
    v_mul_f32 v184, s13, v184
    v_mul_f32 v185, s13, v185
    v_mul_f32 v186, s13, v186
    v_mul_f32 v187, s13, v187
    v_mul_f32 v188, s13, v188
    v_mul_f32 v189, s13, v189
    v_mul_f32 v190, s13, v190
    v_mul_f32 v191, s13, v191
    v_cvt_pk_bf16_f32 v128, v128, v129
    v_cvt_pk_bf16_f32 v129, v130, v131
    v_cvt_pk_bf16_f32 v130, v132, v133
    v_cvt_pk_bf16_f32 v131, v134, v135
    v_cvt_pk_bf16_f32 v132, v136, v137
    v_cvt_pk_bf16_f32 v133, v138, v139
    v_cvt_pk_bf16_f32 v134, v140, v141
    v_cvt_pk_bf16_f32 v135, v142, v143
    v_cvt_pk_bf16_f32 v136, v144, v145
    v_cvt_pk_bf16_f32 v137, v146, v147
    v_cvt_pk_bf16_f32 v138, v148, v149
    v_cvt_pk_bf16_f32 v139, v150, v151
    v_cvt_pk_bf16_f32 v140, v152, v153
    v_cvt_pk_bf16_f32 v141, v154, v155
    v_cvt_pk_bf16_f32 v142, v156, v157
    v_cvt_pk_bf16_f32 v143, v158, v159
    v_cvt_pk_bf16_f32 v144, v160, v161
    v_cvt_pk_bf16_f32 v145, v162, v163
    v_cvt_pk_bf16_f32 v146, v164, v165
    v_cvt_pk_bf16_f32 v147, v166, v167
    v_cvt_pk_bf16_f32 v148, v168, v169
    v_cvt_pk_bf16_f32 v149, v170, v171
    v_cvt_pk_bf16_f32 v150, v172, v173
    v_cvt_pk_bf16_f32 v151, v174, v175
    v_cvt_pk_bf16_f32 v152, v176, v177
    v_cvt_pk_bf16_f32 v153, v178, v179
    v_cvt_pk_bf16_f32 v154, v180, v181
    v_cvt_pk_bf16_f32 v155, v182, v183
    v_cvt_pk_bf16_f32 v156, v184, v185
    v_cvt_pk_bf16_f32 v157, v186, v187
    v_cvt_pk_bf16_f32 v158, v188, v189
    v_cvt_pk_bf16_f32 v159, v190, v191
    v_permlane32_swap_b32 v128, v130
    v_permlane32_swap_b32 v129, v131
    v_permlane32_swap_b32 v132, v134
    v_permlane32_swap_b32 v133, v135
    v_permlane32_swap_b32 v136, v138
    v_permlane32_swap_b32 v137, v139
    v_permlane32_swap_b32 v140, v142
    v_permlane32_swap_b32 v141, v143
    v_permlane32_swap_b32 v144, v146
    v_permlane32_swap_b32 v145, v147
    v_permlane32_swap_b32 v148, v150
    v_permlane32_swap_b32 v149, v151
    v_permlane32_swap_b32 v152, v154
    v_permlane32_swap_b32 v153, v155
    v_permlane32_swap_b32 v156, v158
    v_permlane32_swap_b32 v157, v159
    s_waitcnt lgkmcnt(8)
    v_mfma_f32_32x32x16_bf16 v[160:175], v[208:211], v[0:3], 0
    ds_read_b64_tr_b16 v[208:209], v249 offset:9216
    ds_read_b64_tr_b16 v[210:211], v249 offset:9344
    v_mfma_f32_32x32x16_bf16 v[176:191], v[212:215], v[0:3], 0
    ds_read_b64_tr_b16 v[212:213], v249 offset:1536
    ds_read_b64_tr_b16 v[214:215], v249 offset:1664
    v_mfma_f32_32x32x16_bf16 v[192:207], v[216:219], v[0:3], 0
    ds_read_b64_tr_b16 v[216:217], v249 offset:5632
    ds_read_b64_tr_b16 v[218:219], v249 offset:5760
    v_mfma_f32_32x32x16_bf16 v[160:175], v[220:223], v[4:7], v[160:175]
    ds_read_b64_tr_b16 v[220:221], v249 offset:9728
    s_waitcnt lgkmcnt(14)
    ds_read_b64_tr_b16 v[222:223], v249 offset:9856
    s_waitcnt lgkmcnt(8)
    v_mfma_f32_32x32x16_bf16 v[176:191], v[224:227], v[4:7], v[176:191]
    ds_read_b64_tr_b16 v[224:225], v249 offset:2048
    ds_read_b64_tr_b16 v[226:227], v249 offset:2176
    v_mfma_f32_32x32x16_bf16 v[192:207], v[228:231], v[4:7], v[192:207]
    ds_read_b64_tr_b16 v[228:229], v249 offset:6144
    ds_read_b64_tr_b16 v[230:231], v249 offset:6272
    v_mfma_f32_32x32x16_bf16 v[160:175], v[232:235], v[8:11], v[160:175]
    ds_read_b64_tr_b16 v[232:233], v249 offset:10240
    ds_read_b64_tr_b16 v[234:235], v249 offset:10368
    v_mfma_f32_32x32x16_bf16 v[176:191], v[236:239], v[8:11], v[176:191]
    ds_read_b64_tr_b16 v[236:237], v249 offset:2560
    s_waitcnt lgkmcnt(14)
    ds_read_b64_tr_b16 v[238:239], v249 offset:2688
    s_waitcnt lgkmcnt(8)
    v_mfma_f32_32x32x16_bf16 v[192:207], v[208:211], v[8:11], v[192:207]
    ds_read_b64_tr_b16 v[208:209], v249 offset:6656
    ds_read_b64_tr_b16 v[210:211], v249 offset:6784
    v_mfma_f32_32x32x16_bf16 v[160:175], v[212:215], v[12:15], v[160:175]
    ds_read_b64_tr_b16 v[212:213], v249 offset:10752
    ds_read_b64_tr_b16 v[214:215], v249 offset:10880
    v_mfma_f32_32x32x16_bf16 v[176:191], v[216:219], v[12:15], v[176:191]
    ds_read_b64_tr_b16 v[216:217], v249 offset:3072
    ds_read_b64_tr_b16 v[218:219], v249 offset:3200
    v_mfma_f32_32x32x16_bf16 v[192:207], v[220:223], v[12:15], v[192:207]
    ds_read_b64_tr_b16 v[220:221], v249 offset:7168
    s_waitcnt lgkmcnt(14)
    ds_read_b64_tr_b16 v[222:223], v249 offset:7296
    s_waitcnt lgkmcnt(8)
    v_mfma_f32_32x32x16_bf16 v[160:175], v[224:227], v[16:19], v[160:175]
    ds_read_b64_tr_b16 v[224:225], v249 offset:11264
    ds_read_b64_tr_b16 v[226:227], v249 offset:11392
    v_and_b32 v252, 31, v240
    v_lshrrev_b32 v253, 5, v240
    v_bfe_u32 v254, v240, 2, 2
    v_xor_b32 v253, v253, v254
    v_lshlrev_b32 v253, 4, v253
    v_lshl_add_u32 v247, v252, 6, v253
    v_xor_b32 v248, 32, v247
    v_add_u32 v242, 65536, v247
    v_add_u32 v245, 65536, v248
    v_mfma_f32_32x32x16_bf16 v[176:191], v[228:231], v[16:19], v[176:191]
    ds_read_b64_tr_b16 v[228:229], v249 offset:3584
    ds_read_b64_tr_b16 v[230:231], v249 offset:3712
    v_mfma_f32_32x32x16_bf16 v[192:207], v[232:235], v[16:19], v[192:207]
    ds_read_b64_tr_b16 v[232:233], v249 offset:7680
    ds_read_b64_tr_b16 v[234:235], v249 offset:7808
    v_mfma_f32_32x32x16_bf16 v[160:175], v[236:239], v[20:23], v[160:175]
    ds_read_b64_tr_b16 v[236:237], v249 offset:11776
    s_waitcnt lgkmcnt(14)
    ds_read_b64_tr_b16 v[238:239], v249 offset:11904
    s_waitcnt lgkmcnt(8)
    v_mfma_f32_32x32x16_bf16 v[176:191], v[208:211], v[20:23], v[176:191]
    s_waitcnt vmcnt(10)
    s_barrier
    ds_read_b64_tr_b16 v[208:209], v249 offset:32768
    ds_read_b64_tr_b16 v[210:211], v249 offset:32896
    s_cmp_ge_u32 s4, 4
    s_cbranch_scc1 L_nd30
    s_lshl_b32 s91, s7, 5
    s_add_u32 s91, s91, 1056768
    s_add_u32 m0, s11, 98304
    s_nop 0
    buffer_load_dwordx4 v243, s[64:67], s91 offen lds
    s_lshl_b32 s91, s7, 5
    s_add_u32 s91, s91, 1056768
    s_add_u32 m0, s11, 102368
    s_nop 0
    buffer_load_dwordx4 v243, s[64:67], s91 offen offset:32 lds
L_nd30:
    v_mfma_f32_32x32x16_bf16 v[192:207], v[212:215], v[20:23], v[192:207]
    ds_read_b64_tr_b16 v[212:213], v249 offset:36864
    ds_read_b64_tr_b16 v[214:215], v249 offset:36992
    v_mfma_f32_32x32x16_bf16 v[160:175], v[216:219], v[24:27], v[160:175]
    ds_read_b64_tr_b16 v[216:217], v249 offset:40960
    ds_read_b64_tr_b16 v[218:219], v249 offset:41088
    s_cmp_ge_u32 s4, 4
    s_cbranch_scc1 L_nd31
    s_lshl_b32 s91, s7, 5
    s_add_u32 s91, s91, 1056768
    s_add_u32 m0, s11, 106432
    s_nop 0
    buffer_load_dwordx4 v243, s[64:67], s91 offen offset:64 lds
    s_lshl_b32 s91, s7, 5
    s_add_u32 s91, s91, 1056768
    s_add_u32 m0, s11, 110720
    s_nop 0
    buffer_load_dwordx4 v243, s[72:75], s91 offen lds
L_nd31:
    v_mfma_f32_32x32x16_bf16 v[176:191], v[220:223], v[24:27], v[176:191]
    ds_read_b64_tr_b16 v[220:221], v249 offset:33280
    s_waitcnt lgkmcnt(14)
    ds_read_b64_tr_b16 v[222:223], v249 offset:33408
    s_waitcnt lgkmcnt(8)
    v_mfma_f32_32x32x16_bf16 v[192:207], v[224:227], v[24:27], v[192:207]
    ds_read_b64_tr_b16 v[224:225], v249 offset:37376
    ds_read_b64_tr_b16 v[226:227], v249 offset:37504
    s_cmp_ge_u32 s4, 4
    s_cbranch_scc1 L_nd32
    s_lshl_b32 s91, s7, 5
    s_add_u32 s91, s91, 1056768
    s_add_u32 m0, s11, 114784
    s_nop 0
    buffer_load_dwordx4 v243, s[72:75], s91 offen offset:32 lds
    s_lshl_b32 s91, s7, 5
    s_add_u32 s91, s91, 1056768
    s_add_u32 m0, s11, 118848
    s_nop 0
    buffer_load_dwordx4 v243, s[72:75], s91 offen offset:64 lds
L_nd32:
    v_mfma_f32_32x32x16_bf16 v[160:175], v[228:231], v[28:31], v[160:175]
    ds_read_b64_tr_b16 v[228:229], v249 offset:41472
    ds_read_b64_tr_b16 v[230:231], v249 offset:41600
    v_mfma_f32_32x32x16_bf16 v[176:191], v[232:235], v[28:31], v[176:191]
    ds_read_b64_tr_b16 v[232:233], v249 offset:33792
    ds_read_b64_tr_b16 v[234:235], v249 offset:33920
    v_mfma_f32_32x32x16_bf16 v[192:207], v[236:239], v[28:31], v[192:207]
    ds_read_b64_tr_b16 v[236:237], v249 offset:37888
    s_waitcnt lgkmcnt(14)
    ds_read_b64_tr_b16 v[238:239], v249 offset:38016
    s_waitcnt lgkmcnt(8)
    v_mfma_f32_32x32x16_bf16 v[160:175], v[208:211], v[32:35], v[160:175]
    ds_read_b64_tr_b16 v[208:209], v249 offset:41984
    ds_read_b64_tr_b16 v[210:211], v249 offset:42112
    v_mfma_f32_32x32x16_bf16 v[176:191], v[212:215], v[32:35], v[176:191]
    ds_read_b64_tr_b16 v[212:213], v249 offset:34304
    ds_read_b64_tr_b16 v[214:215], v249 offset:34432
    v_mfma_f32_32x32x16_bf16 v[192:207], v[216:219], v[32:35], v[192:207]
    ds_read_b64_tr_b16 v[216:217], v249 offset:38400
    ds_read_b64_tr_b16 v[218:219], v249 offset:38528
    v_mfma_f32_32x32x16_bf16 v[160:175], v[220:223], v[36:39], v[160:175]
    ds_read_b64_tr_b16 v[220:221], v249 offset:42496
    s_waitcnt lgkmcnt(14)
    ds_read_b64_tr_b16 v[222:223], v249 offset:42624
    s_waitcnt lgkmcnt(8)
    v_mfma_f32_32x32x16_bf16 v[176:191], v[224:227], v[36:39], v[176:191]
    ds_read_b64_tr_b16 v[224:225], v249 offset:34816
    ds_read_b64_tr_b16 v[226:227], v249 offset:34944
    v_mfma_f32_32x32x16_bf16 v[192:207], v[228:231], v[36:39], v[192:207]
    ds_read_b64_tr_b16 v[228:229], v249 offset:38912
    ds_read_b64_tr_b16 v[230:231], v249 offset:39040
    v_mfma_f32_32x32x16_bf16 v[160:175], v[232:235], v[40:43], v[160:175]
    ds_read_b64_tr_b16 v[232:233], v249 offset:43008
    ds_read_b64_tr_b16 v[234:235], v249 offset:43136
    v_mfma_f32_32x32x16_bf16 v[176:191], v[236:239], v[40:43], v[176:191]
    ds_read_b64_tr_b16 v[236:237], v249 offset:35328
    s_waitcnt lgkmcnt(14)
    ds_read_b64_tr_b16 v[238:239], v249 offset:35456
    s_waitcnt lgkmcnt(8)
    v_mfma_f32_32x32x16_bf16 v[192:207], v[208:211], v[40:43], v[192:207]
    ds_read_b64_tr_b16 v[208:209], v249 offset:39424
    ds_read_b64_tr_b16 v[210:211], v249 offset:39552
    v_mfma_f32_32x32x16_bf16 v[160:175], v[212:215], v[44:47], v[160:175]
    ds_read_b64_tr_b16 v[212:213], v249 offset:43520
    ds_read_b64_tr_b16 v[214:215], v249 offset:43648
    v_mfma_f32_32x32x16_bf16 v[176:191], v[216:219], v[44:47], v[176:191]
    ds_read_b64_tr_b16 v[216:217], v249 offset:35840
    ds_read_b64_tr_b16 v[218:219], v249 offset:35968
    v_mfma_f32_32x32x16_bf16 v[192:207], v[220:223], v[44:47], v[192:207]
    ds_read_b64_tr_b16 v[220:221], v249 offset:39936
    s_waitcnt lgkmcnt(14)
    ds_read_b64_tr_b16 v[222:223], v249 offset:40064
    s_waitcnt lgkmcnt(8)
    v_mfma_f32_32x32x16_bf16 v[160:175], v[224:227], v[48:51], v[160:175]
    ds_read_b64_tr_b16 v[224:225], v249 offset:44032
    ds_read_b64_tr_b16 v[226:227], v249 offset:44160
    v_mfma_f32_32x32x16_bf16 v[176:191], v[228:231], v[48:51], v[176:191]
    ds_read_b64_tr_b16 v[228:229], v249 offset:36352
    ds_read_b64_tr_b16 v[230:231], v249 offset:36480
    v_mfma_f32_32x32x16_bf16 v[192:207], v[232:235], v[48:51], v[192:207]
    ds_read_b64_tr_b16 v[232:233], v249 offset:40448
    ds_read_b64_tr_b16 v[234:235], v249 offset:40576
    v_mfma_f32_32x32x16_bf16 v[160:175], v[236:239], v[52:55], v[160:175]
    ds_read_b64_tr_b16 v[236:237], v249 offset:44544
    s_waitcnt lgkmcnt(14)
    ds_read_b64_tr_b16 v[238:239], v249 offset:44672
    s_waitcnt lgkmcnt(8)
    v_mfma_f32_32x32x16_bf16 v[176:191], v[208:211], v[52:55], v[176:191]
    s_waitcnt vmcnt(6)
    s_barrier
    ds_read_b64_tr_b16 v[208:209], v250
    ds_read_b64_tr_b16 v[210:211], v250 offset:128
    s_cmp_ge_u32 s4, 4
    s_cbranch_scc1 L_nd33
    s_mov_b32 s91, 0
    s_add_u32 m0, s11, 0
    s_nop 0
    buffer_load_dwordx4 v244, s[44:47], s91 offen lds
    s_mov_b32 s91, 0
    s_add_u32 m0, s11, 4032
    s_nop 0
    buffer_load_dwordx4 v244, s[44:47], s91 offen offset:64 lds
L_nd33:
    v_mfma_f32_32x32x16_bf16 v[192:207], v[212:215], v[52:55], v[192:207]
    ds_read_b64_tr_b16 v[212:213], v250 offset:4096
    ds_read_b64_tr_b16 v[214:215], v250 offset:4224
    v_mfma_f32_32x32x16_bf16 v[160:175], v[216:219], v[56:59], v[160:175]
    ds_read_b64_tr_b16 v[216:217], v250 offset:8192
    ds_read_b64_tr_b16 v[218:219], v250 offset:8320
    s_cmp_ge_u32 s4, 4
    s_cbranch_scc1 L_nd34
    s_mov_b32 s91, 0
    s_add_u32 m0, s11, 8064
    s_nop 0
    buffer_load_dwordx4 v244, s[44:47], s91 offen offset:128 lds
    s_mov_b32 s91, 0
    s_add_u32 m0, s11, 12096
    s_nop 0
    buffer_load_dwordx4 v244, s[44:47], s91 offen offset:192 lds
L_nd34:
    v_mfma_f32_32x32x16_bf16 v[176:191], v[220:223], v[56:59], v[176:191]
    ds_read_b64_tr_b16 v[220:221], v250 offset:512
    s_waitcnt lgkmcnt(14)
    ds_read_b64_tr_b16 v[222:223], v250 offset:640
    s_waitcnt lgkmcnt(8)
    v_mfma_f32_32x32x16_bf16 v[192:207], v[224:227], v[56:59], v[192:207]
    ds_read_b64_tr_b16 v[224:225], v250 offset:4608
    ds_read_b64_tr_b16 v[226:227], v250 offset:4736
    s_cmp_ge_u32 s4, 4
    s_cbranch_scc1 L_nd35
    s_mov_b32 s91, 0
    s_add_u32 m0, s11, 16384
    s_nop 0
    buffer_load_dwordx4 v251, s[68:71], s91 offen lds
    s_mov_b32 s91, 0
    s_add_u32 m0, s11, 20416
    s_nop 0
    buffer_load_dwordx4 v251, s[68:71], s91 offen offset:64 lds
L_nd35:
    v_mfma_f32_32x32x16_bf16 v[160:175], v[228:231], v[60:63], v[160:175]
    ds_read_b64_tr_b16 v[228:229], v250 offset:8704
    ds_read_b64_tr_b16 v[230:231], v250 offset:8832
    v_mfma_f32_32x32x16_bf16 v[176:191], v[232:235], v[60:63], v[176:191]
    ds_read_b64_tr_b16 v[232:233], v250 offset:1024
    ds_read_b64_tr_b16 v[234:235], v250 offset:1152
    s_cmp_ge_u32 s4, 4
    s_cbranch_scc1 L_nd36
    s_mov_b32 s91, 0
    s_add_u32 m0, s11, 24448
    s_nop 0
    buffer_load_dwordx4 v251, s[68:71], s91 offen offset:128 lds
    s_mov_b32 s91, 0
    s_add_u32 m0, s11, 28480
    s_nop 0
    buffer_load_dwordx4 v251, s[68:71], s91 offen offset:192 lds
L_nd36:
    v_mfma_f32_32x32x16_bf16 v[192:207], v[236:239], v[60:63], v[192:207]
    ds_read_b64_tr_b16 v[236:237], v250 offset:5120
    s_waitcnt lgkmcnt(14)
    ds_read_b64_tr_b16 v[238:239], v250 offset:5248
    s_waitcnt lgkmcnt(8)
    v_mfma_f32_32x32x16_bf16 v[160:175], v[208:211], v[64:67], v[160:175]
    ds_read_b64_tr_b16 v[208:209], v250 offset:9216
    ds_read_b64_tr_b16 v[210:211], v250 offset:9344
    v_mfma_f32_32x32x16_bf16 v[176:191], v[212:215], v[64:67], v[176:191]
    ds_read_b64_tr_b16 v[212:213], v250 offset:1536
    ds_read_b64_tr_b16 v[214:215], v250 offset:1664
    v_mfma_f32_32x32x16_bf16 v[192:207], v[216:219], v[64:67], v[192:207]
    ds_read_b64_tr_b16 v[216:217], v250 offset:5632
    ds_read_b64_tr_b16 v[218:219], v250 offset:5760
    v_mfma_f32_32x32x16_bf16 v[160:175], v[220:223], v[68:71], v[160:175]
    ds_read_b64_tr_b16 v[220:221], v250 offset:9728
    s_waitcnt lgkmcnt(14)
    ds_read_b64_tr_b16 v[222:223], v250 offset:9856
    s_waitcnt lgkmcnt(8)
    v_mfma_f32_32x32x16_bf16 v[176:191], v[224:227], v[68:71], v[176:191]
    ds_read_b64_tr_b16 v[224:225], v250 offset:2048
    ds_read_b64_tr_b16 v[226:227], v250 offset:2176
    v_mfma_f32_32x32x16_bf16 v[192:207], v[228:231], v[68:71], v[192:207]
    ds_read_b64_tr_b16 v[228:229], v250 offset:6144
    ds_read_b64_tr_b16 v[230:231], v250 offset:6272
    v_mfma_f32_32x32x16_bf16 v[160:175], v[232:235], v[72:75], v[160:175]
    ds_read_b64_tr_b16 v[232:233], v250 offset:10240
    ds_read_b64_tr_b16 v[234:235], v250 offset:10368
    v_mfma_f32_32x32x16_bf16 v[176:191], v[236:239], v[72:75], v[176:191]
    ds_read_b64_tr_b16 v[236:237], v250 offset:2560
    s_waitcnt lgkmcnt(14)
    ds_read_b64_tr_b16 v[238:239], v250 offset:2688
    s_waitcnt lgkmcnt(8)
    v_mfma_f32_32x32x16_bf16 v[192:207], v[208:211], v[72:75], v[192:207]
    ds_read_b64_tr_b16 v[208:209], v250 offset:6656
    ds_read_b64_tr_b16 v[210:211], v250 offset:6784
    v_mfma_f32_32x32x16_bf16 v[160:175], v[212:215], v[76:79], v[160:175]
    ds_read_b64_tr_b16 v[212:213], v250 offset:10752
    ds_read_b64_tr_b16 v[214:215], v250 offset:10880
    v_mfma_f32_32x32x16_bf16 v[176:191], v[216:219], v[76:79], v[176:191]
    ds_read_b64_tr_b16 v[216:217], v250 offset:3072
    ds_read_b64_tr_b16 v[218:219], v250 offset:3200
    v_mfma_f32_32x32x16_bf16 v[192:207], v[220:223], v[76:79], v[192:207]
    ds_read_b64_tr_b16 v[220:221], v250 offset:7168
    s_waitcnt lgkmcnt(14)
    ds_read_b64_tr_b16 v[222:223], v250 offset:7296
    s_waitcnt lgkmcnt(8)
    v_mfma_f32_32x32x16_bf16 v[160:175], v[224:227], v[80:83], v[160:175]
    ds_read_b64_tr_b16 v[224:225], v250 offset:11264
    ds_read_b64_tr_b16 v[226:227], v250 offset:11392
    v_mfma_f32_32x32x16_bf16 v[176:191], v[228:231], v[80:83], v[176:191]
    ds_read_b64_tr_b16 v[228:229], v250 offset:3584
    ds_read_b64_tr_b16 v[230:231], v250 offset:3712
    v_mfma_f32_32x32x16_bf16 v[192:207], v[232:235], v[80:83], v[192:207]
    ds_read_b64_tr_b16 v[232:233], v250 offset:7680
    ds_read_b64_tr_b16 v[234:235], v250 offset:7808
    v_mfma_f32_32x32x16_bf16 v[160:175], v[236:239], v[84:87], v[160:175]
    ds_read_b64_tr_b16 v[236:237], v250 offset:11776
    s_waitcnt lgkmcnt(14)
    ds_read_b64_tr_b16 v[238:239], v250 offset:11904
    s_waitcnt lgkmcnt(8)
    v_mfma_f32_32x32x16_bf16 v[176:191], v[208:211], v[84:87], v[176:191]
    s_waitcnt vmcnt(8)
    s_barrier
    ds_read_b64_tr_b16 v[208:209], v250 offset:32768
    ds_read_b64_tr_b16 v[210:211], v250 offset:32896
    s_cmp_ge_u32 s4, 4
    s_cbranch_scc1 L_nd37
    s_mov_b32 s91, 16384
    s_add_u32 m0, s11, 32768
    s_nop 0
    buffer_load_dwordx4 v244, s[44:47], s91 offen lds
    s_mov_b32 s91, 16384
    s_add_u32 m0, s11, 36800
    s_nop 0
    buffer_load_dwordx4 v244, s[44:47], s91 offen offset:64 lds
L_nd37:
    v_mfma_f32_32x32x16_bf16 v[192:207], v[212:215], v[84:87], v[192:207]
    ds_read_b64_tr_b16 v[212:213], v250 offset:33280
    ds_read_b64_tr_b16 v[214:215], v250 offset:33408
    v_mfma_f32_32x32x16_bf16 v[160:175], v[216:219], v[88:91], v[160:175]
    ds_read_b64_tr_b16 v[216:217], v250 offset:33792
    ds_read_b64_tr_b16 v[218:219], v250 offset:33920
    s_cmp_ge_u32 s4, 4
    s_cbranch_scc1 L_nd38
    s_mov_b32 s91, 16384
    s_add_u32 m0, s11, 40832
    s_nop 0
    buffer_load_dwordx4 v244, s[44:47], s91 offen offset:128 lds
    s_mov_b32 s91, 16384
    s_add_u32 m0, s11, 44864
    s_nop 0
    buffer_load_dwordx4 v244, s[44:47], s91 offen offset:192 lds
L_nd38:
    v_mfma_f32_32x32x16_bf16 v[176:191], v[220:223], v[88:91], v[176:191]
    ds_read_b64_tr_b16 v[220:221], v250 offset:34304
    s_waitcnt lgkmcnt(14)
    ds_read_b64_tr_b16 v[222:223], v250 offset:34432
    s_waitcnt lgkmcnt(8)
    v_mfma_f32_32x32x16_bf16 v[192:207], v[224:227], v[88:91], v[192:207]
    ds_read_b64_tr_b16 v[224:225], v250 offset:34816
    ds_read_b64_tr_b16 v[226:227], v250 offset:34944
    s_cmp_ge_u32 s4, 4
    s_cbranch_scc1 L_nd39
    s_mov_b32 s91, 16384
    s_add_u32 m0, s11, 49152
    s_nop 0
    buffer_load_dwordx4 v251, s[68:71], s91 offen lds
    s_mov_b32 s91, 16384
    s_add_u32 m0, s11, 53184
    s_nop 0
    buffer_load_dwordx4 v251, s[68:71], s91 offen offset:64 lds
L_nd39:
    v_mfma_f32_32x32x16_bf16 v[160:175], v[228:231], v[92:95], v[160:175]
    ds_read_b64_tr_b16 v[228:229], v250 offset:35328
    ds_read_b64_tr_b16 v[230:231], v250 offset:35456
    v_mfma_f32_32x32x16_bf16 v[176:191], v[232:235], v[92:95], v[176:191]
    ds_read_b64_tr_b16 v[232:233], v250 offset:35840
    ds_read_b64_tr_b16 v[234:235], v250 offset:35968
    s_cmp_ge_u32 s4, 4
    s_cbranch_scc1 L_nd40
    s_mov_b32 s91, 16384
    s_add_u32 m0, s11, 57216
    s_nop 0
    buffer_load_dwordx4 v251, s[68:71], s91 offen offset:128 lds
    s_mov_b32 s91, 16384
    s_add_u32 m0, s11, 61248
    s_nop 0
    buffer_load_dwordx4 v251, s[68:71], s91 offen offset:192 lds
L_nd40:
    v_mfma_f32_32x32x16_bf16 v[192:207], v[236:239], v[92:95], v[192:207]
    ds_read_b64_tr_b16 v[236:237], v250 offset:36352
    s_waitcnt lgkmcnt(14)
    ds_read_b64_tr_b16 v[238:239], v250 offset:36480
    s_waitcnt lgkmcnt(8)
    v_mfma_f32_32x32x16_bf16 v[160:175], v[208:211], v[96:99], v[160:175]
    ds_read_b64_tr_b16 v[208:209], v250 offset:36864
    ds_read_b64_tr_b16 v[210:211], v250 offset:36992
    v_mfma_f32_32x32x16_bf16 v[160:175], v[212:215], v[100:103], v[160:175]
    ds_read_b64_tr_b16 v[212:213], v250 offset:37376
    ds_read_b64_tr_b16 v[214:215], v250 offset:37504
    v_mfma_f32_32x32x16_bf16 v[160:175], v[216:219], v[104:107], v[160:175]
    ds_read_b64_tr_b16 v[216:217], v250 offset:37888
    ds_read_b64_tr_b16 v[218:219], v250 offset:38016
    v_mfma_f32_32x32x16_bf16 v[160:175], v[220:223], v[108:111], v[160:175]
    ds_read_b64_tr_b16 v[220:221], v250 offset:38400
    s_waitcnt lgkmcnt(14)
    ds_read_b64_tr_b16 v[222:223], v250 offset:38528
    s_waitcnt lgkmcnt(8)
    v_mfma_f32_32x32x16_bf16 v[160:175], v[224:227], v[112:115], v[160:175]
    ds_read_b64_tr_b16 v[224:225], v250 offset:38912
    ds_read_b64_tr_b16 v[226:227], v250 offset:39040
    v_mfma_f32_32x32x16_bf16 v[160:175], v[228:231], v[116:119], v[160:175]
    ds_read_b64_tr_b16 v[228:229], v250 offset:39424
    ds_read_b64_tr_b16 v[230:231], v250 offset:39552
    v_mfma_f32_32x32x16_bf16 v[160:175], v[232:235], v[120:123], v[160:175]
    ds_read_b64_tr_b16 v[232:233], v250 offset:39936
    ds_read_b64_tr_b16 v[234:235], v250 offset:40064
    v_mfma_f32_32x32x16_bf16 v[160:175], v[236:239], v[124:127], v[160:175]
    ds_read_b64_tr_b16 v[236:237], v250 offset:40448
    s_waitcnt lgkmcnt(14)
    ds_read_b64_tr_b16 v[238:239], v250 offset:40576
    s_waitcnt lgkmcnt(8)
    v_mfma_f32_32x32x16_bf16 v[176:191], v[208:211], v[96:99], v[176:191]
    ds_read_b64_tr_b16 v[208:209], v250 offset:40960
    ds_read_b64_tr_b16 v[210:211], v250 offset:41088
    v_mfma_f32_32x32x16_bf16 v[176:191], v[212:215], v[100:103], v[176:191]
    ds_read_b64_tr_b16 v[212:213], v250 offset:41472
    ds_read_b64_tr_b16 v[214:215], v250 offset:41600
    s_mov_b32 s92, 0xbdd2d3e8
    s_lshl_b32 s93, s7, 10
    s_add_u32 s93, s84, s93
    s_add_u32 s93, s93, 262144
    v_mov_b32 v20, 0xc0135761
    v_cvt_pk_bf16_f32 v0, v160, v161
    v_cvt_pk_bf16_f32 v2, v162, v163
    v_cvt_pk_bf16_f32 v4, v164, v165
    v_cvt_pk_bf16_f32 v6, v166, v167
    v_cvt_pk_bf16_f32 v1, v168, v169
    v_cvt_pk_bf16_f32 v3, v170, v171
    v_cvt_pk_bf16_f32 v5, v172, v173
    v_cvt_pk_bf16_f32 v7, v174, v175
    v_lshlrev_b32 v160, 16, v0
    v_lshlrev_b32 v162, 16, v2
    v_lshlrev_b32 v164, 16, v4
    v_lshlrev_b32 v166, 16, v6
    v_and_b32 v161, 4294901760, v0
    v_and_b32 v163, 4294901760, v2
    v_mfma_f32_32x32x16_bf16 v[176:191], v[216:219], v[104:107], v[176:191]
    ds_read_b64_tr_b16 v[216:217], v250 offset:41984
    ds_read_b64_tr_b16 v[218:219], v250 offset:42112
    v_and_b32 v165, 4294901760, v4
    v_and_b32 v167, 4294901760, v6
    v_lshlrev_b32 v168, 16, v1
    v_lshlrev_b32 v170, 16, v3
    v_lshlrev_b32 v172, 16, v5
    v_lshlrev_b32 v174, 16, v7
    v_and_b32 v169, 4294901760, v1
    v_and_b32 v171, 4294901760, v3
    v_and_b32 v173, 4294901760, v5
    v_and_b32 v175, 4294901760, v7
    v_mul_f32 v0, v160, v160
    v_mul_f32 v2, v162, v162
    v_mul_f32 v4, v164, v164
    v_mul_f32 v6, v166, v166
    v_mul_f32 v1, v161, v161
    v_mfma_f32_32x32x16_bf16 v[176:191], v[220:223], v[108:111], v[176:191]
    ds_read_b64_tr_b16 v[220:221], v250 offset:42496
    s_waitcnt lgkmcnt(14)
    ds_read_b64_tr_b16 v[222:223], v250 offset:42624
    v_mul_f32 v3, v163, v163
    v_mul_f32 v5, v165, v165
    v_mul_f32 v7, v167, v167
    v_fma_f32 v0, v0, s92, v20
    v_fma_f32 v2, v2, s92, v20
    v_fma_f32 v4, v4, s92, v20
    v_fma_f32 v6, v6, s92, v20
    v_fma_f32 v1, v1, s92, v20
    v_fma_f32 v3, v3, s92, v20
    v_fma_f32 v5, v5, s92, v20
    v_fma_f32 v7, v7, s92, v20
    v_mul_f32 v0, v0, v160
    v_mul_f32 v2, v2, v162
    v_mul_f32 v4, v4, v164
    v_mul_f32 v6, v6, v166
    s_waitcnt lgkmcnt(8)
    v_mfma_f32_32x32x16_bf16 v[176:191], v[224:227], v[112:115], v[176:191]
    ds_read_b64_tr_b16 v[224:225], v250 offset:43008
    ds_read_b64_tr_b16 v[226:227], v250 offset:43136
    v_mul_f32 v1, v1, v161
    v_mul_f32 v3, v3, v163
    v_mul_f32 v5, v5, v165
    v_mul_f32 v7, v7, v167
    v_exp_f32 v0, v0
    v_exp_f32 v2, v2
    v_exp_f32 v4, v4
    v_exp_f32 v6, v6
    v_exp_f32 v1, v1
    v_exp_f32 v3, v3
    v_exp_f32 v5, v5
    v_exp_f32 v7, v7
    v_add_f32 v0, 1.0, v0
    v_add_f32 v2, 1.0, v2
    v_add_f32 v4, 1.0, v4
    v_mfma_f32_32x32x16_bf16 v[176:191], v[228:231], v[116:119], v[176:191]
    ds_read_b64_tr_b16 v[228:229], v250 offset:43520
    ds_read_b64_tr_b16 v[230:231], v250 offset:43648
    v_add_f32 v6, 1.0, v6
    v_add_f32 v1, 1.0, v1
    v_add_f32 v3, 1.0, v3
    v_add_f32 v5, 1.0, v5
    v_add_f32 v7, 1.0, v7
    v_rcp_f32 v0, v0
    v_rcp_f32 v2, v2
    v_rcp_f32 v4, v4
    v_rcp_f32 v6, v6
    v_rcp_f32 v1, v1
    v_rcp_f32 v3, v3
    v_rcp_f32 v5, v5
    v_rcp_f32 v7, v7
    v_mul_f32 v160, v160, v0
    v_mul_f32 v162, v162, v2
    v_mfma_f32_32x32x16_bf16 v[176:191], v[232:235], v[120:123], v[176:191]
    ds_read_b64_tr_b16 v[232:233], v250 offset:44032
    ds_read_b64_tr_b16 v[234:235], v250 offset:44160
    v_mul_f32 v164, v164, v4
    v_mul_f32 v166, v166, v6
    v_mul_f32 v161, v161, v1
    v_mul_f32 v163, v163, v3
    v_mul_f32 v165, v165, v5
    v_mul_f32 v167, v167, v7
    v_cvt_pk_bf16_f32 v0, v160, v161
    v_cvt_pk_bf16_f32 v2, v162, v163
    v_cvt_pk_bf16_f32 v4, v164, v165
    v_cvt_pk_bf16_f32 v6, v166, v167
    v_lshlrev_b32 v160, 16, v0
    v_lshlrev_b32 v162, 16, v2
    v_lshlrev_b32 v164, 16, v4
    v_lshlrev_b32 v166, 16, v6
    v_and_b32 v161, 4294901760, v0
    v_mfma_f32_32x32x16_bf16 v[176:191], v[236:239], v[124:127], v[176:191]
    ds_read_b64_tr_b16 v[236:237], v250 offset:44544
    s_waitcnt lgkmcnt(14)
    ds_read_b64_tr_b16 v[238:239], v250 offset:44672
    v_and_b32 v163, 4294901760, v2
    v_and_b32 v165, 4294901760, v4
    v_and_b32 v167, 4294901760, v6
    v_mul_f32 v160, v160, v168
    v_mul_f32 v162, v162, v170
    v_mul_f32 v164, v164, v172
    v_mul_f32 v166, v166, v174
    v_mul_f32 v161, v161, v169
    v_mul_f32 v163, v163, v171
    v_mul_f32 v165, v165, v173
    v_mul_f32 v167, v167, v175
    v_cvt_pk_bf16_f32 v8, v160, v161
    v_cvt_pk_bf16_f32 v9, v162, v163
    v_cvt_pk_bf16_f32 v10, v164, v165
    v_cvt_pk_bf16_f32 v11, v166, v167
    buffer_store_dwordx4 v[8:11], v241, s[60:63], s93 offen
    s_waitcnt lgkmcnt(8)
    v_mfma_f32_32x32x16_bf16 v[192:207], v[208:211], v[96:99], v[192:207]
    s_waitcnt vmcnt(9)
    s_barrier
    ds_read_b128 v[208:211], v247
    s_cmp_ge_u32 s4, 4
    s_cbranch_scc1 L_nd41
    s_mov_b32 s91, 32768
    s_add_u32 m0, s11, 65536
    s_nop 0
    buffer_load_dwordx4 v244, s[44:47], s91 offen lds
    s_mov_b32 s91, 32768
    s_add_u32 m0, s11, 69568
    s_nop 0
    buffer_load_dwordx4 v244, s[44:47], s91 offen offset:64 lds
L_nd41:
    v_mfma_f32_32x32x16_bf16 v[192:207], v[212:215], v[100:103], v[192:207]
    ds_read_b128 v[212:215], v248
    v_cvt_pk_bf16_f32 v0, v176, v177
    v_cvt_pk_bf16_f32 v2, v178, v179
    v_cvt_pk_bf16_f32 v4, v180, v181
    v_cvt_pk_bf16_f32 v6, v182, v183
    v_cvt_pk_bf16_f32 v1, v184, v185
    v_cvt_pk_bf16_f32 v3, v186, v187
    v_cvt_pk_bf16_f32 v5, v188, v189
    v_cvt_pk_bf16_f32 v7, v190, v191
    v_lshlrev_b32 v176, 16, v0
    v_lshlrev_b32 v178, 16, v2
    v_lshlrev_b32 v180, 16, v4
    v_lshlrev_b32 v182, 16, v6
    v_and_b32 v177, 4294901760, v0
    v_and_b32 v179, 4294901760, v2
    v_and_b32 v181, 4294901760, v4
    v_mfma_f32_32x32x16_bf16 v[192:207], v[216:219], v[104:107], v[192:207]
    ds_read_b128 v[216:219], v247 offset:4096
    s_cmp_ge_u32 s4, 4
    s_cbranch_scc1 L_nd42
    s_mov_b32 s91, 32768
    s_add_u32 m0, s11, 73600
    s_nop 0
    buffer_load_dwordx4 v244, s[44:47], s91 offen offset:128 lds
    s_mov_b32 s91, 32768
    s_add_u32 m0, s11, 77632
    s_nop 0
    buffer_load_dwordx4 v244, s[44:47], s91 offen offset:192 lds
L_nd42:
    v_and_b32 v183, 4294901760, v6
    v_lshlrev_b32 v184, 16, v1
    v_lshlrev_b32 v186, 16, v3
    v_lshlrev_b32 v188, 16, v5
    v_lshlrev_b32 v190, 16, v7
    v_and_b32 v185, 4294901760, v1
    v_and_b32 v187, 4294901760, v3
    v_and_b32 v189, 4294901760, v5
    v_and_b32 v191, 4294901760, v7
    v_mul_f32 v0, v176, v176
    v_mul_f32 v2, v178, v178
    v_mul_f32 v4, v180, v180
    v_mul_f32 v6, v182, v182
    v_mul_f32 v1, v177, v177
    v_mul_f32 v3, v179, v179
    v_mfma_f32_32x32x16_bf16 v[192:207], v[220:223], v[108:111], v[192:207]
    ds_read_b128 v[220:223], v248 offset:4096
    v_mul_f32 v5, v181, v181
    v_mul_f32 v7, v183, v183
    v_fma_f32 v0, v0, s92, v20
    v_fma_f32 v2, v2, s92, v20
    v_fma_f32 v4, v4, s92, v20
    v_fma_f32 v6, v6, s92, v20
    v_fma_f32 v1, v1, s92, v20
    v_fma_f32 v3, v3, s92, v20
    v_fma_f32 v5, v5, s92, v20
    v_fma_f32 v7, v7, s92, v20
    v_mul_f32 v0, v0, v176
    v_mul_f32 v2, v2, v178
    v_mul_f32 v4, v4, v180
    v_mul_f32 v6, v6, v182
    v_mul_f32 v1, v1, v177
    s_waitcnt lgkmcnt(4)
    v_mfma_f32_32x32x16_bf16 v[192:207], v[224:227], v[112:115], v[192:207]
    ds_read_b128 v[224:227], v247 offset:8192
    s_cmp_ge_u32 s4, 4
    s_cbranch_scc1 L_nd43
    s_mov_b32 s91, 32768
    s_add_u32 m0, s11, 81920
    s_nop 0
    buffer_load_dwordx4 v251, s[68:71], s91 offen lds
    s_mov_b32 s91, 32768
    s_add_u32 m0, s11, 85952
    s_nop 0
    buffer_load_dwordx4 v251, s[68:71], s91 offen offset:64 lds
L_nd43:
    v_mul_f32 v3, v3, v179
    v_mul_f32 v5, v5, v181
    v_mul_f32 v7, v7, v183
    v_exp_f32 v0, v0
    v_exp_f32 v2, v2
    v_exp_f32 v4, v4
    v_exp_f32 v6, v6
    v_exp_f32 v1, v1
    v_exp_f32 v3, v3
    v_exp_f32 v5, v5
    v_exp_f32 v7, v7
    v_add_f32 v0, 1.0, v0
    v_add_f32 v2, 1.0, v2
    v_add_f32 v4, 1.0, v4
    v_add_f32 v6, 1.0, v6
    v_mfma_f32_32x32x16_bf16 v[192:207], v[228:231], v[116:119], v[192:207]
    ds_read_b128 v[228:231], v248 offset:8192
    v_add_f32 v1, 1.0, v1
    v_add_f32 v3, 1.0, v3
    v_add_f32 v5, 1.0, v5
    v_add_f32 v7, 1.0, v7
    v_rcp_f32 v0, v0
    v_rcp_f32 v2, v2
    v_rcp_f32 v4, v4
    v_rcp_f32 v6, v6
    v_rcp_f32 v1, v1
    v_rcp_f32 v3, v3
    v_rcp_f32 v5, v5
    v_rcp_f32 v7, v7
    v_mul_f32 v176, v176, v0
    v_mul_f32 v178, v178, v2
    v_mul_f32 v180, v180, v4
    v_mfma_f32_32x32x16_bf16 v[192:207], v[232:235], v[120:123], v[192:207]
    ds_read_b128 v[232:235], v247 offset:12288
    s_cmp_ge_u32 s4, 4
    s_cbranch_scc1 L_nd44
    s_mov_b32 s91, 32768
    s_add_u32 m0, s11, 89984
    s_nop 0
    buffer_load_dwordx4 v251, s[68:71], s91 offen offset:128 lds
    s_mov_b32 s91, 32768
    s_add_u32 m0, s11, 94016
    s_nop 0
    buffer_load_dwordx4 v251, s[68:71], s91 offen offset:192 lds
L_nd44:
    v_mul_f32 v182, v182, v6
    v_mul_f32 v177, v177, v1
    v_mul_f32 v179, v179, v3
    v_mul_f32 v181, v181, v5
    v_mul_f32 v183, v183, v7
    v_cvt_pk_bf16_f32 v0, v176, v177
    v_cvt_pk_bf16_f32 v2, v178, v179
    v_cvt_pk_bf16_f32 v4, v180, v181
    v_cvt_pk_bf16_f32 v6, v182, v183
    v_lshlrev_b32 v176, 16, v0
    v_lshlrev_b32 v178, 16, v2
    v_lshlrev_b32 v180, 16, v4
    v_lshlrev_b32 v182, 16, v6
    v_and_b32 v177, 4294901760, v0
    v_and_b32 v179, 4294901760, v2
    v_mfma_f32_32x32x16_bf16 v[192:207], v[236:239], v[124:127], v[192:207]
    ds_read_b128 v[236:239], v248 offset:12288
    v_and_b32 v181, 4294901760, v4
    v_and_b32 v183, 4294901760, v6
    v_mul_f32 v176, v176, v184
    v_mul_f32 v178, v178, v186
    v_mul_f32 v180, v180, v188
    v_mul_f32 v182, v182, v190
    v_mul_f32 v177, v177, v185
    v_mul_f32 v179, v179, v187
    v_mul_f32 v181, v181, v189
    v_mul_f32 v183, v183, v191
    v_cvt_pk_bf16_f32 v12, v176, v177
    v_cvt_pk_bf16_f32 v13, v178, v179
    v_cvt_pk_bf16_f32 v14, v180, v181
    v_cvt_pk_bf16_f32 v15, v182, v183
    buffer_store_dwordx4 v[12:15], v241, s[60:63], s93 offen offset:1024
    v_lshrrev_b32 v252, 5, v240
    v_mul_u32_u24 v252, 4, v252
    v_bfe_u32 v253, v240, 2, 2
    v_add_u32 v252, v252, v253
    v_mul_u32_u24 v252, 64, v252
    v_bfe_u32 v253, v240, 4, 1
    v_mul_u32_u24 v253, 32, v253
    v_add_u32 v252, v252, v253
    v_and_b32 v253, 3, v240
    v_lshl_add_u32 v180, v253, 3, v252
    v_add_u32 v181, 65536, v180
    s_mov_b32 s90, 0x4e800000
    s_waitcnt lgkmcnt(4)
    v_mfma_f32_32x32x16_bf16 v[64:79], v[208:211], v[128:131], 0
    ds_read_b128 v[208:211], v247 offset:2048
    v_mfma_f32_32x32x16_bf16 v[64:79], v[212:215], v[132:135], v[64:79]
    ds_read_b128 v[212:215], v248 offset:2048
    v_cvt_pk_bf16_f32 v0, v192, v193
    v_cvt_pk_bf16_f32 v2, v194, v195
    v_cvt_pk_bf16_f32 v4, v196, v197
    v_cvt_pk_bf16_f32 v6, v198, v199
    v_cvt_pk_bf16_f32 v1, v200, v201
    v_cvt_pk_bf16_f32 v3, v202, v203
    v_cvt_pk_bf16_f32 v5, v204, v205
    v_cvt_pk_bf16_f32 v7, v206, v207
    v_lshlrev_b32 v192, 16, v0
    v_lshlrev_b32 v194, 16, v2
    v_lshlrev_b32 v196, 16, v4
    v_lshlrev_b32 v198, 16, v6
    v_and_b32 v193, 4294901760, v0
    v_and_b32 v195, 4294901760, v2
    v_and_b32 v197, 4294901760, v4
    v_mfma_f32_32x32x16_bf16 v[64:79], v[216:219], v[136:139], v[64:79]
    ds_read_b128 v[216:219], v247 offset:6144
    v_and_b32 v199, 4294901760, v6
    v_lshlrev_b32 v200, 16, v1
    v_lshlrev_b32 v202, 16, v3
    v_lshlrev_b32 v204, 16, v5
    v_lshlrev_b32 v206, 16, v7
    v_and_b32 v201, 4294901760, v1
    v_and_b32 v203, 4294901760, v3
    v_and_b32 v205, 4294901760, v5
    v_and_b32 v207, 4294901760, v7
    v_mul_f32 v0, v192, v192
    v_mul_f32 v2, v194, v194
    v_mul_f32 v4, v196, v196
    v_mul_f32 v6, v198, v198
    v_mul_f32 v1, v193, v193
    v_mul_f32 v3, v195, v195
    v_mfma_f32_32x32x16_bf16 v[64:79], v[220:223], v[140:143], v[64:79]
    ds_read_b128 v[220:223], v248 offset:6144
    v_mul_f32 v5, v197, v197
    v_mul_f32 v7, v199, v199
    v_fma_f32 v0, v0, s92, v20
    v_fma_f32 v2, v2, s92, v20
    v_fma_f32 v4, v4, s92, v20
    v_fma_f32 v6, v6, s92, v20
    v_fma_f32 v1, v1, s92, v20
    v_fma_f32 v3, v3, s92, v20
    v_fma_f32 v5, v5, s92, v20
    v_fma_f32 v7, v7, s92, v20
    v_mul_f32 v0, v0, v192
    v_mul_f32 v2, v2, v194
    v_mul_f32 v4, v4, v196
    v_mul_f32 v6, v6, v198
    v_mul_f32 v1, v1, v193
    s_waitcnt lgkmcnt(4)
    v_mfma_f32_32x32x16_bf16 v[64:79], v[224:227], v[144:147], v[64:79]
    ds_read_b128 v[224:227], v247 offset:10240
    v_mul_f32 v3, v3, v195
    v_mul_f32 v5, v5, v197
    v_mul_f32 v7, v7, v199
    v_exp_f32 v0, v0
    v_exp_f32 v2, v2
    v_exp_f32 v4, v4
    v_exp_f32 v6, v6
    v_exp_f32 v1, v1
    v_exp_f32 v3, v3
    v_exp_f32 v5, v5
    v_exp_f32 v7, v7
    v_add_f32 v0, 1.0, v0
    v_add_f32 v2, 1.0, v2
    v_add_f32 v4, 1.0, v4
    v_add_f32 v6, 1.0, v6
    v_mfma_f32_32x32x16_bf16 v[64:79], v[228:231], v[148:151], v[64:79]
    ds_read_b128 v[228:231], v248 offset:10240
    v_add_f32 v1, 1.0, v1
    v_add_f32 v3, 1.0, v3
    v_add_f32 v5, 1.0, v5
    v_add_f32 v7, 1.0, v7
    v_rcp_f32 v0, v0
    v_rcp_f32 v2, v2
    v_rcp_f32 v4, v4
    v_rcp_f32 v6, v6
    v_rcp_f32 v1, v1
    v_rcp_f32 v3, v3
    v_rcp_f32 v5, v5
    v_rcp_f32 v7, v7
    v_mul_f32 v192, v192, v0
    v_mul_f32 v194, v194, v2
    v_mul_f32 v196, v196, v4
    v_mfma_f32_32x32x16_bf16 v[64:79], v[232:235], v[152:155], v[64:79]
    ds_read_b128 v[232:235], v247 offset:14336
    v_mul_f32 v198, v198, v6
    v_mul_f32 v193, v193, v1
    v_mul_f32 v195, v195, v3
    v_mul_f32 v197, v197, v5
    v_mul_f32 v199, v199, v7
    v_cvt_pk_bf16_f32 v0, v192, v193
    v_cvt_pk_bf16_f32 v2, v194, v195
    v_cvt_pk_bf16_f32 v4, v196, v197
    v_cvt_pk_bf16_f32 v6, v198, v199
    v_lshlrev_b32 v192, 16, v0
    v_lshlrev_b32 v194, 16, v2
    v_lshlrev_b32 v196, 16, v4
    v_lshlrev_b32 v198, 16, v6
    v_and_b32 v193, 4294901760, v0
    v_and_b32 v195, 4294901760, v2
    v_mfma_f32_32x32x16_bf16 v[64:79], v[236:239], v[156:159], v[64:79]
    ds_read_b128 v[236:239], v248 offset:14336
    v_and_b32 v197, 4294901760, v4
    v_and_b32 v199, 4294901760, v6
    v_mul_f32 v192, v192, v200
    v_mul_f32 v194, v194, v202
    v_mul_f32 v196, v196, v204
    v_mul_f32 v198, v198, v206
    v_mul_f32 v193, v193, v201
    v_mul_f32 v195, v195, v203
    v_mul_f32 v197, v197, v205
    v_mul_f32 v199, v199, v207
    v_cvt_pk_bf16_f32 v16, v192, v193
    v_cvt_pk_bf16_f32 v17, v194, v195
    v_cvt_pk_bf16_f32 v18, v196, v197
    v_cvt_pk_bf16_f32 v19, v198, v199
    buffer_store_dwordx4 v[16:19], v241, s[60:63], s93 offen offset:2048
    v_max3_f32 v182, v64, v65, v66
    v_max3_f32 v182, v67, v68, v182
    v_max3_f32 v182, v69, v70, v182
    v_max3_f32 v182, v71, v72, v182
    v_max3_f32 v182, v73, v74, v182
    v_max3_f32 v182, v75, v76, v182
    v_max3_f32 v182, v77, v78, v182
    v_max_f32 v182, v182, v79
    v_mov_b32 v183, v182
    s_nop 1
    v_permlane32_swap_b32 v182, v183
    v_max_f32 v182, v182, v183
    v_sub_f32 v112, 0, v182
    v_sub_f32 v113, 0, v182
    v_sub_f32 v114, 0, v182
    v_sub_f32 v115, 0, v182
    v_sub_f32 v116, 0, v182
    v_sub_f32 v117, 0, v182
    v_sub_f32 v118, 0, v182
    v_sub_f32 v119, 0, v182
    v_sub_f32 v120, 0, v182
    v_sub_f32 v121, 0, v182
    v_sub_f32 v122, 0, v182
    v_sub_f32 v123, 0, v182
    v_sub_f32 v124, 0, v182
    v_sub_f32 v125, 0, v182
    v_sub_f32 v126, 0, v182
    v_sub_f32 v127, 0, v182
    v_sub_f32 v64, v64, v182
    v_sub_f32 v65, v65, v182
    v_sub_f32 v66, v66, v182
    v_sub_f32 v67, v67, v182
    v_sub_f32 v68, v68, v182
    v_sub_f32 v69, v69, v182
    v_sub_f32 v70, v70, v182
    v_sub_f32 v71, v71, v182
    v_sub_f32 v72, v72, v182
    v_sub_f32 v73, v73, v182
    v_sub_f32 v74, v74, v182
    v_sub_f32 v75, v75, v182
    v_sub_f32 v76, v76, v182
    v_sub_f32 v77, v77, v182
    v_sub_f32 v78, v78, v182
    v_sub_f32 v79, v79, v182
    v_mov_b32 v178, 0
    v_mov_b32 v179, 0
    s_waitcnt lgkmcnt(4)
    v_mfma_f32_32x32x16_bf16 v[80:95], v[208:211], v[128:131], v[112:127]
    ds_read_b64_tr_b16 v[208:209], v180 offset:16384
    ds_read_b64_tr_b16 v[210:211], v180 offset:16896
    v_exp_f32 v96, v64
    v_exp_f32 v97, v65
    v_exp_f32 v98, v66
    v_exp_f32 v99, v67
    v_add_f32 v176, v178, v96
    v_mfma_f32_32x32x16_bf16 v[80:95], v[212:215], v[132:135], v[80:95]
    ds_read_b64_tr_b16 v[212:213], v180 offset:20480
    ds_read_b64_tr_b16 v[214:215], v180 offset:20992
    v_add_f32 v177, v179, v97
    v_exp_f32 v100, v68
    v_exp_f32 v101, v69
    v_add_f32 v176, v176, v98
    v_add_f32 v177, v177, v99
    v_mfma_f32_32x32x16_bf16 v[80:95], v[216:219], v[136:139], v[80:95]
    ds_read_b64_tr_b16 v[216:217], v180 offset:24576
    ds_read_b64_tr_b16 v[218:219], v180 offset:25088
    v_exp_f32 v102, v70
    v_exp_f32 v103, v71
    v_add_f32 v176, v176, v100
    v_add_f32 v177, v177, v101
    v_exp_f32 v104, v72
    v_mfma_f32_32x32x16_bf16 v[80:95], v[220:223], v[140:143], v[80:95]
    ds_read_b64_tr_b16 v[220:221], v180 offset:28672
    ds_read_b64_tr_b16 v[222:223], v180 offset:29184
    v_exp_f32 v105, v73
    v_add_f32 v176, v176, v102
    v_add_f32 v177, v177, v103
    v_exp_f32 v106, v74
    v_exp_f32 v107, v75
    s_waitcnt lgkmcnt(8)
    v_mfma_f32_32x32x16_bf16 v[80:95], v[224:227], v[144:147], v[80:95]
    ds_read_b64_tr_b16 v[224:225], v180 offset:17408
    ds_read_b64_tr_b16 v[226:227], v180 offset:17920
    v_add_f32 v176, v176, v104
    v_add_f32 v177, v177, v105
    v_exp_f32 v108, v76
    v_exp_f32 v109, v77
    v_add_f32 v176, v176, v106
    v_mfma_f32_32x32x16_bf16 v[80:95], v[228:231], v[148:151], v[80:95]
    ds_read_b64_tr_b16 v[228:229], v180 offset:21504
    ds_read_b64_tr_b16 v[230:231], v180 offset:22016
    v_add_f32 v177, v177, v107
    v_exp_f32 v110, v78
    v_exp_f32 v111, v79
    v_add_f32 v176, v176, v108
    v_add_f32 v177, v177, v109
    v_mfma_f32_32x32x16_bf16 v[80:95], v[232:235], v[152:155], v[80:95]
    ds_read_b64_tr_b16 v[232:233], v180 offset:25600
    ds_read_b64_tr_b16 v[234:235], v180 offset:26112
    v_add_f32 v176, v176, v110
    v_add_f32 v177, v177, v111
    v_add_f32 v182, v176, v177
    v_cmp_lt_f32 vcc, s90, v182
    s_nop 1
    s_cmp_lg_u64 vcc, 0
    s_cbranch_scc1 L_rare0
L_back0:
    v_cvt_pk_bf16_f32 v160, v96, v97
    v_cvt_pk_bf16_f32 v161, v98, v99
    v_mfma_f32_32x32x16_bf16 v[80:95], v[236:239], v[156:159], v[80:95]
    ds_read_b64_tr_b16 v[236:237], v180 offset:29696
    s_waitcnt lgkmcnt(14)
    ds_read_b64_tr_b16 v[238:239], v180 offset:30208
    v_cvt_pk_bf16_f32 v162, v100, v101
    v_cvt_pk_bf16_f32 v163, v102, v103
    v_cvt_pk_bf16_f32 v164, v104, v105
    v_cvt_pk_bf16_f32 v165, v106, v107
    v_cvt_pk_bf16_f32 v166, v108, v109
    v_cvt_pk_bf16_f32 v167, v110, v111
    s_waitcnt lgkmcnt(8)
    v_mfma_f32_32x32x16_bf16 v[0:15], v[208:211], v[160:163], 0
    s_waitcnt vmcnt(11)
    s_barrier
    ds_read_b128 v[208:211], v247 offset:32768
    s_cmp_ge_u32 s4, 4
    s_cbranch_scc1 L_nd45
    s_mov_b32 s91, 49152
    s_add_u32 m0, s11, 98304
    s_nop 0
    buffer_load_dwordx4 v244, s[44:47], s91 offen lds
    s_mov_b32 s91, 49152
    s_add_u32 m0, s11, 102336
    s_nop 0
    buffer_load_dwordx4 v244, s[44:47], s91 offen offset:64 lds
L_nd45:
    v_mfma_f32_32x32x16_bf16 v[16:31], v[212:215], v[160:163], 0
    ds_read_b128 v[212:215], v248 offset:32768
    v_mfma_f32_32x32x16_bf16 v[32:47], v[216:219], v[160:163], 0
    ds_read_b128 v[216:219], v247 offset:36864
    s_cmp_ge_u32 s4, 4
    s_cbranch_scc1 L_nd46
    s_mov_b32 s91, 49152
    s_add_u32 m0, s11, 106368
    s_nop 0
    buffer_load_dwordx4 v244, s[44:47], s91 offen offset:128 lds
    s_mov_b32 s91, 49152
    s_add_u32 m0, s11, 110400
    s_nop 0
    buffer_load_dwordx4 v244, s[44:47], s91 offen offset:192 lds
L_nd46:
    v_mfma_f32_32x32x16_bf16 v[48:63], v[220:223], v[160:163], 0
    ds_read_b128 v[220:223], v248 offset:36864
    v_exp_f32 v96, v80
    v_exp_f32 v97, v81
    v_exp_f32 v98, v82
    v_exp_f32 v99, v83
    s_waitcnt lgkmcnt(4)
    v_mfma_f32_32x32x16_bf16 v[0:15], v[224:227], v[164:167], v[0:15]
    ds_read_b128 v[224:227], v247 offset:40960
    s_cmp_ge_u32 s4, 4
    s_cbranch_scc1 L_nd47
    s_mov_b32 s91, 49152
    s_add_u32 m0, s11, 114688
    s_nop 0
    buffer_load_dwordx4 v251, s[68:71], s91 offen lds
    s_mov_b32 s91, 49152
    s_add_u32 m0, s11, 118720
    s_nop 0
    buffer_load_dwordx4 v251, s[68:71], s91 offen offset:64 lds
L_nd47:
    v_add_f32 v178, v176, v96
    v_add_f32 v179, v177, v97
    v_exp_f32 v100, v84
    v_exp_f32 v101, v85
    v_mfma_f32_32x32x16_bf16 v[16:31], v[228:231], v[164:167], v[16:31]
    ds_read_b128 v[228:231], v248 offset:40960
    v_add_f32 v178, v178, v98
    v_add_f32 v179, v179, v99
    v_exp_f32 v102, v86
    v_exp_f32 v103, v87
    v_mfma_f32_32x32x16_bf16 v[32:47], v[232:235], v[164:167], v[32:47]
    ds_read_b128 v[232:235], v247 offset:45056
    s_cmp_ge_u32 s4, 4
    s_cbranch_scc1 L_nd48
    s_mov_b32 s91, 49152
    s_add_u32 m0, s11, 122752
    s_nop 0
    buffer_load_dwordx4 v251, s[68:71], s91 offen offset:128 lds
    s_mov_b32 s91, 49152
    s_add_u32 m0, s11, 126784
    s_nop 0
    buffer_load_dwordx4 v251, s[68:71], s91 offen offset:192 lds
L_nd48:
    v_add_f32 v178, v178, v100
    v_add_f32 v179, v179, v101
    v_exp_f32 v104, v88
    v_exp_f32 v105, v89
    v_mfma_f32_32x32x16_bf16 v[48:63], v[236:239], v[164:167], v[48:63]
    ds_read_b128 v[236:239], v248 offset:45056
    v_add_f32 v178, v178, v102
    v_add_f32 v179, v179, v103
    v_exp_f32 v106, v90
    v_exp_f32 v107, v91
    s_waitcnt lgkmcnt(4)
    v_mfma_f32_32x32x16_bf16 v[64:79], v[208:211], v[128:131], v[112:127]
    ds_read_b64_tr_b16 v[208:209], v180 offset:18432
    ds_read_b64_tr_b16 v[210:211], v180 offset:18944
    v_add_f32 v178, v178, v104
    v_add_f32 v179, v179, v105
    v_mfma_f32_32x32x16_bf16 v[64:79], v[212:215], v[132:135], v[64:79]
    ds_read_b64_tr_b16 v[212:213], v180 offset:22528
    ds_read_b64_tr_b16 v[214:215], v180 offset:23040
    v_exp_f32 v108, v92
    v_exp_f32 v109, v93
    v_add_f32 v178, v178, v106
    v_mfma_f32_32x32x16_bf16 v[64:79], v[216:219], v[136:139], v[64:79]
    ds_read_b64_tr_b16 v[216:217], v180 offset:26624
    ds_read_b64_tr_b16 v[218:219], v180 offset:27136
    v_add_f32 v179, v179, v107
    v_exp_f32 v110, v94
    v_mfma_f32_32x32x16_bf16 v[64:79], v[220:223], v[140:143], v[64:79]
    ds_read_b64_tr_b16 v[220:221], v180 offset:30720
    ds_read_b64_tr_b16 v[222:223], v180 offset:31232
    v_exp_f32 v111, v95
    v_add_f32 v178, v178, v108
    v_add_f32 v179, v179, v109
    s_waitcnt lgkmcnt(8)
    v_mfma_f32_32x32x16_bf16 v[64:79], v[224:227], v[144:147], v[64:79]
    ds_read_b64_tr_b16 v[224:225], v180 offset:19456
    ds_read_b64_tr_b16 v[226:227], v180 offset:19968
    v_add_f32 v178, v178, v110
    v_add_f32 v179, v179, v111
    v_add_f32 v182, v178, v179
    v_cmp_lt_f32 vcc, s90, v182
    s_nop 1
    s_cmp_lg_u64 vcc, 0
    s_cbranch_scc1 L_rare1
L_back1:
    v_mfma_f32_32x32x16_bf16 v[64:79], v[228:231], v[148:151], v[64:79]
    ds_read_b64_tr_b16 v[228:229], v180 offset:23552
    ds_read_b64_tr_b16 v[230:231], v180 offset:24064
    v_cvt_pk_bf16_f32 v168, v96, v97
    v_cvt_pk_bf16_f32 v169, v98, v99
    v_mfma_f32_32x32x16_bf16 v[64:79], v[232:235], v[152:155], v[64:79]
    ds_read_b64_tr_b16 v[232:233], v180 offset:27648
    ds_read_b64_tr_b16 v[234:235], v180 offset:28160
    v_cvt_pk_bf16_f32 v170, v100, v101
    v_cvt_pk_bf16_f32 v171, v102, v103
    v_cvt_pk_bf16_f32 v172, v104, v105
    v_mfma_f32_32x32x16_bf16 v[64:79], v[236:239], v[156:159], v[64:79]
    ds_read_b64_tr_b16 v[236:237], v180 offset:31744
    s_waitcnt lgkmcnt(14)
    ds_read_b64_tr_b16 v[238:239], v180 offset:32256
    v_cvt_pk_bf16_f32 v173, v106, v107
    v_cvt_pk_bf16_f32 v174, v108, v109
    v_cvt_pk_bf16_f32 v175, v110, v111
    s_waitcnt lgkmcnt(8)
    v_mfma_f32_32x32x16_bf16 v[0:15], v[208:211], v[168:171], v[0:15]
    ds_read_b128 v[208:211], v247 offset:34816
    v_mfma_f32_32x32x16_bf16 v[16:31], v[212:215], v[168:171], v[16:31]
    ds_read_b128 v[212:215], v248 offset:34816
    v_mfma_f32_32x32x16_bf16 v[32:47], v[216:219], v[168:171], v[32:47]
    ds_read_b128 v[216:219], v247 offset:38912
    v_mfma_f32_32x32x16_bf16 v[48:63], v[220:223], v[168:171], v[48:63]
    ds_read_b128 v[220:223], v248 offset:38912
    v_exp_f32 v96, v64
    v_exp_f32 v97, v65
    v_exp_f32 v98, v66
    v_exp_f32 v99, v67
    s_waitcnt lgkmcnt(4)
    v_mfma_f32_32x32x16_bf16 v[0:15], v[224:227], v[172:175], v[0:15]
    ds_read_b128 v[224:227], v247 offset:43008
    v_add_f32 v176, v178, v96
    v_add_f32 v177, v179, v97
    v_exp_f32 v100, v68
    v_exp_f32 v101, v69
    v_mfma_f32_32x32x16_bf16 v[16:31], v[228:231], v[172:175], v[16:31]
    ds_read_b128 v[228:231], v248 offset:43008
    v_add_f32 v176, v176, v98
    v_add_f32 v177, v177, v99
    v_exp_f32 v102, v70
    v_exp_f32 v103, v71
    v_mfma_f32_32x32x16_bf16 v[32:47], v[232:235], v[172:175], v[32:47]
    ds_read_b128 v[232:235], v247 offset:47104
    v_add_f32 v176, v176, v100
    v_add_f32 v177, v177, v101
    v_exp_f32 v104, v72
    v_exp_f32 v105, v73
    v_mfma_f32_32x32x16_bf16 v[48:63], v[236:239], v[172:175], v[48:63]
    ds_read_b128 v[236:239], v248 offset:47104
    v_add_f32 v176, v176, v102
    v_add_f32 v177, v177, v103
    v_exp_f32 v106, v74
    v_exp_f32 v107, v75
    s_waitcnt lgkmcnt(4)
    v_mfma_f32_32x32x16_bf16 v[80:95], v[208:211], v[128:131], v[112:127]
    ds_read_b64_tr_b16 v[208:209], v180 offset:49152
    ds_read_b64_tr_b16 v[210:211], v180 offset:49664
    v_add_f32 v176, v176, v104
    v_add_f32 v177, v177, v105
    v_mfma_f32_32x32x16_bf16 v[80:95], v[212:215], v[132:135], v[80:95]
    ds_read_b64_tr_b16 v[212:213], v180 offset:53248
    ds_read_b64_tr_b16 v[214:215], v180 offset:53760
    v_exp_f32 v108, v76
    v_exp_f32 v109, v77
    v_add_f32 v176, v176, v106
    v_mfma_f32_32x32x16_bf16 v[80:95], v[216:219], v[136:139], v[80:95]
    ds_read_b64_tr_b16 v[216:217], v180 offset:57344
    ds_read_b64_tr_b16 v[218:219], v180 offset:57856
    v_add_f32 v177, v177, v107
    v_exp_f32 v110, v78
    v_mfma_f32_32x32x16_bf16 v[80:95], v[220:223], v[140:143], v[80:95]
    ds_read_b64_tr_b16 v[220:221], v180 offset:61440
    ds_read_b64_tr_b16 v[222:223], v180 offset:61952
    v_exp_f32 v111, v79
    v_add_f32 v176, v176, v108
    v_add_f32 v177, v177, v109
    s_waitcnt lgkmcnt(8)
    v_mfma_f32_32x32x16_bf16 v[80:95], v[224:227], v[144:147], v[80:95]
    ds_read_b64_tr_b16 v[224:225], v180 offset:50176
    ds_read_b64_tr_b16 v[226:227], v180 offset:50688
    v_add_f32 v176, v176, v110
    v_add_f32 v177, v177, v111
    v_add_f32 v182, v176, v177
    v_cmp_lt_f32 vcc, s90, v182
    s_nop 1
    s_cmp_lg_u64 vcc, 0
    s_cbranch_scc1 L_rare2
L_back2:
    v_mfma_f32_32x32x16_bf16 v[80:95], v[228:231], v[148:151], v[80:95]
    ds_read_b64_tr_b16 v[228:229], v180 offset:54272
    ds_read_b64_tr_b16 v[230:231], v180 offset:54784
    v_cvt_pk_bf16_f32 v160, v96, v97
    v_cvt_pk_bf16_f32 v161, v98, v99
    v_mfma_f32_32x32x16_bf16 v[80:95], v[232:235], v[152:155], v[80:95]
    ds_read_b64_tr_b16 v[232:233], v180 offset:58368
    ds_read_b64_tr_b16 v[234:235], v180 offset:58880
    v_cvt_pk_bf16_f32 v162, v100, v101
    v_cvt_pk_bf16_f32 v163, v102, v103
    v_cvt_pk_bf16_f32 v164, v104, v105
    v_mfma_f32_32x32x16_bf16 v[80:95], v[236:239], v[156:159], v[80:95]
    ds_read_b64_tr_b16 v[236:237], v180 offset:62464
    s_waitcnt lgkmcnt(14)
    ds_read_b64_tr_b16 v[238:239], v180 offset:62976
    v_cvt_pk_bf16_f32 v165, v106, v107
    v_cvt_pk_bf16_f32 v166, v108, v109
    v_cvt_pk_bf16_f32 v167, v110, v111
    s_waitcnt lgkmcnt(8)
    v_mfma_f32_32x32x16_bf16 v[0:15], v[208:211], v[160:163], v[0:15]
    s_waitcnt vmcnt(10)
    s_barrier
    ds_read_b128 v[208:211], v242
    s_cmp_ge_u32 s4, 4
    s_cbranch_scc1 L_nd49
    s_mov_b32 s91, 65536
    s_add_u32 m0, s11, 0
    s_nop 0
    buffer_load_dwordx4 v244, s[44:47], s91 offen lds
    s_mov_b32 s91, 65536
    s_add_u32 m0, s11, 4032
    s_nop 0
    buffer_load_dwordx4 v244, s[44:47], s91 offen offset:64 lds
L_nd49:
    v_mfma_f32_32x32x16_bf16 v[16:31], v[212:215], v[160:163], v[16:31]
    ds_read_b128 v[212:215], v245
    v_mfma_f32_32x32x16_bf16 v[32:47], v[216:219], v[160:163], v[32:47]
    ds_read_b128 v[216:219], v242 offset:4096
    s_cmp_ge_u32 s4, 4
    s_cbranch_scc1 L_nd50
    s_mov_b32 s91, 65536
    s_add_u32 m0, s11, 8064
    s_nop 0
    buffer_load_dwordx4 v244, s[44:47], s91 offen offset:128 lds
    s_mov_b32 s91, 65536
    s_add_u32 m0, s11, 12096
    s_nop 0
    buffer_load_dwordx4 v244, s[44:47], s91 offen offset:192 lds
L_nd50:
    v_mfma_f32_32x32x16_bf16 v[48:63], v[220:223], v[160:163], v[48:63]
    ds_read_b128 v[220:223], v245 offset:4096
    v_exp_f32 v96, v80
    v_exp_f32 v97, v81
    v_exp_f32 v98, v82
    v_exp_f32 v99, v83
    s_waitcnt lgkmcnt(4)
    v_mfma_f32_32x32x16_bf16 v[0:15], v[224:227], v[164:167], v[0:15]
    ds_read_b128 v[224:227], v242 offset:8192
    s_cmp_ge_u32 s4, 4
    s_cbranch_scc1 L_nd51
    s_mov_b32 s91, 65536
    s_add_u32 m0, s11, 16384
    s_nop 0
    buffer_load_dwordx4 v251, s[68:71], s91 offen lds
    s_mov_b32 s91, 65536
    s_add_u32 m0, s11, 20416
    s_nop 0
    buffer_load_dwordx4 v251, s[68:71], s91 offen offset:64 lds
L_nd51:
    v_add_f32 v178, v176, v96
    v_add_f32 v179, v177, v97
    v_exp_f32 v100, v84
    v_exp_f32 v101, v85
    v_mfma_f32_32x32x16_bf16 v[16:31], v[228:231], v[164:167], v[16:31]
    ds_read_b128 v[228:231], v245 offset:8192
    v_add_f32 v178, v178, v98
    v_add_f32 v179, v179, v99
    v_exp_f32 v102, v86
    v_exp_f32 v103, v87
    v_mfma_f32_32x32x16_bf16 v[32:47], v[232:235], v[164:167], v[32:47]
    ds_read_b128 v[232:235], v242 offset:12288
    s_cmp_ge_u32 s4, 4
    s_cbranch_scc1 L_nd52
    s_mov_b32 s91, 65536
    s_add_u32 m0, s11, 24448
    s_nop 0
    buffer_load_dwordx4 v251, s[68:71], s91 offen offset:128 lds
    s_mov_b32 s91, 65536
    s_add_u32 m0, s11, 28480
    s_nop 0
    buffer_load_dwordx4 v251, s[68:71], s91 offen offset:192 lds
L_nd52:
    v_add_f32 v178, v178, v100
    v_add_f32 v179, v179, v101
    v_exp_f32 v104, v88
    v_exp_f32 v105, v89
    v_mfma_f32_32x32x16_bf16 v[48:63], v[236:239], v[164:167], v[48:63]
    ds_read_b128 v[236:239], v245 offset:12288
    v_add_f32 v178, v178, v102
    v_add_f32 v179, v179, v103
    v_exp_f32 v106, v90
    v_exp_f32 v107, v91
    s_waitcnt lgkmcnt(4)
    v_mfma_f32_32x32x16_bf16 v[64:79], v[208:211], v[128:131], v[112:127]
    ds_read_b64_tr_b16 v[208:209], v180 offset:51200
    ds_read_b64_tr_b16 v[210:211], v180 offset:51712
    v_add_f32 v178, v178, v104
    v_add_f32 v179, v179, v105
    v_mfma_f32_32x32x16_bf16 v[64:79], v[212:215], v[132:135], v[64:79]
    ds_read_b64_tr_b16 v[212:213], v180 offset:55296
    ds_read_b64_tr_b16 v[214:215], v180 offset:55808
    v_exp_f32 v108, v92
    v_exp_f32 v109, v93
    v_add_f32 v178, v178, v106
    v_mfma_f32_32x32x16_bf16 v[64:79], v[216:219], v[136:139], v[64:79]
    ds_read_b64_tr_b16 v[216:217], v180 offset:59392
    ds_read_b64_tr_b16 v[218:219], v180 offset:59904
    v_add_f32 v179, v179, v107
    v_exp_f32 v110, v94
    v_mfma_f32_32x32x16_bf16 v[64:79], v[220:223], v[140:143], v[64:79]
    ds_read_b64_tr_b16 v[220:221], v180 offset:63488
    ds_read_b64_tr_b16 v[222:223], v180 offset:64000
    v_exp_f32 v111, v95
    v_add_f32 v178, v178, v108
    v_add_f32 v179, v179, v109
    s_waitcnt lgkmcnt(8)
    v_mfma_f32_32x32x16_bf16 v[64:79], v[224:227], v[144:147], v[64:79]
    ds_read_b64_tr_b16 v[224:225], v180 offset:52224
    ds_read_b64_tr_b16 v[226:227], v180 offset:52736
    v_add_f32 v178, v178, v110
    v_add_f32 v179, v179, v111
    v_add_f32 v182, v178, v179
    v_cmp_lt_f32 vcc, s90, v182
    s_nop 1
    s_cmp_lg_u64 vcc, 0
    s_cbranch_scc1 L_rare3
L_back3:
    v_mfma_f32_32x32x16_bf16 v[64:79], v[228:231], v[148:151], v[64:79]
    ds_read_b64_tr_b16 v[228:229], v180 offset:56320
    ds_read_b64_tr_b16 v[230:231], v180 offset:56832
    v_cvt_pk_bf16_f32 v168, v96, v97
    v_cvt_pk_bf16_f32 v169, v98, v99
    v_mfma_f32_32x32x16_bf16 v[64:79], v[232:235], v[152:155], v[64:79]
    ds_read_b64_tr_b16 v[232:233], v180 offset:60416
    ds_read_b64_tr_b16 v[234:235], v180 offset:60928
    v_cvt_pk_bf16_f32 v170, v100, v101
    v_cvt_pk_bf16_f32 v171, v102, v103
    v_cvt_pk_bf16_f32 v172, v104, v105
    v_mfma_f32_32x32x16_bf16 v[64:79], v[236:239], v[156:159], v[64:79]
    ds_read_b64_tr_b16 v[236:237], v180 offset:64512
    s_waitcnt lgkmcnt(14)
    ds_read_b64_tr_b16 v[238:239], v180 offset:65024
    v_cvt_pk_bf16_f32 v173, v106, v107
    v_cvt_pk_bf16_f32 v174, v108, v109
    v_cvt_pk_bf16_f32 v175, v110, v111
    s_waitcnt lgkmcnt(8)
    v_mfma_f32_32x32x16_bf16 v[0:15], v[208:211], v[168:171], v[0:15]
    ds_read_b128 v[208:211], v242 offset:2048
    v_mfma_f32_32x32x16_bf16 v[16:31], v[212:215], v[168:171], v[16:31]
    ds_read_b128 v[212:215], v245 offset:2048
    v_mfma_f32_32x32x16_bf16 v[32:47], v[216:219], v[168:171], v[32:47]
    ds_read_b128 v[216:219], v242 offset:6144
    v_mfma_f32_32x32x16_bf16 v[48:63], v[220:223], v[168:171], v[48:63]
    ds_read_b128 v[220:223], v245 offset:6144
    v_exp_f32 v96, v64
    v_exp_f32 v97, v65
    v_exp_f32 v98, v66
    v_exp_f32 v99, v67
    s_waitcnt lgkmcnt(4)
    v_mfma_f32_32x32x16_bf16 v[0:15], v[224:227], v[172:175], v[0:15]
    ds_read_b128 v[224:227], v242 offset:10240
    v_add_f32 v176, v178, v96
    v_add_f32 v177, v179, v97
    v_exp_f32 v100, v68
    v_exp_f32 v101, v69
    v_mfma_f32_32x32x16_bf16 v[16:31], v[228:231], v[172:175], v[16:31]
    ds_read_b128 v[228:231], v245 offset:10240
    v_add_f32 v176, v176, v98
    v_add_f32 v177, v177, v99
    v_exp_f32 v102, v70
    v_exp_f32 v103, v71
    v_mfma_f32_32x32x16_bf16 v[32:47], v[232:235], v[172:175], v[32:47]
    ds_read_b128 v[232:235], v242 offset:14336
    v_add_f32 v176, v176, v100
    v_add_f32 v177, v177, v101
    v_exp_f32 v104, v72
    v_exp_f32 v105, v73
    v_mfma_f32_32x32x16_bf16 v[48:63], v[236:239], v[172:175], v[48:63]
    ds_read_b128 v[236:239], v245 offset:14336
    v_add_f32 v176, v176, v102
    v_add_f32 v177, v177, v103
    v_exp_f32 v106, v74
    v_exp_f32 v107, v75
    s_waitcnt lgkmcnt(4)
    v_mfma_f32_32x32x16_bf16 v[80:95], v[208:211], v[128:131], v[112:127]
    ds_read_b64_tr_b16 v[208:209], v181 offset:16384
    ds_read_b64_tr_b16 v[210:211], v181 offset:16896
    v_add_f32 v176, v176, v104
    v_add_f32 v177, v177, v105
    v_mfma_f32_32x32x16_bf16 v[80:95], v[212:215], v[132:135], v[80:95]
    ds_read_b64_tr_b16 v[212:213], v181 offset:20480
    ds_read_b64_tr_b16 v[214:215], v181 offset:20992
    v_exp_f32 v108, v76
    v_exp_f32 v109, v77
    v_add_f32 v176, v176, v106
    v_mfma_f32_32x32x16_bf16 v[80:95], v[216:219], v[136:139], v[80:95]
    ds_read_b64_tr_b16 v[216:217], v181 offset:24576
    ds_read_b64_tr_b16 v[218:219], v181 offset:25088
    v_add_f32 v177, v177, v107
    v_exp_f32 v110, v78
    v_mfma_f32_32x32x16_bf16 v[80:95], v[220:223], v[140:143], v[80:95]
    ds_read_b64_tr_b16 v[220:221], v181 offset:28672
    ds_read_b64_tr_b16 v[222:223], v181 offset:29184
    v_exp_f32 v111, v79
    v_add_f32 v176, v176, v108
    v_add_f32 v177, v177, v109
    s_waitcnt lgkmcnt(8)
    v_mfma_f32_32x32x16_bf16 v[80:95], v[224:227], v[144:147], v[80:95]
    ds_read_b64_tr_b16 v[224:225], v181 offset:17408
    ds_read_b64_tr_b16 v[226:227], v181 offset:17920
    v_add_f32 v176, v176, v110
    v_add_f32 v177, v177, v111
    v_add_f32 v182, v176, v177
    v_cmp_lt_f32 vcc, s90, v182
    s_nop 1
    s_cmp_lg_u64 vcc, 0
    s_cbranch_scc1 L_rare4
L_back4:
    v_mfma_f32_32x32x16_bf16 v[80:95], v[228:231], v[148:151], v[80:95]
    ds_read_b64_tr_b16 v[228:229], v181 offset:21504
    ds_read_b64_tr_b16 v[230:231], v181 offset:22016
    v_cvt_pk_bf16_f32 v160, v96, v97
    v_cvt_pk_bf16_f32 v161, v98, v99
    v_mfma_f32_32x32x16_bf16 v[80:95], v[232:235], v[152:155], v[80:95]
    ds_read_b64_tr_b16 v[232:233], v181 offset:25600
    ds_read_b64_tr_b16 v[234:235], v181 offset:26112
    v_cvt_pk_bf16_f32 v162, v100, v101
    v_cvt_pk_bf16_f32 v163, v102, v103
    v_cvt_pk_bf16_f32 v164, v104, v105
    v_mfma_f32_32x32x16_bf16 v[80:95], v[236:239], v[156:159], v[80:95]
    ds_read_b64_tr_b16 v[236:237], v181 offset:29696
    s_waitcnt lgkmcnt(14)
    ds_read_b64_tr_b16 v[238:239], v181 offset:30208
    v_cvt_pk_bf16_f32 v165, v106, v107
    v_cvt_pk_bf16_f32 v166, v108, v109
    v_cvt_pk_bf16_f32 v167, v110, v111
    s_waitcnt lgkmcnt(8)
    v_mfma_f32_32x32x16_bf16 v[0:15], v[208:211], v[160:163], v[0:15]
    s_waitcnt vmcnt(8)
    s_barrier
    ds_read_b128 v[208:211], v242 offset:32768
    s_cmp_ge_u32 s4, 4
    s_cbranch_scc1 L_nd53
    s_mov_b32 s91, 81920
    s_add_u32 m0, s11, 32768
    s_nop 0
    buffer_load_dwordx4 v244, s[44:47], s91 offen lds
    s_mov_b32 s91, 81920
    s_add_u32 m0, s11, 36800
    s_nop 0
    buffer_load_dwordx4 v244, s[44:47], s91 offen offset:64 lds
L_nd53:
    v_mfma_f32_32x32x16_bf16 v[16:31], v[212:215], v[160:163], v[16:31]
    ds_read_b128 v[212:215], v245 offset:32768
    v_mfma_f32_32x32x16_bf16 v[32:47], v[216:219], v[160:163], v[32:47]
    ds_read_b128 v[216:219], v242 offset:36864
    s_cmp_ge_u32 s4, 4
    s_cbranch_scc1 L_nd54
    s_mov_b32 s91, 81920
    s_add_u32 m0, s11, 40832
    s_nop 0
    buffer_load_dwordx4 v244, s[44:47], s91 offen offset:128 lds
    s_mov_b32 s91, 81920
    s_add_u32 m0, s11, 44864
    s_nop 0
    buffer_load_dwordx4 v244, s[44:47], s91 offen offset:192 lds
L_nd54:
    v_mfma_f32_32x32x16_bf16 v[48:63], v[220:223], v[160:163], v[48:63]
    ds_read_b128 v[220:223], v245 offset:36864
    v_exp_f32 v96, v80
    v_exp_f32 v97, v81
    v_exp_f32 v98, v82
    v_exp_f32 v99, v83
    s_waitcnt lgkmcnt(4)
    v_mfma_f32_32x32x16_bf16 v[0:15], v[224:227], v[164:167], v[0:15]
    ds_read_b128 v[224:227], v242 offset:40960
    s_cmp_ge_u32 s4, 4
    s_cbranch_scc1 L_nd55
    s_mov_b32 s91, 81920
    s_add_u32 m0, s11, 49152
    s_nop 0
    buffer_load_dwordx4 v251, s[68:71], s91 offen lds
    s_mov_b32 s91, 81920
    s_add_u32 m0, s11, 53184
    s_nop 0
    buffer_load_dwordx4 v251, s[68:71], s91 offen offset:64 lds
L_nd55:
    v_add_f32 v178, v176, v96
    v_add_f32 v179, v177, v97
    v_exp_f32 v100, v84
    v_exp_f32 v101, v85
    v_mfma_f32_32x32x16_bf16 v[16:31], v[228:231], v[164:167], v[16:31]
    ds_read_b128 v[228:231], v245 offset:40960
    v_add_f32 v178, v178, v98
    v_add_f32 v179, v179, v99
    v_exp_f32 v102, v86
    v_exp_f32 v103, v87
    v_mfma_f32_32x32x16_bf16 v[32:47], v[232:235], v[164:167], v[32:47]
    ds_read_b128 v[232:235], v242 offset:45056
    s_cmp_ge_u32 s4, 4
    s_cbranch_scc1 L_nd56
    s_mov_b32 s91, 81920
    s_add_u32 m0, s11, 57216
    s_nop 0
    buffer_load_dwordx4 v251, s[68:71], s91 offen offset:128 lds
    s_mov_b32 s91, 81920
    s_add_u32 m0, s11, 61248
    s_nop 0
    buffer_load_dwordx4 v251, s[68:71], s91 offen offset:192 lds
L_nd56:
    v_add_f32 v178, v178, v100
    v_add_f32 v179, v179, v101
    v_exp_f32 v104, v88
    v_exp_f32 v105, v89
    v_mfma_f32_32x32x16_bf16 v[48:63], v[236:239], v[164:167], v[48:63]
    ds_read_b128 v[236:239], v245 offset:45056
    v_add_f32 v178, v178, v102
    v_add_f32 v179, v179, v103
    v_exp_f32 v106, v90
    v_exp_f32 v107, v91
    s_waitcnt lgkmcnt(4)
    v_mfma_f32_32x32x16_bf16 v[64:79], v[208:211], v[128:131], v[112:127]
    ds_read_b64_tr_b16 v[208:209], v181 offset:18432
    ds_read_b64_tr_b16 v[210:211], v181 offset:18944
    v_add_f32 v178, v178, v104
    v_add_f32 v179, v179, v105
    v_mfma_f32_32x32x16_bf16 v[64:79], v[212:215], v[132:135], v[64:79]
    ds_read_b64_tr_b16 v[212:213], v181 offset:22528
    ds_read_b64_tr_b16 v[214:215], v181 offset:23040
    v_exp_f32 v108, v92
    v_exp_f32 v109, v93
    v_add_f32 v178, v178, v106
    v_mfma_f32_32x32x16_bf16 v[64:79], v[216:219], v[136:139], v[64:79]
    ds_read_b64_tr_b16 v[216:217], v181 offset:26624
    ds_read_b64_tr_b16 v[218:219], v181 offset:27136
    v_add_f32 v179, v179, v107
    v_exp_f32 v110, v94
    v_mfma_f32_32x32x16_bf16 v[64:79], v[220:223], v[140:143], v[64:79]
    ds_read_b64_tr_b16 v[220:221], v181 offset:30720
    ds_read_b64_tr_b16 v[222:223], v181 offset:31232
    v_exp_f32 v111, v95
    v_add_f32 v178, v178, v108
    v_add_f32 v179, v179, v109
    s_waitcnt lgkmcnt(8)
    v_mfma_f32_32x32x16_bf16 v[64:79], v[224:227], v[144:147], v[64:79]
    ds_read_b64_tr_b16 v[224:225], v181 offset:19456
    ds_read_b64_tr_b16 v[226:227], v181 offset:19968
    v_add_f32 v178, v178, v110
    v_add_f32 v179, v179, v111
    v_add_f32 v182, v178, v179
    v_cmp_lt_f32 vcc, s90, v182
    s_nop 1
    s_cmp_lg_u64 vcc, 0
    s_cbranch_scc1 L_rare5
L_back5:
    v_mfma_f32_32x32x16_bf16 v[64:79], v[228:231], v[148:151], v[64:79]
    ds_read_b64_tr_b16 v[228:229], v181 offset:23552
    ds_read_b64_tr_b16 v[230:231], v181 offset:24064
    v_cvt_pk_bf16_f32 v168, v96, v97
    v_cvt_pk_bf16_f32 v169, v98, v99
    v_mfma_f32_32x32x16_bf16 v[64:79], v[232:235], v[152:155], v[64:79]
    ds_read_b64_tr_b16 v[232:233], v181 offset:27648
    ds_read_b64_tr_b16 v[234:235], v181 offset:28160
    v_cvt_pk_bf16_f32 v170, v100, v101
    v_cvt_pk_bf16_f32 v171, v102, v103
    v_cvt_pk_bf16_f32 v172, v104, v105
    v_mfma_f32_32x32x16_bf16 v[64:79], v[236:239], v[156:159], v[64:79]
    ds_read_b64_tr_b16 v[236:237], v181 offset:31744
    s_waitcnt lgkmcnt(14)
    ds_read_b64_tr_b16 v[238:239], v181 offset:32256
    v_cvt_pk_bf16_f32 v173, v106, v107
    v_cvt_pk_bf16_f32 v174, v108, v109
    v_cvt_pk_bf16_f32 v175, v110, v111
    s_waitcnt lgkmcnt(8)
    v_mfma_f32_32x32x16_bf16 v[0:15], v[208:211], v[168:171], v[0:15]
    ds_read_b128 v[208:211], v242 offset:34816
    v_mfma_f32_32x32x16_bf16 v[16:31], v[212:215], v[168:171], v[16:31]
    ds_read_b128 v[212:215], v245 offset:34816
    v_mfma_f32_32x32x16_bf16 v[32:47], v[216:219], v[168:171], v[32:47]
    ds_read_b128 v[216:219], v242 offset:38912
    v_mfma_f32_32x32x16_bf16 v[48:63], v[220:223], v[168:171], v[48:63]
    ds_read_b128 v[220:223], v245 offset:38912
    v_exp_f32 v96, v64
    v_exp_f32 v97, v65
    v_exp_f32 v98, v66
    v_exp_f32 v99, v67
    s_waitcnt lgkmcnt(4)
    v_mfma_f32_32x32x16_bf16 v[0:15], v[224:227], v[172:175], v[0:15]
    ds_read_b128 v[224:227], v242 offset:43008
    v_add_f32 v176, v178, v96
    v_add_f32 v177, v179, v97
    v_exp_f32 v100, v68
    v_exp_f32 v101, v69
    v_mfma_f32_32x32x16_bf16 v[16:31], v[228:231], v[172:175], v[16:31]
    ds_read_b128 v[228:231], v245 offset:43008
    v_add_f32 v176, v176, v98
    v_add_f32 v177, v177, v99
    v_exp_f32 v102, v70
    v_exp_f32 v103, v71
    v_mfma_f32_32x32x16_bf16 v[32:47], v[232:235], v[172:175], v[32:47]
    ds_read_b128 v[232:235], v242 offset:47104
    v_add_f32 v176, v176, v100
    v_add_f32 v177, v177, v101
    v_exp_f32 v104, v72
    v_exp_f32 v105, v73
    v_mfma_f32_32x32x16_bf16 v[48:63], v[236:239], v[172:175], v[48:63]
    ds_read_b128 v[236:239], v245 offset:47104
    v_add_f32 v176, v176, v102
    v_add_f32 v177, v177, v103
    v_exp_f32 v106, v74
    v_exp_f32 v107, v75
    s_waitcnt lgkmcnt(4)
    v_mfma_f32_32x32x16_bf16 v[80:95], v[208:211], v[128:131], v[112:127]
    ds_read_b64_tr_b16 v[208:209], v181 offset:49152
    ds_read_b64_tr_b16 v[210:211], v181 offset:49664
    v_add_f32 v176, v176, v104
    v_add_f32 v177, v177, v105
    v_mfma_f32_32x32x16_bf16 v[80:95], v[212:215], v[132:135], v[80:95]
    ds_read_b64_tr_b16 v[212:213], v181 offset:53248
    ds_read_b64_tr_b16 v[214:215], v181 offset:53760
    v_exp_f32 v108, v76
    v_exp_f32 v109, v77
    v_add_f32 v176, v176, v106
    v_mfma_f32_32x32x16_bf16 v[80:95], v[216:219], v[136:139], v[80:95]
    ds_read_b64_tr_b16 v[216:217], v181 offset:57344
    ds_read_b64_tr_b16 v[218:219], v181 offset:57856
    v_add_f32 v177, v177, v107
    v_exp_f32 v110, v78
    v_mfma_f32_32x32x16_bf16 v[80:95], v[220:223], v[140:143], v[80:95]
    ds_read_b64_tr_b16 v[220:221], v181 offset:61440
    ds_read_b64_tr_b16 v[222:223], v181 offset:61952
    v_exp_f32 v111, v79
    v_add_f32 v176, v176, v108
    v_add_f32 v177, v177, v109
    s_waitcnt lgkmcnt(8)
    v_mfma_f32_32x32x16_bf16 v[80:95], v[224:227], v[144:147], v[80:95]
    ds_read_b64_tr_b16 v[224:225], v181 offset:50176
    ds_read_b64_tr_b16 v[226:227], v181 offset:50688
    v_add_f32 v176, v176, v110
    v_add_f32 v177, v177, v111
    v_add_f32 v182, v176, v177
    v_cmp_lt_f32 vcc, s90, v182
    s_nop 1
    s_cmp_lg_u64 vcc, 0
    s_cbranch_scc1 L_rare6
L_back6:
    v_mfma_f32_32x32x16_bf16 v[80:95], v[228:231], v[148:151], v[80:95]
    ds_read_b64_tr_b16 v[228:229], v181 offset:54272
    ds_read_b64_tr_b16 v[230:231], v181 offset:54784
    v_cvt_pk_bf16_f32 v160, v96, v97
    v_cvt_pk_bf16_f32 v161, v98, v99
    v_mfma_f32_32x32x16_bf16 v[80:95], v[232:235], v[152:155], v[80:95]
    ds_read_b64_tr_b16 v[232:233], v181 offset:58368
    ds_read_b64_tr_b16 v[234:235], v181 offset:58880
    v_cvt_pk_bf16_f32 v162, v100, v101
    v_cvt_pk_bf16_f32 v163, v102, v103
    v_cvt_pk_bf16_f32 v164, v104, v105
    v_mfma_f32_32x32x16_bf16 v[80:95], v[236:239], v[156:159], v[80:95]
    ds_read_b64_tr_b16 v[236:237], v181 offset:62464
    s_waitcnt lgkmcnt(14)
    ds_read_b64_tr_b16 v[238:239], v181 offset:62976
    v_cvt_pk_bf16_f32 v165, v106, v107
    v_cvt_pk_bf16_f32 v166, v108, v109
    v_cvt_pk_bf16_f32 v167, v110, v111
    s_waitcnt lgkmcnt(8)
    v_mfma_f32_32x32x16_bf16 v[0:15], v[208:211], v[160:163], v[0:15]
    s_waitcnt vmcnt(8)
    s_barrier
    ds_read_b128 v[208:211], v247
    s_cmp_ge_u32 s4, 4
    s_cbranch_scc1 L_nd57
    s_mov_b32 s91, 98304
    s_add_u32 m0, s11, 65536
    s_nop 0
    buffer_load_dwordx4 v244, s[44:47], s91 offen lds
    s_mov_b32 s91, 98304
    s_add_u32 m0, s11, 69568
    s_nop 0
    buffer_load_dwordx4 v244, s[44:47], s91 offen offset:64 lds
L_nd57:
    v_mfma_f32_32x32x16_bf16 v[16:31], v[212:215], v[160:163], v[16:31]
    ds_read_b128 v[212:215], v248
    v_mfma_f32_32x32x16_bf16 v[32:47], v[216:219], v[160:163], v[32:47]
    ds_read_b128 v[216:219], v247 offset:4096
    s_cmp_ge_u32 s4, 4
    s_cbranch_scc1 L_nd58
    s_mov_b32 s91, 98304
    s_add_u32 m0, s11, 73600
    s_nop 0
    buffer_load_dwordx4 v244, s[44:47], s91 offen offset:128 lds
    s_mov_b32 s91, 98304
    s_add_u32 m0, s11, 77632
    s_nop 0
    buffer_load_dwordx4 v244, s[44:47], s91 offen offset:192 lds
L_nd58:
    v_mfma_f32_32x32x16_bf16 v[48:63], v[220:223], v[160:163], v[48:63]
    ds_read_b128 v[220:223], v248 offset:4096
    v_exp_f32 v96, v80
    v_exp_f32 v97, v81
    v_exp_f32 v98, v82
    v_exp_f32 v99, v83
    s_waitcnt lgkmcnt(4)
    v_mfma_f32_32x32x16_bf16 v[0:15], v[224:227], v[164:167], v[0:15]
    ds_read_b128 v[224:227], v247 offset:8192
    s_cmp_ge_u32 s4, 4
    s_cbranch_scc1 L_nd59
    s_mov_b32 s91, 98304
    s_add_u32 m0, s11, 81920
    s_nop 0
    buffer_load_dwordx4 v251, s[68:71], s91 offen lds
    s_mov_b32 s91, 98304
    s_add_u32 m0, s11, 85952
    s_nop 0
    buffer_load_dwordx4 v251, s[68:71], s91 offen offset:64 lds
L_nd59:
    v_add_f32 v178, v176, v96
    v_add_f32 v179, v177, v97
    v_exp_f32 v100, v84
    v_exp_f32 v101, v85
    v_mfma_f32_32x32x16_bf16 v[16:31], v[228:231], v[164:167], v[16:31]
    ds_read_b128 v[228:231], v248 offset:8192
    v_add_f32 v178, v178, v98
    v_add_f32 v179, v179, v99
    v_exp_f32 v102, v86
    v_exp_f32 v103, v87
    v_mfma_f32_32x32x16_bf16 v[32:47], v[232:235], v[164:167], v[32:47]
    ds_read_b128 v[232:235], v247 offset:12288
    s_cmp_ge_u32 s4, 4
    s_cbranch_scc1 L_nd60
    s_mov_b32 s91, 98304
    s_add_u32 m0, s11, 89984
    s_nop 0
    buffer_load_dwordx4 v251, s[68:71], s91 offen offset:128 lds
    s_mov_b32 s91, 98304
    s_add_u32 m0, s11, 94016
    s_nop 0
    buffer_load_dwordx4 v251, s[68:71], s91 offen offset:192 lds
L_nd60:
    v_add_f32 v178, v178, v100
    v_add_f32 v179, v179, v101
    v_exp_f32 v104, v88
    v_exp_f32 v105, v89
    v_mfma_f32_32x32x16_bf16 v[48:63], v[236:239], v[164:167], v[48:63]
    ds_read_b128 v[236:239], v248 offset:12288
    v_add_f32 v178, v178, v102
    v_add_f32 v179, v179, v103
    v_exp_f32 v106, v90
    v_exp_f32 v107, v91
    s_waitcnt lgkmcnt(4)
    v_mfma_f32_32x32x16_bf16 v[64:79], v[208:211], v[128:131], v[112:127]
    ds_read_b64_tr_b16 v[208:209], v181 offset:51200
    ds_read_b64_tr_b16 v[210:211], v181 offset:51712
    v_add_f32 v178, v178, v104
    v_add_f32 v179, v179, v105
    v_mfma_f32_32x32x16_bf16 v[64:79], v[212:215], v[132:135], v[64:79]
    ds_read_b64_tr_b16 v[212:213], v181 offset:55296
    ds_read_b64_tr_b16 v[214:215], v181 offset:55808
    v_exp_f32 v108, v92
    v_exp_f32 v109, v93
    v_add_f32 v178, v178, v106
    v_mfma_f32_32x32x16_bf16 v[64:79], v[216:219], v[136:139], v[64:79]
    ds_read_b64_tr_b16 v[216:217], v181 offset:59392
    ds_read_b64_tr_b16 v[218:219], v181 offset:59904
    v_add_f32 v179, v179, v107
    v_exp_f32 v110, v94
    v_mfma_f32_32x32x16_bf16 v[64:79], v[220:223], v[140:143], v[64:79]
    ds_read_b64_tr_b16 v[220:221], v181 offset:63488
    ds_read_b64_tr_b16 v[222:223], v181 offset:64000
    v_exp_f32 v111, v95
    v_add_f32 v178, v178, v108
    v_add_f32 v179, v179, v109
    s_waitcnt lgkmcnt(8)
    v_mfma_f32_32x32x16_bf16 v[64:79], v[224:227], v[144:147], v[64:79]
    ds_read_b64_tr_b16 v[224:225], v181 offset:52224
    ds_read_b64_tr_b16 v[226:227], v181 offset:52736
    v_add_f32 v178, v178, v110
    v_add_f32 v179, v179, v111
    v_add_f32 v182, v178, v179
    v_cmp_lt_f32 vcc, s90, v182
    s_nop 1
    s_cmp_lg_u64 vcc, 0
    s_cbranch_scc1 L_rare7
L_back7:
    v_mfma_f32_32x32x16_bf16 v[64:79], v[228:231], v[148:151], v[64:79]
    ds_read_b64_tr_b16 v[228:229], v181 offset:56320
    ds_read_b64_tr_b16 v[230:231], v181 offset:56832
    v_cvt_pk_bf16_f32 v168, v96, v97
    v_cvt_pk_bf16_f32 v169, v98, v99
    v_mfma_f32_32x32x16_bf16 v[64:79], v[232:235], v[152:155], v[64:79]
    ds_read_b64_tr_b16 v[232:233], v181 offset:60416
    ds_read_b64_tr_b16 v[234:235], v181 offset:60928
    v_cvt_pk_bf16_f32 v170, v100, v101
    v_cvt_pk_bf16_f32 v171, v102, v103
    v_cvt_pk_bf16_f32 v172, v104, v105
    v_mfma_f32_32x32x16_bf16 v[64:79], v[236:239], v[156:159], v[64:79]
    ds_read_b64_tr_b16 v[236:237], v181 offset:64512
    s_waitcnt lgkmcnt(14)
    ds_read_b64_tr_b16 v[238:239], v181 offset:65024
    v_cvt_pk_bf16_f32 v173, v106, v107
    v_cvt_pk_bf16_f32 v174, v108, v109
    v_cvt_pk_bf16_f32 v175, v110, v111
    s_waitcnt lgkmcnt(8)
    v_mfma_f32_32x32x16_bf16 v[0:15], v[208:211], v[168:171], v[0:15]
    ds_read_b128 v[208:211], v247 offset:2048
    v_mfma_f32_32x32x16_bf16 v[16:31], v[212:215], v[168:171], v[16:31]
    ds_read_b128 v[212:215], v248 offset:2048
    v_mfma_f32_32x32x16_bf16 v[32:47], v[216:219], v[168:171], v[32:47]
    ds_read_b128 v[216:219], v247 offset:6144
    v_mfma_f32_32x32x16_bf16 v[48:63], v[220:223], v[168:171], v[48:63]
    ds_read_b128 v[220:223], v248 offset:6144
    v_exp_f32 v96, v64
    v_exp_f32 v97, v65
    v_exp_f32 v98, v66
    v_exp_f32 v99, v67
    s_waitcnt lgkmcnt(4)
    v_mfma_f32_32x32x16_bf16 v[0:15], v[224:227], v[172:175], v[0:15]
    ds_read_b128 v[224:227], v247 offset:10240
    v_add_f32 v176, v178, v96
    v_add_f32 v177, v179, v97
    v_exp_f32 v100, v68
    v_exp_f32 v101, v69
    v_mfma_f32_32x32x16_bf16 v[16:31], v[228:231], v[172:175], v[16:31]
    ds_read_b128 v[228:231], v248 offset:10240
    v_add_f32 v176, v176, v98
    v_add_f32 v177, v177, v99
    v_exp_f32 v102, v70
    v_exp_f32 v103, v71
    v_mfma_f32_32x32x16_bf16 v[32:47], v[232:235], v[172:175], v[32:47]
    ds_read_b128 v[232:235], v247 offset:14336
    v_add_f32 v176, v176, v100
    v_add_f32 v177, v177, v101
    v_exp_f32 v104, v72
    v_exp_f32 v105, v73
    v_mfma_f32_32x32x16_bf16 v[48:63], v[236:239], v[172:175], v[48:63]
    ds_read_b128 v[236:239], v248 offset:14336
    v_add_f32 v176, v176, v102
    v_add_f32 v177, v177, v103
    v_exp_f32 v106, v74
    v_exp_f32 v107, v75
    s_waitcnt lgkmcnt(4)
    v_mfma_f32_32x32x16_bf16 v[80:95], v[208:211], v[128:131], v[112:127]
    ds_read_b64_tr_b16 v[208:209], v180 offset:16384
    ds_read_b64_tr_b16 v[210:211], v180 offset:16896
    v_add_f32 v176, v176, v104
    v_add_f32 v177, v177, v105
    v_mfma_f32_32x32x16_bf16 v[80:95], v[212:215], v[132:135], v[80:95]
    ds_read_b64_tr_b16 v[212:213], v180 offset:20480
    ds_read_b64_tr_b16 v[214:215], v180 offset:20992
    v_exp_f32 v108, v76
    v_exp_f32 v109, v77
    v_add_f32 v176, v176, v106
    v_mfma_f32_32x32x16_bf16 v[80:95], v[216:219], v[136:139], v[80:95]
    ds_read_b64_tr_b16 v[216:217], v180 offset:24576
    ds_read_b64_tr_b16 v[218:219], v180 offset:25088
    v_add_f32 v177, v177, v107
    v_exp_f32 v110, v78
    v_mfma_f32_32x32x16_bf16 v[80:95], v[220:223], v[140:143], v[80:95]
    ds_read_b64_tr_b16 v[220:221], v180 offset:28672
    ds_read_b64_tr_b16 v[222:223], v180 offset:29184
    v_exp_f32 v111, v79
    v_add_f32 v176, v176, v108
    v_add_f32 v177, v177, v109
    s_waitcnt lgkmcnt(8)
    v_mfma_f32_32x32x16_bf16 v[80:95], v[224:227], v[144:147], v[80:95]
    ds_read_b64_tr_b16 v[224:225], v180 offset:17408
    ds_read_b64_tr_b16 v[226:227], v180 offset:17920
    v_add_f32 v176, v176, v110
    v_add_f32 v177, v177, v111
    v_add_f32 v182, v176, v177
    v_cmp_lt_f32 vcc, s90, v182
    s_nop 1
    s_cmp_lg_u64 vcc, 0
    s_cbranch_scc1 L_rare8
L_back8:
    v_mfma_f32_32x32x16_bf16 v[80:95], v[228:231], v[148:151], v[80:95]
    ds_read_b64_tr_b16 v[228:229], v180 offset:21504
    ds_read_b64_tr_b16 v[230:231], v180 offset:22016
    v_cvt_pk_bf16_f32 v160, v96, v97
    v_cvt_pk_bf16_f32 v161, v98, v99
    v_mfma_f32_32x32x16_bf16 v[80:95], v[232:235], v[152:155], v[80:95]
    ds_read_b64_tr_b16 v[232:233], v180 offset:25600
    ds_read_b64_tr_b16 v[234:235], v180 offset:26112
    v_cvt_pk_bf16_f32 v162, v100, v101
    v_cvt_pk_bf16_f32 v163, v102, v103
    v_cvt_pk_bf16_f32 v164, v104, v105
    v_mfma_f32_32x32x16_bf16 v[80:95], v[236:239], v[156:159], v[80:95]
    ds_read_b64_tr_b16 v[236:237], v180 offset:29696
    s_waitcnt lgkmcnt(14)
    ds_read_b64_tr_b16 v[238:239], v180 offset:30208
    v_cvt_pk_bf16_f32 v165, v106, v107
    v_cvt_pk_bf16_f32 v166, v108, v109
    v_cvt_pk_bf16_f32 v167, v110, v111
    s_waitcnt lgkmcnt(8)
    v_mfma_f32_32x32x16_bf16 v[0:15], v[208:211], v[160:163], v[0:15]
    s_waitcnt vmcnt(8)
    s_barrier
    ds_read_b128 v[208:211], v247 offset:32768
    s_cmp_ge_u32 s4, 4
    s_cbranch_scc1 L_nd61
    s_mov_b32 s91, 114688
    s_add_u32 m0, s11, 98304
    s_nop 0
    buffer_load_dwordx4 v244, s[44:47], s91 offen lds
    s_mov_b32 s91, 114688
    s_add_u32 m0, s11, 102336
    s_nop 0
    buffer_load_dwordx4 v244, s[44:47], s91 offen offset:64 lds
L_nd61:
    v_mfma_f32_32x32x16_bf16 v[16:31], v[212:215], v[160:163], v[16:31]
    ds_read_b128 v[212:215], v248 offset:32768
    v_mfma_f32_32x32x16_bf16 v[32:47], v[216:219], v[160:163], v[32:47]
    ds_read_b128 v[216:219], v247 offset:36864
    s_cmp_ge_u32 s4, 4
    s_cbranch_scc1 L_nd62
    s_mov_b32 s91, 114688
    s_add_u32 m0, s11, 106368
    s_nop 0
    buffer_load_dwordx4 v244, s[44:47], s91 offen offset:128 lds
    s_mov_b32 s91, 114688
    s_add_u32 m0, s11, 110400
    s_nop 0
    buffer_load_dwordx4 v244, s[44:47], s91 offen offset:192 lds
L_nd62:
    v_mfma_f32_32x32x16_bf16 v[48:63], v[220:223], v[160:163], v[48:63]
    ds_read_b128 v[220:223], v248 offset:36864
    v_exp_f32 v96, v80
    v_exp_f32 v97, v81
    v_exp_f32 v98, v82
    v_exp_f32 v99, v83
    s_waitcnt lgkmcnt(4)
    v_mfma_f32_32x32x16_bf16 v[0:15], v[224:227], v[164:167], v[0:15]
    ds_read_b128 v[224:227], v247 offset:40960
    s_cmp_ge_u32 s4, 4
    s_cbranch_scc1 L_nd63
    s_mov_b32 s91, 114688
    s_add_u32 m0, s11, 114688
    s_nop 0
    buffer_load_dwordx4 v251, s[68:71], s91 offen lds
    s_mov_b32 s91, 114688
    s_add_u32 m0, s11, 118720
    s_nop 0
    buffer_load_dwordx4 v251, s[68:71], s91 offen offset:64 lds
L_nd63:
    v_add_f32 v178, v176, v96
    v_add_f32 v179, v177, v97
    v_exp_f32 v100, v84
    v_exp_f32 v101, v85
    v_mfma_f32_32x32x16_bf16 v[16:31], v[228:231], v[164:167], v[16:31]
    ds_read_b128 v[228:231], v248 offset:40960
    v_add_f32 v178, v178, v98
    v_add_f32 v179, v179, v99
    v_exp_f32 v102, v86
    v_exp_f32 v103, v87
    v_mfma_f32_32x32x16_bf16 v[32:47], v[232:235], v[164:167], v[32:47]
    ds_read_b128 v[232:235], v247 offset:45056
    s_cmp_ge_u32 s4, 4
    s_cbranch_scc1 L_nd64
    s_mov_b32 s91, 114688
    s_add_u32 m0, s11, 122752
    s_nop 0
    buffer_load_dwordx4 v251, s[68:71], s91 offen offset:128 lds
    s_mov_b32 s91, 114688
    s_add_u32 m0, s11, 126784
    s_nop 0
    buffer_load_dwordx4 v251, s[68:71], s91 offen offset:192 lds
L_nd64:
    v_add_f32 v178, v178, v100
    v_add_f32 v179, v179, v101
    v_exp_f32 v104, v88
    v_exp_f32 v105, v89
    v_mfma_f32_32x32x16_bf16 v[48:63], v[236:239], v[164:167], v[48:63]
    ds_read_b128 v[236:239], v248 offset:45056
    v_add_f32 v178, v178, v102
    v_add_f32 v179, v179, v103
    v_exp_f32 v106, v90
    v_exp_f32 v107, v91
    s_waitcnt lgkmcnt(4)
    v_mfma_f32_32x32x16_bf16 v[64:79], v[208:211], v[128:131], v[112:127]
    ds_read_b64_tr_b16 v[208:209], v180 offset:18432
    ds_read_b64_tr_b16 v[210:211], v180 offset:18944
    v_add_f32 v178, v178, v104
    v_add_f32 v179, v179, v105
    v_mfma_f32_32x32x16_bf16 v[64:79], v[212:215], v[132:135], v[64:79]
    ds_read_b64_tr_b16 v[212:213], v180 offset:22528
    ds_read_b64_tr_b16 v[214:215], v180 offset:23040
    v_exp_f32 v108, v92
    v_exp_f32 v109, v93
    v_add_f32 v178, v178, v106
    v_mfma_f32_32x32x16_bf16 v[64:79], v[216:219], v[136:139], v[64:79]
    ds_read_b64_tr_b16 v[216:217], v180 offset:26624
    ds_read_b64_tr_b16 v[218:219], v180 offset:27136
    v_add_f32 v179, v179, v107
    v_exp_f32 v110, v94
    v_mfma_f32_32x32x16_bf16 v[64:79], v[220:223], v[140:143], v[64:79]
    ds_read_b64_tr_b16 v[220:221], v180 offset:30720
    ds_read_b64_tr_b16 v[222:223], v180 offset:31232
    v_exp_f32 v111, v95
    v_add_f32 v178, v178, v108
    v_add_f32 v179, v179, v109
    s_waitcnt lgkmcnt(8)
    v_mfma_f32_32x32x16_bf16 v[64:79], v[224:227], v[144:147], v[64:79]
    ds_read_b64_tr_b16 v[224:225], v180 offset:19456
    ds_read_b64_tr_b16 v[226:227], v180 offset:19968
    v_add_f32 v178, v178, v110
    v_add_f32 v179, v179, v111
    v_add_f32 v182, v178, v179
    v_cmp_lt_f32 vcc, s90, v182
    s_nop 1
    s_cmp_lg_u64 vcc, 0
    s_cbranch_scc1 L_rare9
L_back9:
    v_mfma_f32_32x32x16_bf16 v[64:79], v[228:231], v[148:151], v[64:79]
    ds_read_b64_tr_b16 v[228:229], v180 offset:23552
    ds_read_b64_tr_b16 v[230:231], v180 offset:24064
    v_cvt_pk_bf16_f32 v168, v96, v97
    v_cvt_pk_bf16_f32 v169, v98, v99
    v_mfma_f32_32x32x16_bf16 v[64:79], v[232:235], v[152:155], v[64:79]
    ds_read_b64_tr_b16 v[232:233], v180 offset:27648
    ds_read_b64_tr_b16 v[234:235], v180 offset:28160
    v_cvt_pk_bf16_f32 v170, v100, v101
    v_cvt_pk_bf16_f32 v171, v102, v103
    v_cvt_pk_bf16_f32 v172, v104, v105
    v_mfma_f32_32x32x16_bf16 v[64:79], v[236:239], v[156:159], v[64:79]
    ds_read_b64_tr_b16 v[236:237], v180 offset:31744
    s_waitcnt lgkmcnt(14)
    ds_read_b64_tr_b16 v[238:239], v180 offset:32256
    v_cvt_pk_bf16_f32 v173, v106, v107
    v_cvt_pk_bf16_f32 v174, v108, v109
    v_cvt_pk_bf16_f32 v175, v110, v111
    s_waitcnt lgkmcnt(8)
    v_mfma_f32_32x32x16_bf16 v[0:15], v[208:211], v[168:171], v[0:15]
    ds_read_b128 v[208:211], v247 offset:34816
    v_mfma_f32_32x32x16_bf16 v[16:31], v[212:215], v[168:171], v[16:31]
    ds_read_b128 v[212:215], v248 offset:34816
    v_mfma_f32_32x32x16_bf16 v[32:47], v[216:219], v[168:171], v[32:47]
    ds_read_b128 v[216:219], v247 offset:38912
    v_mfma_f32_32x32x16_bf16 v[48:63], v[220:223], v[168:171], v[48:63]
    ds_read_b128 v[220:223], v248 offset:38912
    v_exp_f32 v96, v64
    v_exp_f32 v97, v65
    v_exp_f32 v98, v66
    v_exp_f32 v99, v67
    s_waitcnt lgkmcnt(4)
    v_mfma_f32_32x32x16_bf16 v[0:15], v[224:227], v[172:175], v[0:15]
    ds_read_b128 v[224:227], v247 offset:43008
    v_add_f32 v176, v178, v96
    v_add_f32 v177, v179, v97
    v_exp_f32 v100, v68
    v_exp_f32 v101, v69
    v_mfma_f32_32x32x16_bf16 v[16:31], v[228:231], v[172:175], v[16:31]
    ds_read_b128 v[228:231], v248 offset:43008
    v_add_f32 v176, v176, v98
    v_add_f32 v177, v177, v99
    v_exp_f32 v102, v70
    v_exp_f32 v103, v71
    v_mfma_f32_32x32x16_bf16 v[32:47], v[232:235], v[172:175], v[32:47]
    ds_read_b128 v[232:235], v247 offset:47104
    v_add_f32 v176, v176, v100
    v_add_f32 v177, v177, v101
    v_exp_f32 v104, v72
    v_exp_f32 v105, v73
    v_mfma_f32_32x32x16_bf16 v[48:63], v[236:239], v[172:175], v[48:63]
    ds_read_b128 v[236:239], v248 offset:47104
    v_add_f32 v176, v176, v102
    v_add_f32 v177, v177, v103
    v_exp_f32 v106, v74
    v_exp_f32 v107, v75
    s_waitcnt lgkmcnt(4)
    v_mfma_f32_32x32x16_bf16 v[80:95], v[208:211], v[128:131], v[112:127]
    ds_read_b64_tr_b16 v[208:209], v180 offset:49152
    ds_read_b64_tr_b16 v[210:211], v180 offset:49664
    v_add_f32 v176, v176, v104
    v_add_f32 v177, v177, v105
    v_mfma_f32_32x32x16_bf16 v[80:95], v[212:215], v[132:135], v[80:95]
    ds_read_b64_tr_b16 v[212:213], v180 offset:53248
    ds_read_b64_tr_b16 v[214:215], v180 offset:53760
    v_exp_f32 v108, v76
    v_exp_f32 v109, v77
    v_add_f32 v176, v176, v106
    v_mfma_f32_32x32x16_bf16 v[80:95], v[216:219], v[136:139], v[80:95]
    ds_read_b64_tr_b16 v[216:217], v180 offset:57344
    ds_read_b64_tr_b16 v[218:219], v180 offset:57856
    v_add_f32 v177, v177, v107
    v_exp_f32 v110, v78
    v_mfma_f32_32x32x16_bf16 v[80:95], v[220:223], v[140:143], v[80:95]
    ds_read_b64_tr_b16 v[220:221], v180 offset:61440
    ds_read_b64_tr_b16 v[222:223], v180 offset:61952
    v_exp_f32 v111, v79
    v_add_f32 v176, v176, v108
    v_add_f32 v177, v177, v109
    s_waitcnt lgkmcnt(8)
    v_mfma_f32_32x32x16_bf16 v[80:95], v[224:227], v[144:147], v[80:95]
    ds_read_b64_tr_b16 v[224:225], v180 offset:50176
    ds_read_b64_tr_b16 v[226:227], v180 offset:50688
    v_add_f32 v176, v176, v110
    v_add_f32 v177, v177, v111
    v_add_f32 v182, v176, v177
    v_cmp_lt_f32 vcc, s90, v182
    s_nop 1
    s_cmp_lg_u64 vcc, 0
    s_cbranch_scc1 L_rare10
L_back10:
    v_mfma_f32_32x32x16_bf16 v[80:95], v[228:231], v[148:151], v[80:95]
    ds_read_b64_tr_b16 v[228:229], v180 offset:54272
    ds_read_b64_tr_b16 v[230:231], v180 offset:54784
    v_cvt_pk_bf16_f32 v160, v96, v97
    v_cvt_pk_bf16_f32 v161, v98, v99
    v_mfma_f32_32x32x16_bf16 v[80:95], v[232:235], v[152:155], v[80:95]
    ds_read_b64_tr_b16 v[232:233], v180 offset:58368
    ds_read_b64_tr_b16 v[234:235], v180 offset:58880
    v_cvt_pk_bf16_f32 v162, v100, v101
    v_cvt_pk_bf16_f32 v163, v102, v103
    v_cvt_pk_bf16_f32 v164, v104, v105
    v_mfma_f32_32x32x16_bf16 v[80:95], v[236:239], v[156:159], v[80:95]
    ds_read_b64_tr_b16 v[236:237], v180 offset:62464
    s_waitcnt lgkmcnt(14)
    ds_read_b64_tr_b16 v[238:239], v180 offset:62976
    v_cvt_pk_bf16_f32 v165, v106, v107
    v_cvt_pk_bf16_f32 v166, v108, v109
    v_cvt_pk_bf16_f32 v167, v110, v111
    s_waitcnt lgkmcnt(8)
    v_mfma_f32_32x32x16_bf16 v[0:15], v[208:211], v[160:163], v[0:15]
    s_waitcnt vmcnt(8)
    s_barrier
    ds_read_b128 v[208:211], v242
    v_mfma_f32_32x32x16_bf16 v[16:31], v[212:215], v[160:163], v[16:31]
    ds_read_b128 v[212:215], v245
    v_mfma_f32_32x32x16_bf16 v[32:47], v[216:219], v[160:163], v[32:47]
    ds_read_b128 v[216:219], v242 offset:4096
    v_mfma_f32_32x32x16_bf16 v[48:63], v[220:223], v[160:163], v[48:63]
    ds_read_b128 v[220:223], v245 offset:4096
    v_exp_f32 v96, v80
    v_exp_f32 v97, v81
    v_exp_f32 v98, v82
    v_exp_f32 v99, v83
    s_waitcnt lgkmcnt(4)
    v_mfma_f32_32x32x16_bf16 v[0:15], v[224:227], v[164:167], v[0:15]
    ds_read_b128 v[224:227], v242 offset:8192
    v_add_f32 v178, v176, v96
    v_add_f32 v179, v177, v97
    v_exp_f32 v100, v84
    v_exp_f32 v101, v85
    v_mfma_f32_32x32x16_bf16 v[16:31], v[228:231], v[164:167], v[16:31]
    ds_read_b128 v[228:231], v245 offset:8192
    v_add_f32 v178, v178, v98
    v_add_f32 v179, v179, v99
    v_exp_f32 v102, v86
    v_exp_f32 v103, v87
    v_mfma_f32_32x32x16_bf16 v[32:47], v[232:235], v[164:167], v[32:47]
    ds_read_b128 v[232:235], v242 offset:12288
    v_add_f32 v178, v178, v100
    v_add_f32 v179, v179, v101
    v_exp_f32 v104, v88
    v_exp_f32 v105, v89
    v_mfma_f32_32x32x16_bf16 v[48:63], v[236:239], v[164:167], v[48:63]
    ds_read_b128 v[236:239], v245 offset:12288
    v_add_f32 v178, v178, v102
    v_add_f32 v179, v179, v103
    v_exp_f32 v106, v90
    v_exp_f32 v107, v91
    s_waitcnt lgkmcnt(4)
    v_mfma_f32_32x32x16_bf16 v[64:79], v[208:211], v[128:131], v[112:127]
    ds_read_b64_tr_b16 v[208:209], v180 offset:51200
    ds_read_b64_tr_b16 v[210:211], v180 offset:51712
    v_add_f32 v178, v178, v104
    v_add_f32 v179, v179, v105
    v_mfma_f32_32x32x16_bf16 v[64:79], v[212:215], v[132:135], v[64:79]
    ds_read_b64_tr_b16 v[212:213], v180 offset:55296
    ds_read_b64_tr_b16 v[214:215], v180 offset:55808
    v_exp_f32 v108, v92
    v_exp_f32 v109, v93
    v_add_f32 v178, v178, v106
    v_mfma_f32_32x32x16_bf16 v[64:79], v[216:219], v[136:139], v[64:79]
    ds_read_b64_tr_b16 v[216:217], v180 offset:59392
    ds_read_b64_tr_b16 v[218:219], v180 offset:59904
    v_add_f32 v179, v179, v107
    v_exp_f32 v110, v94
    v_mfma_f32_32x32x16_bf16 v[64:79], v[220:223], v[140:143], v[64:79]
    ds_read_b64_tr_b16 v[220:221], v180 offset:63488
    ds_read_b64_tr_b16 v[222:223], v180 offset:64000
    v_exp_f32 v111, v95
    v_add_f32 v178, v178, v108
    v_add_f32 v179, v179, v109
    s_waitcnt lgkmcnt(8)
    v_mfma_f32_32x32x16_bf16 v[64:79], v[224:227], v[144:147], v[64:79]
    ds_read_b64_tr_b16 v[224:225], v180 offset:52224
    ds_read_b64_tr_b16 v[226:227], v180 offset:52736
    v_add_f32 v178, v178, v110
    v_add_f32 v179, v179, v111
    v_add_f32 v182, v178, v179
    v_cmp_lt_f32 vcc, s90, v182
    s_nop 1
    s_cmp_lg_u64 vcc, 0
    s_cbranch_scc1 L_rare11
L_back11:
    v_mfma_f32_32x32x16_bf16 v[64:79], v[228:231], v[148:151], v[64:79]
    ds_read_b64_tr_b16 v[228:229], v180 offset:56320
    ds_read_b64_tr_b16 v[230:231], v180 offset:56832
    v_cvt_pk_bf16_f32 v168, v96, v97
    v_cvt_pk_bf16_f32 v169, v98, v99
    v_mfma_f32_32x32x16_bf16 v[64:79], v[232:235], v[152:155], v[64:79]
    ds_read_b64_tr_b16 v[232:233], v180 offset:60416
    ds_read_b64_tr_b16 v[234:235], v180 offset:60928
    v_cvt_pk_bf16_f32 v170, v100, v101
    v_cvt_pk_bf16_f32 v171, v102, v103
    v_cvt_pk_bf16_f32 v172, v104, v105
    v_mfma_f32_32x32x16_bf16 v[64:79], v[236:239], v[156:159], v[64:79]
    ds_read_b64_tr_b16 v[236:237], v180 offset:64512
    s_waitcnt lgkmcnt(14)
    ds_read_b64_tr_b16 v[238:239], v180 offset:65024
    v_cvt_pk_bf16_f32 v173, v106, v107
    v_cvt_pk_bf16_f32 v174, v108, v109
    v_cvt_pk_bf16_f32 v175, v110, v111
    s_waitcnt lgkmcnt(8)
    v_mfma_f32_32x32x16_bf16 v[0:15], v[208:211], v[168:171], v[0:15]
    ds_read_b128 v[208:211], v242 offset:2048
    v_mfma_f32_32x32x16_bf16 v[16:31], v[212:215], v[168:171], v[16:31]
    ds_read_b128 v[212:215], v245 offset:2048
    v_mfma_f32_32x32x16_bf16 v[32:47], v[216:219], v[168:171], v[32:47]
    ds_read_b128 v[216:219], v242 offset:6144
    v_mfma_f32_32x32x16_bf16 v[48:63], v[220:223], v[168:171], v[48:63]
    ds_read_b128 v[220:223], v245 offset:6144
    v_exp_f32 v96, v64
    v_exp_f32 v97, v65
    v_exp_f32 v98, v66
    v_exp_f32 v99, v67
    s_waitcnt lgkmcnt(4)
    v_mfma_f32_32x32x16_bf16 v[0:15], v[224:227], v[172:175], v[0:15]
    ds_read_b128 v[224:227], v242 offset:10240
    v_add_f32 v176, v178, v96
    v_add_f32 v177, v179, v97
    v_exp_f32 v100, v68
    v_exp_f32 v101, v69
    v_mfma_f32_32x32x16_bf16 v[16:31], v[228:231], v[172:175], v[16:31]
    ds_read_b128 v[228:231], v245 offset:10240
    v_add_f32 v176, v176, v98
    v_add_f32 v177, v177, v99
    v_exp_f32 v102, v70
    v_exp_f32 v103, v71
    v_mfma_f32_32x32x16_bf16 v[32:47], v[232:235], v[172:175], v[32:47]
    ds_read_b128 v[232:235], v242 offset:14336
    v_add_f32 v176, v176, v100
    v_add_f32 v177, v177, v101
    v_exp_f32 v104, v72
    v_exp_f32 v105, v73
    v_mfma_f32_32x32x16_bf16 v[48:63], v[236:239], v[172:175], v[48:63]
    ds_read_b128 v[236:239], v245 offset:14336
    v_add_f32 v176, v176, v102
    v_add_f32 v177, v177, v103
    v_exp_f32 v106, v74
    v_exp_f32 v107, v75
    s_waitcnt lgkmcnt(4)
    v_mfma_f32_32x32x16_bf16 v[80:95], v[208:211], v[128:131], v[112:127]
    ds_read_b64_tr_b16 v[208:209], v181 offset:16384
    ds_read_b64_tr_b16 v[210:211], v181 offset:16896
    v_add_f32 v176, v176, v104
    v_add_f32 v177, v177, v105
    v_mfma_f32_32x32x16_bf16 v[80:95], v[212:215], v[132:135], v[80:95]
    ds_read_b64_tr_b16 v[212:213], v181 offset:20480
    ds_read_b64_tr_b16 v[214:215], v181 offset:20992
    v_exp_f32 v108, v76
    v_exp_f32 v109, v77
    v_add_f32 v176, v176, v106
    v_mfma_f32_32x32x16_bf16 v[80:95], v[216:219], v[136:139], v[80:95]
    ds_read_b64_tr_b16 v[216:217], v181 offset:24576
    ds_read_b64_tr_b16 v[218:219], v181 offset:25088
    v_add_f32 v177, v177, v107
    v_exp_f32 v110, v78
    v_mfma_f32_32x32x16_bf16 v[80:95], v[220:223], v[140:143], v[80:95]
    ds_read_b64_tr_b16 v[220:221], v181 offset:28672
    ds_read_b64_tr_b16 v[222:223], v181 offset:29184
    v_exp_f32 v111, v79
    v_add_f32 v176, v176, v108
    v_add_f32 v177, v177, v109
    s_waitcnt lgkmcnt(8)
    v_mfma_f32_32x32x16_bf16 v[80:95], v[224:227], v[144:147], v[80:95]
    ds_read_b64_tr_b16 v[224:225], v181 offset:17408
    ds_read_b64_tr_b16 v[226:227], v181 offset:17920
    v_add_f32 v176, v176, v110
    v_add_f32 v177, v177, v111
    v_add_f32 v182, v176, v177
    v_cmp_lt_f32 vcc, s90, v182
    s_nop 1
    s_cmp_lg_u64 vcc, 0
    s_cbranch_scc1 L_rare12
L_back12:
    v_mfma_f32_32x32x16_bf16 v[80:95], v[228:231], v[148:151], v[80:95]
    ds_read_b64_tr_b16 v[228:229], v181 offset:21504
    ds_read_b64_tr_b16 v[230:231], v181 offset:22016
    v_cvt_pk_bf16_f32 v160, v96, v97
    v_cvt_pk_bf16_f32 v161, v98, v99
    v_mfma_f32_32x32x16_bf16 v[80:95], v[232:235], v[152:155], v[80:95]
    ds_read_b64_tr_b16 v[232:233], v181 offset:25600
    ds_read_b64_tr_b16 v[234:235], v181 offset:26112
    v_cvt_pk_bf16_f32 v162, v100, v101
    v_cvt_pk_bf16_f32 v163, v102, v103
    v_cvt_pk_bf16_f32 v164, v104, v105
    v_mfma_f32_32x32x16_bf16 v[80:95], v[236:239], v[156:159], v[80:95]
    ds_read_b64_tr_b16 v[236:237], v181 offset:29696
    s_waitcnt lgkmcnt(14)
    ds_read_b64_tr_b16 v[238:239], v181 offset:30208
    v_cvt_pk_bf16_f32 v165, v106, v107
    v_cvt_pk_bf16_f32 v166, v108, v109
    v_cvt_pk_bf16_f32 v167, v110, v111
    s_waitcnt lgkmcnt(8)
    v_mfma_f32_32x32x16_bf16 v[0:15], v[208:211], v[160:163], v[0:15]
    s_waitcnt vmcnt(0)
    s_barrier
    ds_read_b128 v[208:211], v242 offset:32768
    v_mfma_f32_32x32x16_bf16 v[16:31], v[212:215], v[160:163], v[16:31]
    ds_read_b128 v[212:215], v245 offset:32768
    v_mfma_f32_32x32x16_bf16 v[32:47], v[216:219], v[160:163], v[32:47]
    ds_read_b128 v[216:219], v242 offset:36864
    v_mfma_f32_32x32x16_bf16 v[48:63], v[220:223], v[160:163], v[48:63]
    ds_read_b128 v[220:223], v245 offset:36864
    v_exp_f32 v96, v80
    v_exp_f32 v97, v81
    v_exp_f32 v98, v82
    v_exp_f32 v99, v83
    s_waitcnt lgkmcnt(4)
    v_mfma_f32_32x32x16_bf16 v[0:15], v[224:227], v[164:167], v[0:15]
    ds_read_b128 v[224:227], v242 offset:40960
    v_add_f32 v178, v176, v96
    v_add_f32 v179, v177, v97
    v_exp_f32 v100, v84
    v_exp_f32 v101, v85
    v_mfma_f32_32x32x16_bf16 v[16:31], v[228:231], v[164:167], v[16:31]
    ds_read_b128 v[228:231], v245 offset:40960
    v_add_f32 v178, v178, v98
    v_add_f32 v179, v179, v99
    v_exp_f32 v102, v86
    v_exp_f32 v103, v87
    v_mfma_f32_32x32x16_bf16 v[32:47], v[232:235], v[164:167], v[32:47]
    ds_read_b128 v[232:235], v242 offset:45056
    v_add_f32 v178, v178, v100
    v_add_f32 v179, v179, v101
    v_exp_f32 v104, v88
    v_exp_f32 v105, v89
    v_mfma_f32_32x32x16_bf16 v[48:63], v[236:239], v[164:167], v[48:63]
    ds_read_b128 v[236:239], v245 offset:45056
    v_add_f32 v178, v178, v102
    v_add_f32 v179, v179, v103
    v_exp_f32 v106, v90
    v_exp_f32 v107, v91
    s_waitcnt lgkmcnt(4)
    v_mfma_f32_32x32x16_bf16 v[64:79], v[208:211], v[128:131], v[112:127]
    ds_read_b64_tr_b16 v[208:209], v181 offset:18432
    ds_read_b64_tr_b16 v[210:211], v181 offset:18944
    v_add_f32 v178, v178, v104
    v_add_f32 v179, v179, v105
    v_mfma_f32_32x32x16_bf16 v[64:79], v[212:215], v[132:135], v[64:79]
    ds_read_b64_tr_b16 v[212:213], v181 offset:22528
    ds_read_b64_tr_b16 v[214:215], v181 offset:23040
    v_exp_f32 v108, v92
    v_exp_f32 v109, v93
    v_add_f32 v178, v178, v106
    v_mfma_f32_32x32x16_bf16 v[64:79], v[216:219], v[136:139], v[64:79]
    ds_read_b64_tr_b16 v[216:217], v181 offset:26624
    ds_read_b64_tr_b16 v[218:219], v181 offset:27136
    v_add_f32 v179, v179, v107
    v_exp_f32 v110, v94
    v_mfma_f32_32x32x16_bf16 v[64:79], v[220:223], v[140:143], v[64:79]
    ds_read_b64_tr_b16 v[220:221], v181 offset:30720
    ds_read_b64_tr_b16 v[222:223], v181 offset:31232
    v_exp_f32 v111, v95
    v_add_f32 v178, v178, v108
    v_add_f32 v179, v179, v109
    s_waitcnt lgkmcnt(8)
    v_mfma_f32_32x32x16_bf16 v[64:79], v[224:227], v[144:147], v[64:79]
    ds_read_b64_tr_b16 v[224:225], v181 offset:19456
    ds_read_b64_tr_b16 v[226:227], v181 offset:19968
    v_add_f32 v178, v178, v110
    v_add_f32 v179, v179, v111
    v_add_f32 v182, v178, v179
    v_cmp_lt_f32 vcc, s90, v182
    s_nop 1
    s_cmp_lg_u64 vcc, 0
    s_cbranch_scc1 L_rare13
L_back13:
    v_mfma_f32_32x32x16_bf16 v[64:79], v[228:231], v[148:151], v[64:79]
    ds_read_b64_tr_b16 v[228:229], v181 offset:23552
    ds_read_b64_tr_b16 v[230:231], v181 offset:24064
    v_cvt_pk_bf16_f32 v168, v96, v97
    v_cvt_pk_bf16_f32 v169, v98, v99
    v_mfma_f32_32x32x16_bf16 v[64:79], v[232:235], v[152:155], v[64:79]
    ds_read_b64_tr_b16 v[232:233], v181 offset:27648
    ds_read_b64_tr_b16 v[234:235], v181 offset:28160
    v_cvt_pk_bf16_f32 v170, v100, v101
    v_cvt_pk_bf16_f32 v171, v102, v103
    v_cvt_pk_bf16_f32 v172, v104, v105
    v_mfma_f32_32x32x16_bf16 v[64:79], v[236:239], v[156:159], v[64:79]
    ds_read_b64_tr_b16 v[236:237], v181 offset:31744
    s_waitcnt lgkmcnt(14)
    ds_read_b64_tr_b16 v[238:239], v181 offset:32256
    v_cvt_pk_bf16_f32 v173, v106, v107
    v_cvt_pk_bf16_f32 v174, v108, v109
    v_cvt_pk_bf16_f32 v175, v110, v111
    s_waitcnt lgkmcnt(8)
    v_mfma_f32_32x32x16_bf16 v[0:15], v[208:211], v[168:171], v[0:15]
    ds_read_b128 v[208:211], v242 offset:34816
    v_mfma_f32_32x32x16_bf16 v[16:31], v[212:215], v[168:171], v[16:31]
    ds_read_b128 v[212:215], v245 offset:34816
    v_mfma_f32_32x32x16_bf16 v[32:47], v[216:219], v[168:171], v[32:47]
    ds_read_b128 v[216:219], v242 offset:38912
    v_mfma_f32_32x32x16_bf16 v[48:63], v[220:223], v[168:171], v[48:63]
    ds_read_b128 v[220:223], v245 offset:38912
    v_exp_f32 v96, v64
    v_exp_f32 v97, v65
    v_exp_f32 v98, v66
    v_exp_f32 v99, v67
    s_waitcnt lgkmcnt(4)
    v_mfma_f32_32x32x16_bf16 v[0:15], v[224:227], v[172:175], v[0:15]
    ds_read_b128 v[224:227], v242 offset:43008
    v_add_f32 v176, v178, v96
    v_add_f32 v177, v179, v97
    v_exp_f32 v100, v68
    v_exp_f32 v101, v69
    v_mfma_f32_32x32x16_bf16 v[16:31], v[228:231], v[172:175], v[16:31]
    ds_read_b128 v[228:231], v245 offset:43008
    v_add_f32 v176, v176, v98
    v_add_f32 v177, v177, v99
    v_exp_f32 v102, v70
    v_exp_f32 v103, v71
    v_mfma_f32_32x32x16_bf16 v[32:47], v[232:235], v[172:175], v[32:47]
    ds_read_b128 v[232:235], v242 offset:47104
    v_add_f32 v176, v176, v100
    v_add_f32 v177, v177, v101
    v_exp_f32 v104, v72
    v_exp_f32 v105, v73
    v_mfma_f32_32x32x16_bf16 v[48:63], v[236:239], v[172:175], v[48:63]
    ds_read_b128 v[236:239], v245 offset:47104
    v_add_f32 v176, v176, v102
    v_add_f32 v177, v177, v103
    v_exp_f32 v106, v74
    v_exp_f32 v107, v75
    s_waitcnt lgkmcnt(4)
    v_mfma_f32_32x32x16_bf16 v[80:95], v[208:211], v[128:131], v[112:127]
    ds_read_b64_tr_b16 v[208:209], v181 offset:49152
    ds_read_b64_tr_b16 v[210:211], v181 offset:49664
    v_add_f32 v176, v176, v104
    v_add_f32 v177, v177, v105
    v_mfma_f32_32x32x16_bf16 v[80:95], v[212:215], v[132:135], v[80:95]
    ds_read_b64_tr_b16 v[212:213], v181 offset:53248
    ds_read_b64_tr_b16 v[214:215], v181 offset:53760
    v_exp_f32 v108, v76
    v_exp_f32 v109, v77
    v_add_f32 v176, v176, v106
    v_mfma_f32_32x32x16_bf16 v[80:95], v[216:219], v[136:139], v[80:95]
    ds_read_b64_tr_b16 v[216:217], v181 offset:57344
    ds_read_b64_tr_b16 v[218:219], v181 offset:57856
    v_add_f32 v177, v177, v107
    v_exp_f32 v110, v78
    v_mfma_f32_32x32x16_bf16 v[80:95], v[220:223], v[140:143], v[80:95]
    ds_read_b64_tr_b16 v[220:221], v181 offset:61440
    ds_read_b64_tr_b16 v[222:223], v181 offset:61952
    v_exp_f32 v111, v79
    v_add_f32 v176, v176, v108
    v_add_f32 v177, v177, v109
    s_waitcnt lgkmcnt(8)
    v_mfma_f32_32x32x16_bf16 v[80:95], v[224:227], v[144:147], v[80:95]
    ds_read_b64_tr_b16 v[224:225], v181 offset:50176
    ds_read_b64_tr_b16 v[226:227], v181 offset:50688
    v_add_f32 v176, v176, v110
    v_add_f32 v177, v177, v111
    v_add_f32 v182, v176, v177
    v_cmp_lt_f32 vcc, s90, v182
    s_nop 1
    s_cmp_lg_u64 vcc, 0
    s_cbranch_scc1 L_rare14
L_back14:
    v_mfma_f32_32x32x16_bf16 v[80:95], v[228:231], v[148:151], v[80:95]
    ds_read_b64_tr_b16 v[228:229], v181 offset:54272
    ds_read_b64_tr_b16 v[230:231], v181 offset:54784
    v_cvt_pk_bf16_f32 v160, v96, v97
    v_cvt_pk_bf16_f32 v161, v98, v99
    v_mfma_f32_32x32x16_bf16 v[80:95], v[232:235], v[152:155], v[80:95]
    ds_read_b64_tr_b16 v[232:233], v181 offset:58368
    ds_read_b64_tr_b16 v[234:235], v181 offset:58880
    v_cvt_pk_bf16_f32 v162, v100, v101
    v_cvt_pk_bf16_f32 v163, v102, v103
    v_cvt_pk_bf16_f32 v164, v104, v105
    v_mfma_f32_32x32x16_bf16 v[80:95], v[236:239], v[156:159], v[80:95]
    ds_read_b64_tr_b16 v[236:237], v181 offset:62464
    s_waitcnt lgkmcnt(14)
    ds_read_b64_tr_b16 v[238:239], v181 offset:62976
    v_cvt_pk_bf16_f32 v165, v106, v107
    v_cvt_pk_bf16_f32 v166, v108, v109
    v_cvt_pk_bf16_f32 v167, v110, v111
    s_waitcnt lgkmcnt(8)
    v_mfma_f32_32x32x16_bf16 v[0:15], v[208:211], v[160:163], v[0:15]
    ds_read_b64_tr_b16 v[208:209], v181 offset:51200
    ds_read_b64_tr_b16 v[210:211], v181 offset:51712
    v_mfma_f32_32x32x16_bf16 v[16:31], v[212:215], v[160:163], v[16:31]
    ds_read_b64_tr_b16 v[212:213], v181 offset:55296
    ds_read_b64_tr_b16 v[214:215], v181 offset:55808
    v_mfma_f32_32x32x16_bf16 v[32:47], v[216:219], v[160:163], v[32:47]
    ds_read_b64_tr_b16 v[216:217], v181 offset:59392
    ds_read_b64_tr_b16 v[218:219], v181 offset:59904
    v_mfma_f32_32x32x16_bf16 v[48:63], v[220:223], v[160:163], v[48:63]
    ds_read_b64_tr_b16 v[220:221], v181 offset:63488
    s_waitcnt lgkmcnt(14)
    ds_read_b64_tr_b16 v[222:223], v181 offset:64000
    v_exp_f32 v96, v80
    v_exp_f32 v97, v81
    v_exp_f32 v98, v82
    v_exp_f32 v99, v83
    s_waitcnt lgkmcnt(8)
    v_mfma_f32_32x32x16_bf16 v[0:15], v[224:227], v[164:167], v[0:15]
    ds_read_b64_tr_b16 v[224:225], v181 offset:52224
    ds_read_b64_tr_b16 v[226:227], v181 offset:52736
    v_add_f32 v178, v176, v96
    v_add_f32 v179, v177, v97
    v_exp_f32 v100, v84
    v_exp_f32 v101, v85
    v_mfma_f32_32x32x16_bf16 v[16:31], v[228:231], v[164:167], v[16:31]
    ds_read_b64_tr_b16 v[228:229], v181 offset:56320
    ds_read_b64_tr_b16 v[230:231], v181 offset:56832
    v_add_f32 v178, v178, v98
    v_add_f32 v179, v179, v99
    v_exp_f32 v102, v86
    v_exp_f32 v103, v87
    v_mfma_f32_32x32x16_bf16 v[32:47], v[232:235], v[164:167], v[32:47]
    ds_read_b64_tr_b16 v[232:233], v181 offset:60416
    ds_read_b64_tr_b16 v[234:235], v181 offset:60928
    v_add_f32 v178, v178, v100
    v_add_f32 v179, v179, v101
    v_exp_f32 v104, v88
    v_exp_f32 v105, v89
    v_mfma_f32_32x32x16_bf16 v[48:63], v[236:239], v[164:167], v[48:63]
    ds_read_b64_tr_b16 v[236:237], v181 offset:64512
    s_waitcnt lgkmcnt(14)
    ds_read_b64_tr_b16 v[238:239], v181 offset:65024
    v_add_f32 v178, v178, v102
    v_add_f32 v179, v179, v103
    v_exp_f32 v106, v90
    v_exp_f32 v107, v91
    v_add_f32 v178, v178, v104
    v_add_f32 v179, v179, v105
    v_exp_f32 v108, v92
    v_exp_f32 v109, v93
    v_add_f32 v178, v178, v106
    v_add_f32 v179, v179, v107
    v_exp_f32 v110, v94
    v_exp_f32 v111, v95
    v_add_f32 v178, v178, v108
    v_add_f32 v179, v179, v109
    v_add_f32 v178, v178, v110
    v_add_f32 v179, v179, v111
    v_add_f32 v182, v178, v179
    v_cmp_lt_f32 vcc, s90, v182
    s_nop 1
    s_cmp_lg_u64 vcc, 0
    s_cbranch_scc1 L_rare15
L_back15:
    v_cvt_pk_bf16_f32 v168, v96, v97
    v_cvt_pk_bf16_f32 v169, v98, v99
    v_cvt_pk_bf16_f32 v170, v100, v101
    v_cvt_pk_bf16_f32 v171, v102, v103
    v_cvt_pk_bf16_f32 v172, v104, v105
    v_cvt_pk_bf16_f32 v173, v106, v107
    v_cvt_pk_bf16_f32 v174, v108, v109
    v_cvt_pk_bf16_f32 v175, v110, v111
    s_waitcnt lgkmcnt(8)
    v_mfma_f32_32x32x16_bf16 v[0:15], v[208:211], v[168:171], v[0:15]
    v_mfma_f32_32x32x16_bf16 v[16:31], v[212:215], v[168:171], v[16:31]
    v_mfma_f32_32x32x16_bf16 v[32:47], v[216:219], v[168:171], v[32:47]
    v_mfma_f32_32x32x16_bf16 v[48:63], v[220:223], v[168:171], v[48:63]
    s_waitcnt lgkmcnt(0)
    v_mfma_f32_32x32x16_bf16 v[0:15], v[224:227], v[172:175], v[0:15]
    v_mfma_f32_32x32x16_bf16 v[16:31], v[228:231], v[172:175], v[16:31]
    v_mfma_f32_32x32x16_bf16 v[32:47], v[232:235], v[172:175], v[32:47]
    v_mfma_f32_32x32x16_bf16 v[48:63], v[236:239], v[172:175], v[48:63]
    v_add_f32 v182, v178, v179
    v_mov_b32 v183, v182
    s_nop 1
    v_permlane32_swap_b32 v182, v183
    v_add_f32 v182, v182, v183
    v_rcp_f32 v182, v182
    s_lshl_b32 s8, s5, 13
    s_add_u32 s8, s8, s84
    s_add_u32 s9, s8, 4096
    v_mul_f32 v0, v0, v182
    v_mul_f32 v1, v1, v182
    v_mul_f32 v2, v2, v182
    v_mul_f32 v3, v3, v182
    v_mul_f32 v4, v4, v182
    v_mul_f32 v5, v5, v182
    v_mul_f32 v6, v6, v182
    v_mul_f32 v7, v7, v182
    v_mul_f32 v8, v8, v182
    v_mul_f32 v9, v9, v182
    v_mul_f32 v10, v10, v182
    v_mul_f32 v11, v11, v182
    v_mul_f32 v12, v12, v182
    v_mul_f32 v13, v13, v182
    v_mul_f32 v14, v14, v182
    v_mul_f32 v15, v15, v182
    v_cvt_pk_bf16_f32 v64, v0, v1
    v_cvt_pk_bf16_f32 v65, v2, v3
    v_cvt_pk_bf16_f32 v66, v4, v5
    v_cvt_pk_bf16_f32 v67, v6, v7
    v_cvt_pk_bf16_f32 v68, v8, v9
    v_cvt_pk_bf16_f32 v69, v10, v11
    v_cvt_pk_bf16_f32 v70, v12, v13
    v_cvt_pk_bf16_f32 v71, v14, v15
    buffer_store_dwordx4 v[64:67], v241, s[60:63], s8 offen
    buffer_store_dwordx4 v[68:71], v241, s[60:63], s8 offen offset:1024
    v_mul_f32 v16, v16, v182
    v_mul_f32 v17, v17, v182
    v_mul_f32 v18, v18, v182
    v_mul_f32 v19, v19, v182
    v_mul_f32 v20, v20, v182
    v_mul_f32 v21, v21, v182
    v_mul_f32 v22, v22, v182
    v_mul_f32 v23, v23, v182
    v_mul_f32 v24, v24, v182
    v_mul_f32 v25, v25, v182
    v_mul_f32 v26, v26, v182
    v_mul_f32 v27, v27, v182
    v_mul_f32 v28, v28, v182
    v_mul_f32 v29, v29, v182
    v_mul_f32 v30, v30, v182
    v_mul_f32 v31, v31, v182
    v_cvt_pk_bf16_f32 v72, v16, v17
    v_cvt_pk_bf16_f32 v73, v18, v19
    v_cvt_pk_bf16_f32 v74, v20, v21
    v_cvt_pk_bf16_f32 v75, v22, v23
    v_cvt_pk_bf16_f32 v76, v24, v25
    v_cvt_pk_bf16_f32 v77, v26, v27
    v_cvt_pk_bf16_f32 v78, v28, v29
    v_cvt_pk_bf16_f32 v79, v30, v31
    buffer_store_dwordx4 v[72:75], v241, s[60:63], s8 offen offset:2048
    buffer_store_dwordx4 v[76:79], v241, s[60:63], s8 offen offset:3072
    v_mul_f32 v32, v32, v182
    v_mul_f32 v33, v33, v182
    v_mul_f32 v34, v34, v182
    v_mul_f32 v35, v35, v182
    v_mul_f32 v36, v36, v182
    v_mul_f32 v37, v37, v182
    v_mul_f32 v38, v38, v182
    v_mul_f32 v39, v39, v182
    v_mul_f32 v40, v40, v182
    v_mul_f32 v41, v41, v182
    v_mul_f32 v42, v42, v182
    v_mul_f32 v43, v43, v182
    v_mul_f32 v44, v44, v182
    v_mul_f32 v45, v45, v182
    v_mul_f32 v46, v46, v182
    v_mul_f32 v47, v47, v182
    v_cvt_pk_bf16_f32 v80, v32, v33
    v_cvt_pk_bf16_f32 v81, v34, v35
    v_cvt_pk_bf16_f32 v82, v36, v37
    v_cvt_pk_bf16_f32 v83, v38, v39
    v_cvt_pk_bf16_f32 v84, v40, v41
    v_cvt_pk_bf16_f32 v85, v42, v43
    v_cvt_pk_bf16_f32 v86, v44, v45
    v_cvt_pk_bf16_f32 v87, v46, v47
    buffer_store_dwordx4 v[80:83], v241, s[60:63], s9 offen
    buffer_store_dwordx4 v[84:87], v241, s[60:63], s9 offen offset:1024
    v_mul_f32 v48, v48, v182
    v_mul_f32 v49, v49, v182
    v_mul_f32 v50, v50, v182
    v_mul_f32 v51, v51, v182
    v_mul_f32 v52, v52, v182
    v_mul_f32 v53, v53, v182
    v_mul_f32 v54, v54, v182
    v_mul_f32 v55, v55, v182
    v_mul_f32 v56, v56, v182
    v_mul_f32 v57, v57, v182
    v_mul_f32 v58, v58, v182
    v_mul_f32 v59, v59, v182
    v_mul_f32 v60, v60, v182
    v_mul_f32 v61, v61, v182
    v_mul_f32 v62, v62, v182
    v_mul_f32 v63, v63, v182
    v_cvt_pk_bf16_f32 v88, v48, v49
    v_cvt_pk_bf16_f32 v89, v50, v51
    v_cvt_pk_bf16_f32 v90, v52, v53
    v_cvt_pk_bf16_f32 v91, v54, v55
    v_cvt_pk_bf16_f32 v92, v56, v57
    v_cvt_pk_bf16_f32 v93, v58, v59
    v_cvt_pk_bf16_f32 v94, v60, v61
    v_cvt_pk_bf16_f32 v95, v62, v63
    buffer_store_dwordx4 v[88:91], v241, s[60:63], s9 offen offset:2048
    buffer_store_dwordx4 v[92:95], v241, s[60:63], s9 offen offset:3072
L_attn_end:
    s_endpgm
L_rare0:
    s_nop 15
    s_nop 15
    v_max3_f32 v182, v64, v65, v66
    v_max3_f32 v182, v67, v68, v182
    v_max3_f32 v182, v69, v70, v182
    v_max3_f32 v182, v71, v72, v182
    v_max3_f32 v182, v73, v74, v182
    v_max3_f32 v182, v75, v76, v182
    v_max3_f32 v182, v77, v78, v182
    v_max_f32 v182, v182, v79
    v_mov_b32 v183, v182
    s_nop 3
    v_permlane32_swap_b32 v182, v183
    s_nop 3
    v_max3_f32 v182, v182, v183, 0
    v_sub_f32 v183, 0, v182
    v_exp_f32 v183, v183
    s_nop 3
    v_mul_f32 v0, v0, v183
    v_mul_f32 v1, v1, v183
    v_mul_f32 v2, v2, v183
    v_mul_f32 v3, v3, v183
    v_mul_f32 v4, v4, v183
    v_mul_f32 v5, v5, v183
    v_mul_f32 v6, v6, v183
    v_mul_f32 v7, v7, v183
    v_mul_f32 v8, v8, v183
    v_mul_f32 v9, v9, v183
    v_mul_f32 v10, v10, v183
    v_mul_f32 v11, v11, v183
    v_mul_f32 v12, v12, v183
    v_mul_f32 v13, v13, v183
    v_mul_f32 v14, v14, v183
    v_mul_f32 v15, v15, v183
    v_mul_f32 v16, v16, v183
    v_mul_f32 v17, v17, v183
    v_mul_f32 v18, v18, v183
    v_mul_f32 v19, v19, v183
    v_mul_f32 v20, v20, v183
    v_mul_f32 v21, v21, v183
    v_mul_f32 v22, v22, v183
    v_mul_f32 v23, v23, v183
    v_mul_f32 v24, v24, v183
    v_mul_f32 v25, v25, v183
    v_mul_f32 v26, v26, v183
    v_mul_f32 v27, v27, v183
    v_mul_f32 v28, v28, v183
    v_mul_f32 v29, v29, v183
    v_mul_f32 v30, v30, v183
    v_mul_f32 v31, v31, v183
    v_mul_f32 v32, v32, v183
    v_mul_f32 v33, v33, v183
    v_mul_f32 v34, v34, v183
    v_mul_f32 v35, v35, v183
    v_mul_f32 v36, v36, v183
    v_mul_f32 v37, v37, v183
    v_mul_f32 v38, v38, v183
    v_mul_f32 v39, v39, v183
    v_mul_f32 v40, v40, v183
    v_mul_f32 v41, v41, v183
    v_mul_f32 v42, v42, v183
    v_mul_f32 v43, v43, v183
    v_mul_f32 v44, v44, v183
    v_mul_f32 v45, v45, v183
    v_mul_f32 v46, v46, v183
    v_mul_f32 v47, v47, v183
    v_mul_f32 v48, v48, v183
    v_mul_f32 v49, v49, v183
    v_mul_f32 v50, v50, v183
    v_mul_f32 v51, v51, v183
    v_mul_f32 v52, v52, v183
    v_mul_f32 v53, v53, v183
    v_mul_f32 v54, v54, v183
    v_mul_f32 v55, v55, v183
    v_mul_f32 v56, v56, v183
    v_mul_f32 v57, v57, v183
    v_mul_f32 v58, v58, v183
    v_mul_f32 v59, v59, v183
    v_mul_f32 v60, v60, v183
    v_mul_f32 v61, v61, v183
    v_mul_f32 v62, v62, v183
    v_mul_f32 v63, v63, v183
    v_mul_f32 v178, v178, v183
    v_mul_f32 v179, v179, v183
    v_sub_f32 v64, v64, v182
    v_sub_f32 v112, v112, v182
    v_sub_f32 v80, v80, v182
    v_sub_f32 v65, v65, v182
    v_sub_f32 v113, v113, v182
    v_sub_f32 v81, v81, v182
    v_sub_f32 v66, v66, v182
    v_sub_f32 v114, v114, v182
    v_sub_f32 v82, v82, v182
    v_sub_f32 v67, v67, v182
    v_sub_f32 v115, v115, v182
    v_sub_f32 v83, v83, v182
    v_sub_f32 v68, v68, v182
    v_sub_f32 v116, v116, v182
    v_sub_f32 v84, v84, v182
    v_sub_f32 v69, v69, v182
    v_sub_f32 v117, v117, v182
    v_sub_f32 v85, v85, v182
    v_sub_f32 v70, v70, v182
    v_sub_f32 v118, v118, v182
    v_sub_f32 v86, v86, v182
    v_sub_f32 v71, v71, v182
    v_sub_f32 v119, v119, v182
    v_sub_f32 v87, v87, v182
    v_sub_f32 v72, v72, v182
    v_sub_f32 v120, v120, v182
    v_sub_f32 v88, v88, v182
    v_sub_f32 v73, v73, v182
    v_sub_f32 v121, v121, v182
    v_sub_f32 v89, v89, v182
    v_sub_f32 v74, v74, v182
    v_sub_f32 v122, v122, v182
    v_sub_f32 v90, v90, v182
    v_sub_f32 v75, v75, v182
    v_sub_f32 v123, v123, v182
    v_sub_f32 v91, v91, v182
    v_sub_f32 v76, v76, v182
    v_sub_f32 v124, v124, v182
    v_sub_f32 v92, v92, v182
    v_sub_f32 v77, v77, v182
    v_sub_f32 v125, v125, v182
    v_sub_f32 v93, v93, v182
    v_sub_f32 v78, v78, v182
    v_sub_f32 v126, v126, v182
    v_sub_f32 v94, v94, v182
    v_sub_f32 v79, v79, v182
    v_sub_f32 v127, v127, v182
    v_sub_f32 v95, v95, v182
    v_exp_f32 v96, v64
    v_exp_f32 v97, v65
    v_exp_f32 v98, v66
    v_exp_f32 v99, v67
    v_exp_f32 v100, v68
    v_exp_f32 v101, v69
    v_exp_f32 v102, v70
    v_exp_f32 v103, v71
    v_exp_f32 v104, v72
    v_exp_f32 v105, v73
    v_exp_f32 v106, v74
    v_exp_f32 v107, v75
    v_exp_f32 v108, v76
    v_exp_f32 v109, v77
    v_exp_f32 v110, v78
    v_exp_f32 v111, v79
    s_nop 3
    v_add_f32 v176, v178, v96
    v_add_f32 v177, v179, v97
    v_add_f32 v176, v176, v98
    v_add_f32 v177, v177, v99
    v_add_f32 v176, v176, v100
    v_add_f32 v177, v177, v101
    v_add_f32 v176, v176, v102
    v_add_f32 v177, v177, v103
    v_add_f32 v176, v176, v104
    v_add_f32 v177, v177, v105
    v_add_f32 v176, v176, v106
    v_add_f32 v177, v177, v107
    v_add_f32 v176, v176, v108
    v_add_f32 v177, v177, v109
    v_add_f32 v176, v176, v110
    v_add_f32 v177, v177, v111
    s_nop 7
    s_branch L_back0
L_rare1:
    s_nop 15
    s_nop 15
    v_max3_f32 v182, v80, v81, v82
    v_max3_f32 v182, v83, v84, v182
    v_max3_f32 v182, v85, v86, v182
    v_max3_f32 v182, v87, v88, v182
    v_max3_f32 v182, v89, v90, v182
    v_max3_f32 v182, v91, v92, v182
    v_max3_f32 v182, v93, v94, v182
    v_max_f32 v182, v182, v95
    v_mov_b32 v183, v182
    s_nop 3
    v_permlane32_swap_b32 v182, v183
    s_nop 3
    v_max3_f32 v182, v182, v183, 0
    v_sub_f32 v183, 0, v182
    v_exp_f32 v183, v183
    s_nop 3
    v_mul_f32 v0, v0, v183
    v_mul_f32 v1, v1, v183
    v_mul_f32 v2, v2, v183
    v_mul_f32 v3, v3, v183
    v_mul_f32 v4, v4, v183
    v_mul_f32 v5, v5, v183
    v_mul_f32 v6, v6, v183
    v_mul_f32 v7, v7, v183
    v_mul_f32 v8, v8, v183
    v_mul_f32 v9, v9, v183
    v_mul_f32 v10, v10, v183
    v_mul_f32 v11, v11, v183
    v_mul_f32 v12, v12, v183
    v_mul_f32 v13, v13, v183
    v_mul_f32 v14, v14, v183
    v_mul_f32 v15, v15, v183
    v_mul_f32 v16, v16, v183
    v_mul_f32 v17, v17, v183
    v_mul_f32 v18, v18, v183
    v_mul_f32 v19, v19, v183
    v_mul_f32 v20, v20, v183
    v_mul_f32 v21, v21, v183
    v_mul_f32 v22, v22, v183
    v_mul_f32 v23, v23, v183
    v_mul_f32 v24, v24, v183
    v_mul_f32 v25, v25, v183
    v_mul_f32 v26, v26, v183
    v_mul_f32 v27, v27, v183
    v_mul_f32 v28, v28, v183
    v_mul_f32 v29, v29, v183
    v_mul_f32 v30, v30, v183
    v_mul_f32 v31, v31, v183
    v_mul_f32 v32, v32, v183
    v_mul_f32 v33, v33, v183
    v_mul_f32 v34, v34, v183
    v_mul_f32 v35, v35, v183
    v_mul_f32 v36, v36, v183
    v_mul_f32 v37, v37, v183
    v_mul_f32 v38, v38, v183
    v_mul_f32 v39, v39, v183
    v_mul_f32 v40, v40, v183
    v_mul_f32 v41, v41, v183
    v_mul_f32 v42, v42, v183
    v_mul_f32 v43, v43, v183
    v_mul_f32 v44, v44, v183
    v_mul_f32 v45, v45, v183
    v_mul_f32 v46, v46, v183
    v_mul_f32 v47, v47, v183
    v_mul_f32 v48, v48, v183
    v_mul_f32 v49, v49, v183
    v_mul_f32 v50, v50, v183
    v_mul_f32 v51, v51, v183
    v_mul_f32 v52, v52, v183
    v_mul_f32 v53, v53, v183
    v_mul_f32 v54, v54, v183
    v_mul_f32 v55, v55, v183
    v_mul_f32 v56, v56, v183
    v_mul_f32 v57, v57, v183
    v_mul_f32 v58, v58, v183
    v_mul_f32 v59, v59, v183
    v_mul_f32 v60, v60, v183
    v_mul_f32 v61, v61, v183
    v_mul_f32 v62, v62, v183
    v_mul_f32 v63, v63, v183
    v_mul_f32 v176, v176, v183
    v_mul_f32 v177, v177, v183
    v_sub_f32 v80, v80, v182
    v_sub_f32 v112, v112, v182
    v_sub_f32 v64, v64, v182
    v_sub_f32 v81, v81, v182
    v_sub_f32 v113, v113, v182
    v_sub_f32 v65, v65, v182
    v_sub_f32 v82, v82, v182
    v_sub_f32 v114, v114, v182
    v_sub_f32 v66, v66, v182
    v_sub_f32 v83, v83, v182
    v_sub_f32 v115, v115, v182
    v_sub_f32 v67, v67, v182
    v_sub_f32 v84, v84, v182
    v_sub_f32 v116, v116, v182
    v_sub_f32 v68, v68, v182
    v_sub_f32 v85, v85, v182
    v_sub_f32 v117, v117, v182
    v_sub_f32 v69, v69, v182
    v_sub_f32 v86, v86, v182
    v_sub_f32 v118, v118, v182
    v_sub_f32 v70, v70, v182
    v_sub_f32 v87, v87, v182
    v_sub_f32 v119, v119, v182
    v_sub_f32 v71, v71, v182
    v_sub_f32 v88, v88, v182
    v_sub_f32 v120, v120, v182
    v_sub_f32 v72, v72, v182
    v_sub_f32 v89, v89, v182
    v_sub_f32 v121, v121, v182
    v_sub_f32 v73, v73, v182
    v_sub_f32 v90, v90, v182
    v_sub_f32 v122, v122, v182
    v_sub_f32 v74, v74, v182
    v_sub_f32 v91, v91, v182
    v_sub_f32 v123, v123, v182
    v_sub_f32 v75, v75, v182
    v_sub_f32 v92, v92, v182
    v_sub_f32 v124, v124, v182
    v_sub_f32 v76, v76, v182
    v_sub_f32 v93, v93, v182
    v_sub_f32 v125, v125, v182
    v_sub_f32 v77, v77, v182
    v_sub_f32 v94, v94, v182
    v_sub_f32 v126, v126, v182
    v_sub_f32 v78, v78, v182
    v_sub_f32 v95, v95, v182
    v_sub_f32 v127, v127, v182
    v_sub_f32 v79, v79, v182
    v_exp_f32 v96, v80
    v_exp_f32 v97, v81
    v_exp_f32 v98, v82
    v_exp_f32 v99, v83
    v_exp_f32 v100, v84
    v_exp_f32 v101, v85
    v_exp_f32 v102, v86
    v_exp_f32 v103, v87
    v_exp_f32 v104, v88
    v_exp_f32 v105, v89
    v_exp_f32 v106, v90
    v_exp_f32 v107, v91
    v_exp_f32 v108, v92
    v_exp_f32 v109, v93
    v_exp_f32 v110, v94
    v_exp_f32 v111, v95
    s_nop 3
    v_add_f32 v178, v176, v96
    v_add_f32 v179, v177, v97
    v_add_f32 v178, v178, v98
    v_add_f32 v179, v179, v99
    v_add_f32 v178, v178, v100
    v_add_f32 v179, v179, v101
    v_add_f32 v178, v178, v102
    v_add_f32 v179, v179, v103
    v_add_f32 v178, v178, v104
    v_add_f32 v179, v179, v105
    v_add_f32 v178, v178, v106
    v_add_f32 v179, v179, v107
    v_add_f32 v178, v178, v108
    v_add_f32 v179, v179, v109
    v_add_f32 v178, v178, v110
    v_add_f32 v179, v179, v111
    s_nop 7
    s_branch L_back1
L_rare2:
    s_nop 15
    s_nop 15
    v_max3_f32 v182, v64, v65, v66
    v_max3_f32 v182, v67, v68, v182
    v_max3_f32 v182, v69, v70, v182
    v_max3_f32 v182, v71, v72, v182
    v_max3_f32 v182, v73, v74, v182
    v_max3_f32 v182, v75, v76, v182
    v_max3_f32 v182, v77, v78, v182
    v_max_f32 v182, v182, v79
    v_mov_b32 v183, v182
    s_nop 3
    v_permlane32_swap_b32 v182, v183
    s_nop 3
    v_max3_f32 v182, v182, v183, 0
    v_sub_f32 v183, 0, v182
    v_exp_f32 v183, v183
    s_nop 3
    v_mul_f32 v0, v0, v183
    v_mul_f32 v1, v1, v183
    v_mul_f32 v2, v2, v183
    v_mul_f32 v3, v3, v183
    v_mul_f32 v4, v4, v183
    v_mul_f32 v5, v5, v183
    v_mul_f32 v6, v6, v183
    v_mul_f32 v7, v7, v183
    v_mul_f32 v8, v8, v183
    v_mul_f32 v9, v9, v183
    v_mul_f32 v10, v10, v183
    v_mul_f32 v11, v11, v183
    v_mul_f32 v12, v12, v183
    v_mul_f32 v13, v13, v183
    v_mul_f32 v14, v14, v183
    v_mul_f32 v15, v15, v183
    v_mul_f32 v16, v16, v183
    v_mul_f32 v17, v17, v183
    v_mul_f32 v18, v18, v183
    v_mul_f32 v19, v19, v183
    v_mul_f32 v20, v20, v183
    v_mul_f32 v21, v21, v183
    v_mul_f32 v22, v22, v183
    v_mul_f32 v23, v23, v183
    v_mul_f32 v24, v24, v183
    v_mul_f32 v25, v25, v183
    v_mul_f32 v26, v26, v183
    v_mul_f32 v27, v27, v183
    v_mul_f32 v28, v28, v183
    v_mul_f32 v29, v29, v183
    v_mul_f32 v30, v30, v183
    v_mul_f32 v31, v31, v183
    v_mul_f32 v32, v32, v183
    v_mul_f32 v33, v33, v183
    v_mul_f32 v34, v34, v183
    v_mul_f32 v35, v35, v183
    v_mul_f32 v36, v36, v183
    v_mul_f32 v37, v37, v183
    v_mul_f32 v38, v38, v183
    v_mul_f32 v39, v39, v183
    v_mul_f32 v40, v40, v183
    v_mul_f32 v41, v41, v183
    v_mul_f32 v42, v42, v183
    v_mul_f32 v43, v43, v183
    v_mul_f32 v44, v44, v183
    v_mul_f32 v45, v45, v183
    v_mul_f32 v46, v46, v183
    v_mul_f32 v47, v47, v183
    v_mul_f32 v48, v48, v183
    v_mul_f32 v49, v49, v183
    v_mul_f32 v50, v50, v183
    v_mul_f32 v51, v51, v183
    v_mul_f32 v52, v52, v183
    v_mul_f32 v53, v53, v183
    v_mul_f32 v54, v54, v183
    v_mul_f32 v55, v55, v183
    v_mul_f32 v56, v56, v183
    v_mul_f32 v57, v57, v183
    v_mul_f32 v58, v58, v183
    v_mul_f32 v59, v59, v183
    v_mul_f32 v60, v60, v183
    v_mul_f32 v61, v61, v183
    v_mul_f32 v62, v62, v183
    v_mul_f32 v63, v63, v183
    v_mul_f32 v178, v178, v183
    v_mul_f32 v179, v179, v183
    v_sub_f32 v64, v64, v182
    v_sub_f32 v112, v112, v182
    v_sub_f32 v80, v80, v182
    v_sub_f32 v65, v65, v182
    v_sub_f32 v113, v113, v182
    v_sub_f32 v81, v81, v182
    v_sub_f32 v66, v66, v182
    v_sub_f32 v114, v114, v182
    v_sub_f32 v82, v82, v182
    v_sub_f32 v67, v67, v182
    v_sub_f32 v115, v115, v182
    v_sub_f32 v83, v83, v182
    v_sub_f32 v68, v68, v182
    v_sub_f32 v116, v116, v182
    v_sub_f32 v84, v84, v182
    v_sub_f32 v69, v69, v182
    v_sub_f32 v117, v117, v182
    v_sub_f32 v85, v85, v182
    v_sub_f32 v70, v70, v182
    v_sub_f32 v118, v118, v182
    v_sub_f32 v86, v86, v182
    v_sub_f32 v71, v71, v182
    v_sub_f32 v119, v119, v182
    v_sub_f32 v87, v87, v182
    v_sub_f32 v72, v72, v182
    v_sub_f32 v120, v120, v182
    v_sub_f32 v88, v88, v182
    v_sub_f32 v73, v73, v182
    v_sub_f32 v121, v121, v182
    v_sub_f32 v89, v89, v182
    v_sub_f32 v74, v74, v182
    v_sub_f32 v122, v122, v182
    v_sub_f32 v90, v90, v182
    v_sub_f32 v75, v75, v182
    v_sub_f32 v123, v123, v182
    v_sub_f32 v91, v91, v182
    v_sub_f32 v76, v76, v182
    v_sub_f32 v124, v124, v182
    v_sub_f32 v92, v92, v182
    v_sub_f32 v77, v77, v182
    v_sub_f32 v125, v125, v182
    v_sub_f32 v93, v93, v182
    v_sub_f32 v78, v78, v182
    v_sub_f32 v126, v126, v182
    v_sub_f32 v94, v94, v182
    v_sub_f32 v79, v79, v182
    v_sub_f32 v127, v127, v182
    v_sub_f32 v95, v95, v182
    v_exp_f32 v96, v64
    v_exp_f32 v97, v65
    v_exp_f32 v98, v66
    v_exp_f32 v99, v67
    v_exp_f32 v100, v68
    v_exp_f32 v101, v69
    v_exp_f32 v102, v70
    v_exp_f32 v103, v71
    v_exp_f32 v104, v72
    v_exp_f32 v105, v73
    v_exp_f32 v106, v74
    v_exp_f32 v107, v75
    v_exp_f32 v108, v76
    v_exp_f32 v109, v77
    v_exp_f32 v110, v78
    v_exp_f32 v111, v79
    s_nop 3
    v_add_f32 v176, v178, v96
    v_add_f32 v177, v179, v97
    v_add_f32 v176, v176, v98
    v_add_f32 v177, v177, v99
    v_add_f32 v176, v176, v100
    v_add_f32 v177, v177, v101
    v_add_f32 v176, v176, v102
    v_add_f32 v177, v177, v103
    v_add_f32 v176, v176, v104
    v_add_f32 v177, v177, v105
    v_add_f32 v176, v176, v106
    v_add_f32 v177, v177, v107
    v_add_f32 v176, v176, v108
    v_add_f32 v177, v177, v109
    v_add_f32 v176, v176, v110
    v_add_f32 v177, v177, v111
    s_nop 7
    s_branch L_back2
L_rare3:
    s_nop 15
    s_nop 15
    v_max3_f32 v182, v80, v81, v82
    v_max3_f32 v182, v83, v84, v182
    v_max3_f32 v182, v85, v86, v182
    v_max3_f32 v182, v87, v88, v182
    v_max3_f32 v182, v89, v90, v182
    v_max3_f32 v182, v91, v92, v182
    v_max3_f32 v182, v93, v94, v182
    v_max_f32 v182, v182, v95
    v_mov_b32 v183, v182
    s_nop 3
    v_permlane32_swap_b32 v182, v183
    s_nop 3
    v_max3_f32 v182, v182, v183, 0
    v_sub_f32 v183, 0, v182
    v_exp_f32 v183, v183
    s_nop 3
    v_mul_f32 v0, v0, v183
    v_mul_f32 v1, v1, v183
    v_mul_f32 v2, v2, v183
    v_mul_f32 v3, v3, v183
    v_mul_f32 v4, v4, v183
    v_mul_f32 v5, v5, v183
    v_mul_f32 v6, v6, v183
    v_mul_f32 v7, v7, v183
    v_mul_f32 v8, v8, v183
    v_mul_f32 v9, v9, v183
    v_mul_f32 v10, v10, v183
    v_mul_f32 v11, v11, v183
    v_mul_f32 v12, v12, v183
    v_mul_f32 v13, v13, v183
    v_mul_f32 v14, v14, v183
    v_mul_f32 v15, v15, v183
    v_mul_f32 v16, v16, v183
    v_mul_f32 v17, v17, v183
    v_mul_f32 v18, v18, v183
    v_mul_f32 v19, v19, v183
    v_mul_f32 v20, v20, v183
    v_mul_f32 v21, v21, v183
    v_mul_f32 v22, v22, v183
    v_mul_f32 v23, v23, v183
    v_mul_f32 v24, v24, v183
    v_mul_f32 v25, v25, v183
    v_mul_f32 v26, v26, v183
    v_mul_f32 v27, v27, v183
    v_mul_f32 v28, v28, v183
    v_mul_f32 v29, v29, v183
    v_mul_f32 v30, v30, v183
    v_mul_f32 v31, v31, v183
    v_mul_f32 v32, v32, v183
    v_mul_f32 v33, v33, v183
    v_mul_f32 v34, v34, v183
    v_mul_f32 v35, v35, v183
    v_mul_f32 v36, v36, v183
    v_mul_f32 v37, v37, v183
    v_mul_f32 v38, v38, v183
    v_mul_f32 v39, v39, v183
    v_mul_f32 v40, v40, v183
    v_mul_f32 v41, v41, v183
    v_mul_f32 v42, v42, v183
    v_mul_f32 v43, v43, v183
    v_mul_f32 v44, v44, v183
    v_mul_f32 v45, v45, v183
    v_mul_f32 v46, v46, v183
    v_mul_f32 v47, v47, v183
    v_mul_f32 v48, v48, v183
    v_mul_f32 v49, v49, v183
    v_mul_f32 v50, v50, v183
    v_mul_f32 v51, v51, v183
    v_mul_f32 v52, v52, v183
    v_mul_f32 v53, v53, v183
    v_mul_f32 v54, v54, v183
    v_mul_f32 v55, v55, v183
    v_mul_f32 v56, v56, v183
    v_mul_f32 v57, v57, v183
    v_mul_f32 v58, v58, v183
    v_mul_f32 v59, v59, v183
    v_mul_f32 v60, v60, v183
    v_mul_f32 v61, v61, v183
    v_mul_f32 v62, v62, v183
    v_mul_f32 v63, v63, v183
    v_mul_f32 v176, v176, v183
    v_mul_f32 v177, v177, v183
    v_sub_f32 v80, v80, v182
    v_sub_f32 v112, v112, v182
    v_sub_f32 v64, v64, v182
    v_sub_f32 v81, v81, v182
    v_sub_f32 v113, v113, v182
    v_sub_f32 v65, v65, v182
    v_sub_f32 v82, v82, v182
    v_sub_f32 v114, v114, v182
    v_sub_f32 v66, v66, v182
    v_sub_f32 v83, v83, v182
    v_sub_f32 v115, v115, v182
    v_sub_f32 v67, v67, v182
    v_sub_f32 v84, v84, v182
    v_sub_f32 v116, v116, v182
    v_sub_f32 v68, v68, v182
    v_sub_f32 v85, v85, v182
    v_sub_f32 v117, v117, v182
    v_sub_f32 v69, v69, v182
    v_sub_f32 v86, v86, v182
    v_sub_f32 v118, v118, v182
    v_sub_f32 v70, v70, v182
    v_sub_f32 v87, v87, v182
    v_sub_f32 v119, v119, v182
    v_sub_f32 v71, v71, v182
    v_sub_f32 v88, v88, v182
    v_sub_f32 v120, v120, v182
    v_sub_f32 v72, v72, v182
    v_sub_f32 v89, v89, v182
    v_sub_f32 v121, v121, v182
    v_sub_f32 v73, v73, v182
    v_sub_f32 v90, v90, v182
    v_sub_f32 v122, v122, v182
    v_sub_f32 v74, v74, v182
    v_sub_f32 v91, v91, v182
    v_sub_f32 v123, v123, v182
    v_sub_f32 v75, v75, v182
    v_sub_f32 v92, v92, v182
    v_sub_f32 v124, v124, v182
    v_sub_f32 v76, v76, v182
    v_sub_f32 v93, v93, v182
    v_sub_f32 v125, v125, v182
    v_sub_f32 v77, v77, v182
    v_sub_f32 v94, v94, v182
    v_sub_f32 v126, v126, v182
    v_sub_f32 v78, v78, v182
    v_sub_f32 v95, v95, v182
    v_sub_f32 v127, v127, v182
    v_sub_f32 v79, v79, v182
    v_exp_f32 v96, v80
    v_exp_f32 v97, v81
    v_exp_f32 v98, v82
    v_exp_f32 v99, v83
    v_exp_f32 v100, v84
    v_exp_f32 v101, v85
    v_exp_f32 v102, v86
    v_exp_f32 v103, v87
    v_exp_f32 v104, v88
    v_exp_f32 v105, v89
    v_exp_f32 v106, v90
    v_exp_f32 v107, v91
    v_exp_f32 v108, v92
    v_exp_f32 v109, v93
    v_exp_f32 v110, v94
    v_exp_f32 v111, v95
    s_nop 3
    v_add_f32 v178, v176, v96
    v_add_f32 v179, v177, v97
    v_add_f32 v178, v178, v98
    v_add_f32 v179, v179, v99
    v_add_f32 v178, v178, v100
    v_add_f32 v179, v179, v101
    v_add_f32 v178, v178, v102
    v_add_f32 v179, v179, v103
    v_add_f32 v178, v178, v104
    v_add_f32 v179, v179, v105
    v_add_f32 v178, v178, v106
    v_add_f32 v179, v179, v107
    v_add_f32 v178, v178, v108
    v_add_f32 v179, v179, v109
    v_add_f32 v178, v178, v110
    v_add_f32 v179, v179, v111
    s_nop 7
    s_branch L_back3
L_rare4:
    s_nop 15
    s_nop 15
    v_max3_f32 v182, v64, v65, v66
    v_max3_f32 v182, v67, v68, v182
    v_max3_f32 v182, v69, v70, v182
    v_max3_f32 v182, v71, v72, v182
    v_max3_f32 v182, v73, v74, v182
    v_max3_f32 v182, v75, v76, v182
    v_max3_f32 v182, v77, v78, v182
    v_max_f32 v182, v182, v79
    v_mov_b32 v183, v182
    s_nop 3
    v_permlane32_swap_b32 v182, v183
    s_nop 3
    v_max3_f32 v182, v182, v183, 0
    v_sub_f32 v183, 0, v182
    v_exp_f32 v183, v183
    s_nop 3
    v_mul_f32 v0, v0, v183
    v_mul_f32 v1, v1, v183
    v_mul_f32 v2, v2, v183
    v_mul_f32 v3, v3, v183
    v_mul_f32 v4, v4, v183
    v_mul_f32 v5, v5, v183
    v_mul_f32 v6, v6, v183
    v_mul_f32 v7, v7, v183
    v_mul_f32 v8, v8, v183
    v_mul_f32 v9, v9, v183
    v_mul_f32 v10, v10, v183
    v_mul_f32 v11, v11, v183
    v_mul_f32 v12, v12, v183
    v_mul_f32 v13, v13, v183
    v_mul_f32 v14, v14, v183
    v_mul_f32 v15, v15, v183
    v_mul_f32 v16, v16, v183
    v_mul_f32 v17, v17, v183
    v_mul_f32 v18, v18, v183
    v_mul_f32 v19, v19, v183
    v_mul_f32 v20, v20, v183
    v_mul_f32 v21, v21, v183
    v_mul_f32 v22, v22, v183
    v_mul_f32 v23, v23, v183
    v_mul_f32 v24, v24, v183
    v_mul_f32 v25, v25, v183
    v_mul_f32 v26, v26, v183
    v_mul_f32 v27, v27, v183
    v_mul_f32 v28, v28, v183
    v_mul_f32 v29, v29, v183
    v_mul_f32 v30, v30, v183
    v_mul_f32 v31, v31, v183
    v_mul_f32 v32, v32, v183
    v_mul_f32 v33, v33, v183
    v_mul_f32 v34, v34, v183
    v_mul_f32 v35, v35, v183
    v_mul_f32 v36, v36, v183
    v_mul_f32 v37, v37, v183
    v_mul_f32 v38, v38, v183
    v_mul_f32 v39, v39, v183
    v_mul_f32 v40, v40, v183
    v_mul_f32 v41, v41, v183
    v_mul_f32 v42, v42, v183
    v_mul_f32 v43, v43, v183
    v_mul_f32 v44, v44, v183
    v_mul_f32 v45, v45, v183
    v_mul_f32 v46, v46, v183
    v_mul_f32 v47, v47, v183
    v_mul_f32 v48, v48, v183
    v_mul_f32 v49, v49, v183
    v_mul_f32 v50, v50, v183
    v_mul_f32 v51, v51, v183
    v_mul_f32 v52, v52, v183
    v_mul_f32 v53, v53, v183
    v_mul_f32 v54, v54, v183
    v_mul_f32 v55, v55, v183
    v_mul_f32 v56, v56, v183
    v_mul_f32 v57, v57, v183
    v_mul_f32 v58, v58, v183
    v_mul_f32 v59, v59, v183
    v_mul_f32 v60, v60, v183
    v_mul_f32 v61, v61, v183
    v_mul_f32 v62, v62, v183
    v_mul_f32 v63, v63, v183
    v_mul_f32 v178, v178, v183
    v_mul_f32 v179, v179, v183
    v_sub_f32 v64, v64, v182
    v_sub_f32 v112, v112, v182
    v_sub_f32 v80, v80, v182
    v_sub_f32 v65, v65, v182
    v_sub_f32 v113, v113, v182
    v_sub_f32 v81, v81, v182
    v_sub_f32 v66, v66, v182
    v_sub_f32 v114, v114, v182
    v_sub_f32 v82, v82, v182
    v_sub_f32 v67, v67, v182
    v_sub_f32 v115, v115, v182
    v_sub_f32 v83, v83, v182
    v_sub_f32 v68, v68, v182
    v_sub_f32 v116, v116, v182
    v_sub_f32 v84, v84, v182
    v_sub_f32 v69, v69, v182
    v_sub_f32 v117, v117, v182
    v_sub_f32 v85, v85, v182
    v_sub_f32 v70, v70, v182
    v_sub_f32 v118, v118, v182
    v_sub_f32 v86, v86, v182
    v_sub_f32 v71, v71, v182
    v_sub_f32 v119, v119, v182
    v_sub_f32 v87, v87, v182
    v_sub_f32 v72, v72, v182
    v_sub_f32 v120, v120, v182
    v_sub_f32 v88, v88, v182
    v_sub_f32 v73, v73, v182
    v_sub_f32 v121, v121, v182
    v_sub_f32 v89, v89, v182
    v_sub_f32 v74, v74, v182
    v_sub_f32 v122, v122, v182
    v_sub_f32 v90, v90, v182
    v_sub_f32 v75, v75, v182
    v_sub_f32 v123, v123, v182
    v_sub_f32 v91, v91, v182
    v_sub_f32 v76, v76, v182
    v_sub_f32 v124, v124, v182
    v_sub_f32 v92, v92, v182
    v_sub_f32 v77, v77, v182
    v_sub_f32 v125, v125, v182
    v_sub_f32 v93, v93, v182
    v_sub_f32 v78, v78, v182
    v_sub_f32 v126, v126, v182
    v_sub_f32 v94, v94, v182
    v_sub_f32 v79, v79, v182
    v_sub_f32 v127, v127, v182
    v_sub_f32 v95, v95, v182
    v_exp_f32 v96, v64
    v_exp_f32 v97, v65
    v_exp_f32 v98, v66
    v_exp_f32 v99, v67
    v_exp_f32 v100, v68
    v_exp_f32 v101, v69
    v_exp_f32 v102, v70
    v_exp_f32 v103, v71
    v_exp_f32 v104, v72
    v_exp_f32 v105, v73
    v_exp_f32 v106, v74
    v_exp_f32 v107, v75
    v_exp_f32 v108, v76
    v_exp_f32 v109, v77
    v_exp_f32 v110, v78
    v_exp_f32 v111, v79
    s_nop 3
    v_add_f32 v176, v178, v96
    v_add_f32 v177, v179, v97
    v_add_f32 v176, v176, v98
    v_add_f32 v177, v177, v99
    v_add_f32 v176, v176, v100
    v_add_f32 v177, v177, v101
    v_add_f32 v176, v176, v102
    v_add_f32 v177, v177, v103
    v_add_f32 v176, v176, v104
    v_add_f32 v177, v177, v105
    v_add_f32 v176, v176, v106
    v_add_f32 v177, v177, v107
    v_add_f32 v176, v176, v108
    v_add_f32 v177, v177, v109
    v_add_f32 v176, v176, v110
    v_add_f32 v177, v177, v111
    s_nop 7
    s_branch L_back4
L_rare5:
    s_nop 15
    s_nop 15
    v_max3_f32 v182, v80, v81, v82
    v_max3_f32 v182, v83, v84, v182
    v_max3_f32 v182, v85, v86, v182
    v_max3_f32 v182, v87, v88, v182
    v_max3_f32 v182, v89, v90, v182
    v_max3_f32 v182, v91, v92, v182
    v_max3_f32 v182, v93, v94, v182
    v_max_f32 v182, v182, v95
    v_mov_b32 v183, v182
    s_nop 3
    v_permlane32_swap_b32 v182, v183
    s_nop 3
    v_max3_f32 v182, v182, v183, 0
    v_sub_f32 v183, 0, v182
    v_exp_f32 v183, v183
    s_nop 3
    v_mul_f32 v0, v0, v183
    v_mul_f32 v1, v1, v183
    v_mul_f32 v2, v2, v183
    v_mul_f32 v3, v3, v183
    v_mul_f32 v4, v4, v183
    v_mul_f32 v5, v5, v183
    v_mul_f32 v6, v6, v183
    v_mul_f32 v7, v7, v183
    v_mul_f32 v8, v8, v183
    v_mul_f32 v9, v9, v183
    v_mul_f32 v10, v10, v183
    v_mul_f32 v11, v11, v183
    v_mul_f32 v12, v12, v183
    v_mul_f32 v13, v13, v183
    v_mul_f32 v14, v14, v183
    v_mul_f32 v15, v15, v183
    v_mul_f32 v16, v16, v183
    v_mul_f32 v17, v17, v183
    v_mul_f32 v18, v18, v183
    v_mul_f32 v19, v19, v183
    v_mul_f32 v20, v20, v183
    v_mul_f32 v21, v21, v183
    v_mul_f32 v22, v22, v183
    v_mul_f32 v23, v23, v183
    v_mul_f32 v24, v24, v183
    v_mul_f32 v25, v25, v183
    v_mul_f32 v26, v26, v183
    v_mul_f32 v27, v27, v183
    v_mul_f32 v28, v28, v183
    v_mul_f32 v29, v29, v183
    v_mul_f32 v30, v30, v183
    v_mul_f32 v31, v31, v183
    v_mul_f32 v32, v32, v183
    v_mul_f32 v33, v33, v183
    v_mul_f32 v34, v34, v183
    v_mul_f32 v35, v35, v183
    v_mul_f32 v36, v36, v183
    v_mul_f32 v37, v37, v183
    v_mul_f32 v38, v38, v183
    v_mul_f32 v39, v39, v183
    v_mul_f32 v40, v40, v183
    v_mul_f32 v41, v41, v183
    v_mul_f32 v42, v42, v183
    v_mul_f32 v43, v43, v183
    v_mul_f32 v44, v44, v183
    v_mul_f32 v45, v45, v183
    v_mul_f32 v46, v46, v183
    v_mul_f32 v47, v47, v183
    v_mul_f32 v48, v48, v183
    v_mul_f32 v49, v49, v183
    v_mul_f32 v50, v50, v183
    v_mul_f32 v51, v51, v183
    v_mul_f32 v52, v52, v183
    v_mul_f32 v53, v53, v183
    v_mul_f32 v54, v54, v183
    v_mul_f32 v55, v55, v183
    v_mul_f32 v56, v56, v183
    v_mul_f32 v57, v57, v183
    v_mul_f32 v58, v58, v183
    v_mul_f32 v59, v59, v183
    v_mul_f32 v60, v60, v183
    v_mul_f32 v61, v61, v183
    v_mul_f32 v62, v62, v183
    v_mul_f32 v63, v63, v183
    v_mul_f32 v176, v176, v183
    v_mul_f32 v177, v177, v183
    v_sub_f32 v80, v80, v182
    v_sub_f32 v112, v112, v182
    v_sub_f32 v64, v64, v182
    v_sub_f32 v81, v81, v182
    v_sub_f32 v113, v113, v182
    v_sub_f32 v65, v65, v182
    v_sub_f32 v82, v82, v182
    v_sub_f32 v114, v114, v182
    v_sub_f32 v66, v66, v182
    v_sub_f32 v83, v83, v182
    v_sub_f32 v115, v115, v182
    v_sub_f32 v67, v67, v182
    v_sub_f32 v84, v84, v182
    v_sub_f32 v116, v116, v182
    v_sub_f32 v68, v68, v182
    v_sub_f32 v85, v85, v182
    v_sub_f32 v117, v117, v182
    v_sub_f32 v69, v69, v182
    v_sub_f32 v86, v86, v182
    v_sub_f32 v118, v118, v182
    v_sub_f32 v70, v70, v182
    v_sub_f32 v87, v87, v182
    v_sub_f32 v119, v119, v182
    v_sub_f32 v71, v71, v182
    v_sub_f32 v88, v88, v182
    v_sub_f32 v120, v120, v182
    v_sub_f32 v72, v72, v182
    v_sub_f32 v89, v89, v182
    v_sub_f32 v121, v121, v182
    v_sub_f32 v73, v73, v182
    v_sub_f32 v90, v90, v182
    v_sub_f32 v122, v122, v182
    v_sub_f32 v74, v74, v182
    v_sub_f32 v91, v91, v182
    v_sub_f32 v123, v123, v182
    v_sub_f32 v75, v75, v182
    v_sub_f32 v92, v92, v182
    v_sub_f32 v124, v124, v182
    v_sub_f32 v76, v76, v182
    v_sub_f32 v93, v93, v182
    v_sub_f32 v125, v125, v182
    v_sub_f32 v77, v77, v182
    v_sub_f32 v94, v94, v182
    v_sub_f32 v126, v126, v182
    v_sub_f32 v78, v78, v182
    v_sub_f32 v95, v95, v182
    v_sub_f32 v127, v127, v182
    v_sub_f32 v79, v79, v182
    v_exp_f32 v96, v80
    v_exp_f32 v97, v81
    v_exp_f32 v98, v82
    v_exp_f32 v99, v83
    v_exp_f32 v100, v84
    v_exp_f32 v101, v85
    v_exp_f32 v102, v86
    v_exp_f32 v103, v87
    v_exp_f32 v104, v88
    v_exp_f32 v105, v89
    v_exp_f32 v106, v90
    v_exp_f32 v107, v91
    v_exp_f32 v108, v92
    v_exp_f32 v109, v93
    v_exp_f32 v110, v94
    v_exp_f32 v111, v95
    s_nop 3
    v_add_f32 v178, v176, v96
    v_add_f32 v179, v177, v97
    v_add_f32 v178, v178, v98
    v_add_f32 v179, v179, v99
    v_add_f32 v178, v178, v100
    v_add_f32 v179, v179, v101
    v_add_f32 v178, v178, v102
    v_add_f32 v179, v179, v103
    v_add_f32 v178, v178, v104
    v_add_f32 v179, v179, v105
    v_add_f32 v178, v178, v106
    v_add_f32 v179, v179, v107
    v_add_f32 v178, v178, v108
    v_add_f32 v179, v179, v109
    v_add_f32 v178, v178, v110
    v_add_f32 v179, v179, v111
    s_nop 7
    s_branch L_back5
L_rare6:
    s_nop 15
    s_nop 15
    v_max3_f32 v182, v64, v65, v66
    v_max3_f32 v182, v67, v68, v182
    v_max3_f32 v182, v69, v70, v182
    v_max3_f32 v182, v71, v72, v182
    v_max3_f32 v182, v73, v74, v182
    v_max3_f32 v182, v75, v76, v182
    v_max3_f32 v182, v77, v78, v182
    v_max_f32 v182, v182, v79
    v_mov_b32 v183, v182
    s_nop 3
    v_permlane32_swap_b32 v182, v183
    s_nop 3
    v_max3_f32 v182, v182, v183, 0
    v_sub_f32 v183, 0, v182
    v_exp_f32 v183, v183
    s_nop 3
    v_mul_f32 v0, v0, v183
    v_mul_f32 v1, v1, v183
    v_mul_f32 v2, v2, v183
    v_mul_f32 v3, v3, v183
    v_mul_f32 v4, v4, v183
    v_mul_f32 v5, v5, v183
    v_mul_f32 v6, v6, v183
    v_mul_f32 v7, v7, v183
    v_mul_f32 v8, v8, v183
    v_mul_f32 v9, v9, v183
    v_mul_f32 v10, v10, v183
    v_mul_f32 v11, v11, v183
    v_mul_f32 v12, v12, v183
    v_mul_f32 v13, v13, v183
    v_mul_f32 v14, v14, v183
    v_mul_f32 v15, v15, v183
    v_mul_f32 v16, v16, v183
    v_mul_f32 v17, v17, v183
    v_mul_f32 v18, v18, v183
    v_mul_f32 v19, v19, v183
    v_mul_f32 v20, v20, v183
    v_mul_f32 v21, v21, v183
    v_mul_f32 v22, v22, v183
    v_mul_f32 v23, v23, v183
    v_mul_f32 v24, v24, v183
    v_mul_f32 v25, v25, v183
    v_mul_f32 v26, v26, v183
    v_mul_f32 v27, v27, v183
    v_mul_f32 v28, v28, v183
    v_mul_f32 v29, v29, v183
    v_mul_f32 v30, v30, v183
    v_mul_f32 v31, v31, v183
    v_mul_f32 v32, v32, v183
    v_mul_f32 v33, v33, v183
    v_mul_f32 v34, v34, v183
    v_mul_f32 v35, v35, v183
    v_mul_f32 v36, v36, v183
    v_mul_f32 v37, v37, v183
    v_mul_f32 v38, v38, v183
    v_mul_f32 v39, v39, v183
    v_mul_f32 v40, v40, v183
    v_mul_f32 v41, v41, v183
    v_mul_f32 v42, v42, v183
    v_mul_f32 v43, v43, v183
    v_mul_f32 v44, v44, v183
    v_mul_f32 v45, v45, v183
    v_mul_f32 v46, v46, v183
    v_mul_f32 v47, v47, v183
    v_mul_f32 v48, v48, v183
    v_mul_f32 v49, v49, v183
    v_mul_f32 v50, v50, v183
    v_mul_f32 v51, v51, v183
    v_mul_f32 v52, v52, v183
    v_mul_f32 v53, v53, v183
    v_mul_f32 v54, v54, v183
    v_mul_f32 v55, v55, v183
    v_mul_f32 v56, v56, v183
    v_mul_f32 v57, v57, v183
    v_mul_f32 v58, v58, v183
    v_mul_f32 v59, v59, v183
    v_mul_f32 v60, v60, v183
    v_mul_f32 v61, v61, v183
    v_mul_f32 v62, v62, v183
    v_mul_f32 v63, v63, v183
    v_mul_f32 v178, v178, v183
    v_mul_f32 v179, v179, v183
    v_sub_f32 v64, v64, v182
    v_sub_f32 v112, v112, v182
    v_sub_f32 v80, v80, v182
    v_sub_f32 v65, v65, v182
    v_sub_f32 v113, v113, v182
    v_sub_f32 v81, v81, v182
    v_sub_f32 v66, v66, v182
    v_sub_f32 v114, v114, v182
    v_sub_f32 v82, v82, v182
    v_sub_f32 v67, v67, v182
    v_sub_f32 v115, v115, v182
    v_sub_f32 v83, v83, v182
    v_sub_f32 v68, v68, v182
    v_sub_f32 v116, v116, v182
    v_sub_f32 v84, v84, v182
    v_sub_f32 v69, v69, v182
    v_sub_f32 v117, v117, v182
    v_sub_f32 v85, v85, v182
    v_sub_f32 v70, v70, v182
    v_sub_f32 v118, v118, v182
    v_sub_f32 v86, v86, v182
    v_sub_f32 v71, v71, v182
    v_sub_f32 v119, v119, v182
    v_sub_f32 v87, v87, v182
    v_sub_f32 v72, v72, v182
    v_sub_f32 v120, v120, v182
    v_sub_f32 v88, v88, v182
    v_sub_f32 v73, v73, v182
    v_sub_f32 v121, v121, v182
    v_sub_f32 v89, v89, v182
    v_sub_f32 v74, v74, v182
    v_sub_f32 v122, v122, v182
    v_sub_f32 v90, v90, v182
    v_sub_f32 v75, v75, v182
    v_sub_f32 v123, v123, v182
    v_sub_f32 v91, v91, v182
    v_sub_f32 v76, v76, v182
    v_sub_f32 v124, v124, v182
    v_sub_f32 v92, v92, v182
    v_sub_f32 v77, v77, v182
    v_sub_f32 v125, v125, v182
    v_sub_f32 v93, v93, v182
    v_sub_f32 v78, v78, v182
    v_sub_f32 v126, v126, v182
    v_sub_f32 v94, v94, v182
    v_sub_f32 v79, v79, v182
    v_sub_f32 v127, v127, v182
    v_sub_f32 v95, v95, v182
    v_exp_f32 v96, v64
    v_exp_f32 v97, v65
    v_exp_f32 v98, v66
    v_exp_f32 v99, v67
    v_exp_f32 v100, v68
    v_exp_f32 v101, v69
    v_exp_f32 v102, v70
    v_exp_f32 v103, v71
    v_exp_f32 v104, v72
    v_exp_f32 v105, v73
    v_exp_f32 v106, v74
    v_exp_f32 v107, v75
    v_exp_f32 v108, v76
    v_exp_f32 v109, v77
    v_exp_f32 v110, v78
    v_exp_f32 v111, v79
    s_nop 3
    v_add_f32 v176, v178, v96
    v_add_f32 v177, v179, v97
    v_add_f32 v176, v176, v98
    v_add_f32 v177, v177, v99
    v_add_f32 v176, v176, v100
    v_add_f32 v177, v177, v101
    v_add_f32 v176, v176, v102
    v_add_f32 v177, v177, v103
    v_add_f32 v176, v176, v104
    v_add_f32 v177, v177, v105
    v_add_f32 v176, v176, v106
    v_add_f32 v177, v177, v107
    v_add_f32 v176, v176, v108
    v_add_f32 v177, v177, v109
    v_add_f32 v176, v176, v110
    v_add_f32 v177, v177, v111
    s_nop 7
    s_branch L_back6
L_rare7:
    s_nop 15
    s_nop 15
    v_max3_f32 v182, v80, v81, v82
    v_max3_f32 v182, v83, v84, v182
    v_max3_f32 v182, v85, v86, v182
    v_max3_f32 v182, v87, v88, v182
    v_max3_f32 v182, v89, v90, v182
    v_max3_f32 v182, v91, v92, v182
    v_max3_f32 v182, v93, v94, v182
    v_max_f32 v182, v182, v95
    v_mov_b32 v183, v182
    s_nop 3
    v_permlane32_swap_b32 v182, v183
    s_nop 3
    v_max3_f32 v182, v182, v183, 0
    v_sub_f32 v183, 0, v182
    v_exp_f32 v183, v183
    s_nop 3
    v_mul_f32 v0, v0, v183
    v_mul_f32 v1, v1, v183
    v_mul_f32 v2, v2, v183
    v_mul_f32 v3, v3, v183
    v_mul_f32 v4, v4, v183
    v_mul_f32 v5, v5, v183
    v_mul_f32 v6, v6, v183
    v_mul_f32 v7, v7, v183
    v_mul_f32 v8, v8, v183
    v_mul_f32 v9, v9, v183
    v_mul_f32 v10, v10, v183
    v_mul_f32 v11, v11, v183
    v_mul_f32 v12, v12, v183
    v_mul_f32 v13, v13, v183
    v_mul_f32 v14, v14, v183
    v_mul_f32 v15, v15, v183
    v_mul_f32 v16, v16, v183
    v_mul_f32 v17, v17, v183
    v_mul_f32 v18, v18, v183
    v_mul_f32 v19, v19, v183
    v_mul_f32 v20, v20, v183
    v_mul_f32 v21, v21, v183
    v_mul_f32 v22, v22, v183
    v_mul_f32 v23, v23, v183
    v_mul_f32 v24, v24, v183
    v_mul_f32 v25, v25, v183
    v_mul_f32 v26, v26, v183
    v_mul_f32 v27, v27, v183
    v_mul_f32 v28, v28, v183
    v_mul_f32 v29, v29, v183
    v_mul_f32 v30, v30, v183
    v_mul_f32 v31, v31, v183
    v_mul_f32 v32, v32, v183
    v_mul_f32 v33, v33, v183
    v_mul_f32 v34, v34, v183
    v_mul_f32 v35, v35, v183
    v_mul_f32 v36, v36, v183
    v_mul_f32 v37, v37, v183
    v_mul_f32 v38, v38, v183
    v_mul_f32 v39, v39, v183
    v_mul_f32 v40, v40, v183
    v_mul_f32 v41, v41, v183
    v_mul_f32 v42, v42, v183
    v_mul_f32 v43, v43, v183
    v_mul_f32 v44, v44, v183
    v_mul_f32 v45, v45, v183
    v_mul_f32 v46, v46, v183
    v_mul_f32 v47, v47, v183
    v_mul_f32 v48, v48, v183
    v_mul_f32 v49, v49, v183
    v_mul_f32 v50, v50, v183
    v_mul_f32 v51, v51, v183
    v_mul_f32 v52, v52, v183
    v_mul_f32 v53, v53, v183
    v_mul_f32 v54, v54, v183
    v_mul_f32 v55, v55, v183
    v_mul_f32 v56, v56, v183
    v_mul_f32 v57, v57, v183
    v_mul_f32 v58, v58, v183
    v_mul_f32 v59, v59, v183
    v_mul_f32 v60, v60, v183
    v_mul_f32 v61, v61, v183
    v_mul_f32 v62, v62, v183
    v_mul_f32 v63, v63, v183
    v_mul_f32 v176, v176, v183
    v_mul_f32 v177, v177, v183
    v_sub_f32 v80, v80, v182
    v_sub_f32 v112, v112, v182
    v_sub_f32 v64, v64, v182
    v_sub_f32 v81, v81, v182
    v_sub_f32 v113, v113, v182
    v_sub_f32 v65, v65, v182
    v_sub_f32 v82, v82, v182
    v_sub_f32 v114, v114, v182
    v_sub_f32 v66, v66, v182
    v_sub_f32 v83, v83, v182
    v_sub_f32 v115, v115, v182
    v_sub_f32 v67, v67, v182
    v_sub_f32 v84, v84, v182
    v_sub_f32 v116, v116, v182
    v_sub_f32 v68, v68, v182
    v_sub_f32 v85, v85, v182
    v_sub_f32 v117, v117, v182
    v_sub_f32 v69, v69, v182
    v_sub_f32 v86, v86, v182
    v_sub_f32 v118, v118, v182
    v_sub_f32 v70, v70, v182
    v_sub_f32 v87, v87, v182
    v_sub_f32 v119, v119, v182
    v_sub_f32 v71, v71, v182
    v_sub_f32 v88, v88, v182
    v_sub_f32 v120, v120, v182
    v_sub_f32 v72, v72, v182
    v_sub_f32 v89, v89, v182
    v_sub_f32 v121, v121, v182
    v_sub_f32 v73, v73, v182
    v_sub_f32 v90, v90, v182
    v_sub_f32 v122, v122, v182
    v_sub_f32 v74, v74, v182
    v_sub_f32 v91, v91, v182
    v_sub_f32 v123, v123, v182
    v_sub_f32 v75, v75, v182
    v_sub_f32 v92, v92, v182
    v_sub_f32 v124, v124, v182
    v_sub_f32 v76, v76, v182
    v_sub_f32 v93, v93, v182
    v_sub_f32 v125, v125, v182
    v_sub_f32 v77, v77, v182
    v_sub_f32 v94, v94, v182
    v_sub_f32 v126, v126, v182
    v_sub_f32 v78, v78, v182
    v_sub_f32 v95, v95, v182
    v_sub_f32 v127, v127, v182
    v_sub_f32 v79, v79, v182
    v_exp_f32 v96, v80
    v_exp_f32 v97, v81
    v_exp_f32 v98, v82
    v_exp_f32 v99, v83
    v_exp_f32 v100, v84
    v_exp_f32 v101, v85
    v_exp_f32 v102, v86
    v_exp_f32 v103, v87
    v_exp_f32 v104, v88
    v_exp_f32 v105, v89
    v_exp_f32 v106, v90
    v_exp_f32 v107, v91
    v_exp_f32 v108, v92
    v_exp_f32 v109, v93
    v_exp_f32 v110, v94
    v_exp_f32 v111, v95
    s_nop 3
    v_add_f32 v178, v176, v96
    v_add_f32 v179, v177, v97
    v_add_f32 v178, v178, v98
    v_add_f32 v179, v179, v99
    v_add_f32 v178, v178, v100
    v_add_f32 v179, v179, v101
    v_add_f32 v178, v178, v102
    v_add_f32 v179, v179, v103
    v_add_f32 v178, v178, v104
    v_add_f32 v179, v179, v105
    v_add_f32 v178, v178, v106
    v_add_f32 v179, v179, v107
    v_add_f32 v178, v178, v108
    v_add_f32 v179, v179, v109
    v_add_f32 v178, v178, v110
    v_add_f32 v179, v179, v111
    s_nop 7
    s_branch L_back7
L_rare8:
    s_nop 15
    s_nop 15
    v_max3_f32 v182, v64, v65, v66
    v_max3_f32 v182, v67, v68, v182
    v_max3_f32 v182, v69, v70, v182
    v_max3_f32 v182, v71, v72, v182
    v_max3_f32 v182, v73, v74, v182
    v_max3_f32 v182, v75, v76, v182
    v_max3_f32 v182, v77, v78, v182
    v_max_f32 v182, v182, v79
    v_mov_b32 v183, v182
    s_nop 3
    v_permlane32_swap_b32 v182, v183
    s_nop 3
    v_max3_f32 v182, v182, v183, 0
    v_sub_f32 v183, 0, v182
    v_exp_f32 v183, v183
    s_nop 3
    v_mul_f32 v0, v0, v183
    v_mul_f32 v1, v1, v183
    v_mul_f32 v2, v2, v183
    v_mul_f32 v3, v3, v183
    v_mul_f32 v4, v4, v183
    v_mul_f32 v5, v5, v183
    v_mul_f32 v6, v6, v183
    v_mul_f32 v7, v7, v183
    v_mul_f32 v8, v8, v183
    v_mul_f32 v9, v9, v183
    v_mul_f32 v10, v10, v183
    v_mul_f32 v11, v11, v183
    v_mul_f32 v12, v12, v183
    v_mul_f32 v13, v13, v183
    v_mul_f32 v14, v14, v183
    v_mul_f32 v15, v15, v183
    v_mul_f32 v16, v16, v183
    v_mul_f32 v17, v17, v183
    v_mul_f32 v18, v18, v183
    v_mul_f32 v19, v19, v183
    v_mul_f32 v20, v20, v183
    v_mul_f32 v21, v21, v183
    v_mul_f32 v22, v22, v183
    v_mul_f32 v23, v23, v183
    v_mul_f32 v24, v24, v183
    v_mul_f32 v25, v25, v183
    v_mul_f32 v26, v26, v183
    v_mul_f32 v27, v27, v183
    v_mul_f32 v28, v28, v183
    v_mul_f32 v29, v29, v183
    v_mul_f32 v30, v30, v183
    v_mul_f32 v31, v31, v183
    v_mul_f32 v32, v32, v183
    v_mul_f32 v33, v33, v183
    v_mul_f32 v34, v34, v183
    v_mul_f32 v35, v35, v183
    v_mul_f32 v36, v36, v183
    v_mul_f32 v37, v37, v183
    v_mul_f32 v38, v38, v183
    v_mul_f32 v39, v39, v183
    v_mul_f32 v40, v40, v183
    v_mul_f32 v41, v41, v183
    v_mul_f32 v42, v42, v183
    v_mul_f32 v43, v43, v183
    v_mul_f32 v44, v44, v183
    v_mul_f32 v45, v45, v183
    v_mul_f32 v46, v46, v183
    v_mul_f32 v47, v47, v183
    v_mul_f32 v48, v48, v183
    v_mul_f32 v49, v49, v183
    v_mul_f32 v50, v50, v183
    v_mul_f32 v51, v51, v183
    v_mul_f32 v52, v52, v183
    v_mul_f32 v53, v53, v183
    v_mul_f32 v54, v54, v183
    v_mul_f32 v55, v55, v183
    v_mul_f32 v56, v56, v183
    v_mul_f32 v57, v57, v183
    v_mul_f32 v58, v58, v183
    v_mul_f32 v59, v59, v183
    v_mul_f32 v60, v60, v183
    v_mul_f32 v61, v61, v183
    v_mul_f32 v62, v62, v183
    v_mul_f32 v63, v63, v183
    v_mul_f32 v178, v178, v183
    v_mul_f32 v179, v179, v183
    v_sub_f32 v64, v64, v182
    v_sub_f32 v112, v112, v182
    v_sub_f32 v80, v80, v182
    v_sub_f32 v65, v65, v182
    v_sub_f32 v113, v113, v182
    v_sub_f32 v81, v81, v182
    v_sub_f32 v66, v66, v182
    v_sub_f32 v114, v114, v182
    v_sub_f32 v82, v82, v182
    v_sub_f32 v67, v67, v182
    v_sub_f32 v115, v115, v182
    v_sub_f32 v83, v83, v182
    v_sub_f32 v68, v68, v182
    v_sub_f32 v116, v116, v182
    v_sub_f32 v84, v84, v182
    v_sub_f32 v69, v69, v182
    v_sub_f32 v117, v117, v182
    v_sub_f32 v85, v85, v182
    v_sub_f32 v70, v70, v182
    v_sub_f32 v118, v118, v182
    v_sub_f32 v86, v86, v182
    v_sub_f32 v71, v71, v182
    v_sub_f32 v119, v119, v182
    v_sub_f32 v87, v87, v182
    v_sub_f32 v72, v72, v182
    v_sub_f32 v120, v120, v182
    v_sub_f32 v88, v88, v182
    v_sub_f32 v73, v73, v182
    v_sub_f32 v121, v121, v182
    v_sub_f32 v89, v89, v182
    v_sub_f32 v74, v74, v182
    v_sub_f32 v122, v122, v182
    v_sub_f32 v90, v90, v182
    v_sub_f32 v75, v75, v182
    v_sub_f32 v123, v123, v182
    v_sub_f32 v91, v91, v182
    v_sub_f32 v76, v76, v182
    v_sub_f32 v124, v124, v182
    v_sub_f32 v92, v92, v182
    v_sub_f32 v77, v77, v182
    v_sub_f32 v125, v125, v182
    v_sub_f32 v93, v93, v182
    v_sub_f32 v78, v78, v182
    v_sub_f32 v126, v126, v182
    v_sub_f32 v94, v94, v182
    v_sub_f32 v79, v79, v182
    v_sub_f32 v127, v127, v182
    v_sub_f32 v95, v95, v182
    v_exp_f32 v96, v64
    v_exp_f32 v97, v65
    v_exp_f32 v98, v66
    v_exp_f32 v99, v67
    v_exp_f32 v100, v68
    v_exp_f32 v101, v69
    v_exp_f32 v102, v70
    v_exp_f32 v103, v71
    v_exp_f32 v104, v72
    v_exp_f32 v105, v73
    v_exp_f32 v106, v74
    v_exp_f32 v107, v75
    v_exp_f32 v108, v76
    v_exp_f32 v109, v77
    v_exp_f32 v110, v78
    v_exp_f32 v111, v79
    s_nop 3
    v_add_f32 v176, v178, v96
    v_add_f32 v177, v179, v97
    v_add_f32 v176, v176, v98
    v_add_f32 v177, v177, v99
    v_add_f32 v176, v176, v100
    v_add_f32 v177, v177, v101
    v_add_f32 v176, v176, v102
    v_add_f32 v177, v177, v103
    v_add_f32 v176, v176, v104
    v_add_f32 v177, v177, v105
    v_add_f32 v176, v176, v106
    v_add_f32 v177, v177, v107
    v_add_f32 v176, v176, v108
    v_add_f32 v177, v177, v109
    v_add_f32 v176, v176, v110
    v_add_f32 v177, v177, v111
    s_nop 7
    s_branch L_back8
L_rare9:
    s_nop 15
    s_nop 15
    v_max3_f32 v182, v80, v81, v82
    v_max3_f32 v182, v83, v84, v182
    v_max3_f32 v182, v85, v86, v182
    v_max3_f32 v182, v87, v88, v182
    v_max3_f32 v182, v89, v90, v182
    v_max3_f32 v182, v91, v92, v182
    v_max3_f32 v182, v93, v94, v182
    v_max_f32 v182, v182, v95
    v_mov_b32 v183, v182
    s_nop 3
    v_permlane32_swap_b32 v182, v183
    s_nop 3
    v_max3_f32 v182, v182, v183, 0
    v_sub_f32 v183, 0, v182
    v_exp_f32 v183, v183
    s_nop 3
    v_mul_f32 v0, v0, v183
    v_mul_f32 v1, v1, v183
    v_mul_f32 v2, v2, v183
    v_mul_f32 v3, v3, v183
    v_mul_f32 v4, v4, v183
    v_mul_f32 v5, v5, v183
    v_mul_f32 v6, v6, v183
    v_mul_f32 v7, v7, v183
    v_mul_f32 v8, v8, v183
    v_mul_f32 v9, v9, v183
    v_mul_f32 v10, v10, v183
    v_mul_f32 v11, v11, v183
    v_mul_f32 v12, v12, v183
    v_mul_f32 v13, v13, v183
    v_mul_f32 v14, v14, v183
    v_mul_f32 v15, v15, v183
    v_mul_f32 v16, v16, v183
    v_mul_f32 v17, v17, v183
    v_mul_f32 v18, v18, v183
    v_mul_f32 v19, v19, v183
    v_mul_f32 v20, v20, v183
    v_mul_f32 v21, v21, v183
    v_mul_f32 v22, v22, v183
    v_mul_f32 v23, v23, v183
    v_mul_f32 v24, v24, v183
    v_mul_f32 v25, v25, v183
    v_mul_f32 v26, v26, v183
    v_mul_f32 v27, v27, v183
    v_mul_f32 v28, v28, v183
    v_mul_f32 v29, v29, v183
    v_mul_f32 v30, v30, v183
    v_mul_f32 v31, v31, v183
    v_mul_f32 v32, v32, v183
    v_mul_f32 v33, v33, v183
    v_mul_f32 v34, v34, v183
    v_mul_f32 v35, v35, v183
    v_mul_f32 v36, v36, v183
    v_mul_f32 v37, v37, v183
    v_mul_f32 v38, v38, v183
    v_mul_f32 v39, v39, v183
    v_mul_f32 v40, v40, v183
    v_mul_f32 v41, v41, v183
    v_mul_f32 v42, v42, v183
    v_mul_f32 v43, v43, v183
    v_mul_f32 v44, v44, v183
    v_mul_f32 v45, v45, v183
    v_mul_f32 v46, v46, v183
    v_mul_f32 v47, v47, v183
    v_mul_f32 v48, v48, v183
    v_mul_f32 v49, v49, v183
    v_mul_f32 v50, v50, v183
    v_mul_f32 v51, v51, v183
    v_mul_f32 v52, v52, v183
    v_mul_f32 v53, v53, v183
    v_mul_f32 v54, v54, v183
    v_mul_f32 v55, v55, v183
    v_mul_f32 v56, v56, v183
    v_mul_f32 v57, v57, v183
    v_mul_f32 v58, v58, v183
    v_mul_f32 v59, v59, v183
    v_mul_f32 v60, v60, v183
    v_mul_f32 v61, v61, v183
    v_mul_f32 v62, v62, v183
    v_mul_f32 v63, v63, v183
    v_mul_f32 v176, v176, v183
    v_mul_f32 v177, v177, v183
    v_sub_f32 v80, v80, v182
    v_sub_f32 v112, v112, v182
    v_sub_f32 v64, v64, v182
    v_sub_f32 v81, v81, v182
    v_sub_f32 v113, v113, v182
    v_sub_f32 v65, v65, v182
    v_sub_f32 v82, v82, v182
    v_sub_f32 v114, v114, v182
    v_sub_f32 v66, v66, v182
    v_sub_f32 v83, v83, v182
    v_sub_f32 v115, v115, v182
    v_sub_f32 v67, v67, v182
    v_sub_f32 v84, v84, v182
    v_sub_f32 v116, v116, v182
    v_sub_f32 v68, v68, v182
    v_sub_f32 v85, v85, v182
    v_sub_f32 v117, v117, v182
    v_sub_f32 v69, v69, v182
    v_sub_f32 v86, v86, v182
    v_sub_f32 v118, v118, v182
    v_sub_f32 v70, v70, v182
    v_sub_f32 v87, v87, v182
    v_sub_f32 v119, v119, v182
    v_sub_f32 v71, v71, v182
    v_sub_f32 v88, v88, v182
    v_sub_f32 v120, v120, v182
    v_sub_f32 v72, v72, v182
    v_sub_f32 v89, v89, v182
    v_sub_f32 v121, v121, v182
    v_sub_f32 v73, v73, v182
    v_sub_f32 v90, v90, v182
    v_sub_f32 v122, v122, v182
    v_sub_f32 v74, v74, v182
    v_sub_f32 v91, v91, v182
    v_sub_f32 v123, v123, v182
    v_sub_f32 v75, v75, v182
    v_sub_f32 v92, v92, v182
    v_sub_f32 v124, v124, v182
    v_sub_f32 v76, v76, v182
    v_sub_f32 v93, v93, v182
    v_sub_f32 v125, v125, v182
    v_sub_f32 v77, v77, v182
    v_sub_f32 v94, v94, v182
    v_sub_f32 v126, v126, v182
    v_sub_f32 v78, v78, v182
    v_sub_f32 v95, v95, v182
    v_sub_f32 v127, v127, v182
    v_sub_f32 v79, v79, v182
    v_exp_f32 v96, v80
    v_exp_f32 v97, v81
    v_exp_f32 v98, v82
    v_exp_f32 v99, v83
    v_exp_f32 v100, v84
    v_exp_f32 v101, v85
    v_exp_f32 v102, v86
    v_exp_f32 v103, v87
    v_exp_f32 v104, v88
    v_exp_f32 v105, v89
    v_exp_f32 v106, v90
    v_exp_f32 v107, v91
    v_exp_f32 v108, v92
    v_exp_f32 v109, v93
    v_exp_f32 v110, v94
    v_exp_f32 v111, v95
    s_nop 3
    v_add_f32 v178, v176, v96
    v_add_f32 v179, v177, v97
    v_add_f32 v178, v178, v98
    v_add_f32 v179, v179, v99
    v_add_f32 v178, v178, v100
    v_add_f32 v179, v179, v101
    v_add_f32 v178, v178, v102
    v_add_f32 v179, v179, v103
    v_add_f32 v178, v178, v104
    v_add_f32 v179, v179, v105
    v_add_f32 v178, v178, v106
    v_add_f32 v179, v179, v107
    v_add_f32 v178, v178, v108
    v_add_f32 v179, v179, v109
    v_add_f32 v178, v178, v110
    v_add_f32 v179, v179, v111
    s_nop 7
    s_branch L_back9
L_rare10:
    s_nop 15
    s_nop 15
    v_max3_f32 v182, v64, v65, v66
    v_max3_f32 v182, v67, v68, v182
    v_max3_f32 v182, v69, v70, v182
    v_max3_f32 v182, v71, v72, v182
    v_max3_f32 v182, v73, v74, v182
    v_max3_f32 v182, v75, v76, v182
    v_max3_f32 v182, v77, v78, v182
    v_max_f32 v182, v182, v79
    v_mov_b32 v183, v182
    s_nop 3
    v_permlane32_swap_b32 v182, v183
    s_nop 3
    v_max3_f32 v182, v182, v183, 0
    v_sub_f32 v183, 0, v182
    v_exp_f32 v183, v183
    s_nop 3
    v_mul_f32 v0, v0, v183
    v_mul_f32 v1, v1, v183
    v_mul_f32 v2, v2, v183
    v_mul_f32 v3, v3, v183
    v_mul_f32 v4, v4, v183
    v_mul_f32 v5, v5, v183
    v_mul_f32 v6, v6, v183
    v_mul_f32 v7, v7, v183
    v_mul_f32 v8, v8, v183
    v_mul_f32 v9, v9, v183
    v_mul_f32 v10, v10, v183
    v_mul_f32 v11, v11, v183
    v_mul_f32 v12, v12, v183
    v_mul_f32 v13, v13, v183
    v_mul_f32 v14, v14, v183
    v_mul_f32 v15, v15, v183
    v_mul_f32 v16, v16, v183
    v_mul_f32 v17, v17, v183
    v_mul_f32 v18, v18, v183
    v_mul_f32 v19, v19, v183
    v_mul_f32 v20, v20, v183
    v_mul_f32 v21, v21, v183
    v_mul_f32 v22, v22, v183
    v_mul_f32 v23, v23, v183
    v_mul_f32 v24, v24, v183
    v_mul_f32 v25, v25, v183
    v_mul_f32 v26, v26, v183
    v_mul_f32 v27, v27, v183
    v_mul_f32 v28, v28, v183
    v_mul_f32 v29, v29, v183
    v_mul_f32 v30, v30, v183
    v_mul_f32 v31, v31, v183
    v_mul_f32 v32, v32, v183
    v_mul_f32 v33, v33, v183
    v_mul_f32 v34, v34, v183
    v_mul_f32 v35, v35, v183
    v_mul_f32 v36, v36, v183
    v_mul_f32 v37, v37, v183
    v_mul_f32 v38, v38, v183
    v_mul_f32 v39, v39, v183
    v_mul_f32 v40, v40, v183
    v_mul_f32 v41, v41, v183
    v_mul_f32 v42, v42, v183
    v_mul_f32 v43, v43, v183
    v_mul_f32 v44, v44, v183
    v_mul_f32 v45, v45, v183
    v_mul_f32 v46, v46, v183
    v_mul_f32 v47, v47, v183
    v_mul_f32 v48, v48, v183
    v_mul_f32 v49, v49, v183
    v_mul_f32 v50, v50, v183
    v_mul_f32 v51, v51, v183
    v_mul_f32 v52, v52, v183
    v_mul_f32 v53, v53, v183
    v_mul_f32 v54, v54, v183
    v_mul_f32 v55, v55, v183
    v_mul_f32 v56, v56, v183
    v_mul_f32 v57, v57, v183
    v_mul_f32 v58, v58, v183
    v_mul_f32 v59, v59, v183
    v_mul_f32 v60, v60, v183
    v_mul_f32 v61, v61, v183
    v_mul_f32 v62, v62, v183
    v_mul_f32 v63, v63, v183
    v_mul_f32 v178, v178, v183
    v_mul_f32 v179, v179, v183
    v_sub_f32 v64, v64, v182
    v_sub_f32 v112, v112, v182
    v_sub_f32 v80, v80, v182
    v_sub_f32 v65, v65, v182
    v_sub_f32 v113, v113, v182
    v_sub_f32 v81, v81, v182
    v_sub_f32 v66, v66, v182
    v_sub_f32 v114, v114, v182
    v_sub_f32 v82, v82, v182
    v_sub_f32 v67, v67, v182
    v_sub_f32 v115, v115, v182
    v_sub_f32 v83, v83, v182
    v_sub_f32 v68, v68, v182
    v_sub_f32 v116, v116, v182
    v_sub_f32 v84, v84, v182
    v_sub_f32 v69, v69, v182
    v_sub_f32 v117, v117, v182
    v_sub_f32 v85, v85, v182
    v_sub_f32 v70, v70, v182
    v_sub_f32 v118, v118, v182
    v_sub_f32 v86, v86, v182
    v_sub_f32 v71, v71, v182
    v_sub_f32 v119, v119, v182
    v_sub_f32 v87, v87, v182
    v_sub_f32 v72, v72, v182
    v_sub_f32 v120, v120, v182
    v_sub_f32 v88, v88, v182
    v_sub_f32 v73, v73, v182
    v_sub_f32 v121, v121, v182
    v_sub_f32 v89, v89, v182
    v_sub_f32 v74, v74, v182
    v_sub_f32 v122, v122, v182
    v_sub_f32 v90, v90, v182
    v_sub_f32 v75, v75, v182
    v_sub_f32 v123, v123, v182
    v_sub_f32 v91, v91, v182
    v_sub_f32 v76, v76, v182
    v_sub_f32 v124, v124, v182
    v_sub_f32 v92, v92, v182
    v_sub_f32 v77, v77, v182
    v_sub_f32 v125, v125, v182
    v_sub_f32 v93, v93, v182
    v_sub_f32 v78, v78, v182
    v_sub_f32 v126, v126, v182
    v_sub_f32 v94, v94, v182
    v_sub_f32 v79, v79, v182
    v_sub_f32 v127, v127, v182
    v_sub_f32 v95, v95, v182
    v_exp_f32 v96, v64
    v_exp_f32 v97, v65
    v_exp_f32 v98, v66
    v_exp_f32 v99, v67
    v_exp_f32 v100, v68
    v_exp_f32 v101, v69
    v_exp_f32 v102, v70
    v_exp_f32 v103, v71
    v_exp_f32 v104, v72
    v_exp_f32 v105, v73
    v_exp_f32 v106, v74
    v_exp_f32 v107, v75
    v_exp_f32 v108, v76
    v_exp_f32 v109, v77
    v_exp_f32 v110, v78
    v_exp_f32 v111, v79
    s_nop 3
    v_add_f32 v176, v178, v96
    v_add_f32 v177, v179, v97
    v_add_f32 v176, v176, v98
    v_add_f32 v177, v177, v99
    v_add_f32 v176, v176, v100
    v_add_f32 v177, v177, v101
    v_add_f32 v176, v176, v102
    v_add_f32 v177, v177, v103
    v_add_f32 v176, v176, v104
    v_add_f32 v177, v177, v105
    v_add_f32 v176, v176, v106
    v_add_f32 v177, v177, v107
    v_add_f32 v176, v176, v108
    v_add_f32 v177, v177, v109
    v_add_f32 v176, v176, v110
    v_add_f32 v177, v177, v111
    s_nop 7
    s_branch L_back10
L_rare11:
    s_nop 15
    s_nop 15
    v_max3_f32 v182, v80, v81, v82
    v_max3_f32 v182, v83, v84, v182
    v_max3_f32 v182, v85, v86, v182
    v_max3_f32 v182, v87, v88, v182
    v_max3_f32 v182, v89, v90, v182
    v_max3_f32 v182, v91, v92, v182
    v_max3_f32 v182, v93, v94, v182
    v_max_f32 v182, v182, v95
    v_mov_b32 v183, v182
    s_nop 3
    v_permlane32_swap_b32 v182, v183
    s_nop 3
    v_max3_f32 v182, v182, v183, 0
    v_sub_f32 v183, 0, v182
    v_exp_f32 v183, v183
    s_nop 3
    v_mul_f32 v0, v0, v183
    v_mul_f32 v1, v1, v183
    v_mul_f32 v2, v2, v183
    v_mul_f32 v3, v3, v183
    v_mul_f32 v4, v4, v183
    v_mul_f32 v5, v5, v183
    v_mul_f32 v6, v6, v183
    v_mul_f32 v7, v7, v183
    v_mul_f32 v8, v8, v183
    v_mul_f32 v9, v9, v183
    v_mul_f32 v10, v10, v183
    v_mul_f32 v11, v11, v183
    v_mul_f32 v12, v12, v183
    v_mul_f32 v13, v13, v183
    v_mul_f32 v14, v14, v183
    v_mul_f32 v15, v15, v183
    v_mul_f32 v16, v16, v183
    v_mul_f32 v17, v17, v183
    v_mul_f32 v18, v18, v183
    v_mul_f32 v19, v19, v183
    v_mul_f32 v20, v20, v183
    v_mul_f32 v21, v21, v183
    v_mul_f32 v22, v22, v183
    v_mul_f32 v23, v23, v183
    v_mul_f32 v24, v24, v183
    v_mul_f32 v25, v25, v183
    v_mul_f32 v26, v26, v183
    v_mul_f32 v27, v27, v183
    v_mul_f32 v28, v28, v183
    v_mul_f32 v29, v29, v183
    v_mul_f32 v30, v30, v183
    v_mul_f32 v31, v31, v183
    v_mul_f32 v32, v32, v183
    v_mul_f32 v33, v33, v183
    v_mul_f32 v34, v34, v183
    v_mul_f32 v35, v35, v183
    v_mul_f32 v36, v36, v183
    v_mul_f32 v37, v37, v183
    v_mul_f32 v38, v38, v183
    v_mul_f32 v39, v39, v183
    v_mul_f32 v40, v40, v183
    v_mul_f32 v41, v41, v183
    v_mul_f32 v42, v42, v183
    v_mul_f32 v43, v43, v183
    v_mul_f32 v44, v44, v183
    v_mul_f32 v45, v45, v183
    v_mul_f32 v46, v46, v183
    v_mul_f32 v47, v47, v183
    v_mul_f32 v48, v48, v183
    v_mul_f32 v49, v49, v183
    v_mul_f32 v50, v50, v183
    v_mul_f32 v51, v51, v183
    v_mul_f32 v52, v52, v183
    v_mul_f32 v53, v53, v183
    v_mul_f32 v54, v54, v183
    v_mul_f32 v55, v55, v183
    v_mul_f32 v56, v56, v183
    v_mul_f32 v57, v57, v183
    v_mul_f32 v58, v58, v183
    v_mul_f32 v59, v59, v183
    v_mul_f32 v60, v60, v183
    v_mul_f32 v61, v61, v183
    v_mul_f32 v62, v62, v183
    v_mul_f32 v63, v63, v183
    v_mul_f32 v176, v176, v183
    v_mul_f32 v177, v177, v183
    v_sub_f32 v80, v80, v182
    v_sub_f32 v112, v112, v182
    v_sub_f32 v64, v64, v182
    v_sub_f32 v81, v81, v182
    v_sub_f32 v113, v113, v182
    v_sub_f32 v65, v65, v182
    v_sub_f32 v82, v82, v182
    v_sub_f32 v114, v114, v182
    v_sub_f32 v66, v66, v182
    v_sub_f32 v83, v83, v182
    v_sub_f32 v115, v115, v182
    v_sub_f32 v67, v67, v182
    v_sub_f32 v84, v84, v182
    v_sub_f32 v116, v116, v182
    v_sub_f32 v68, v68, v182
    v_sub_f32 v85, v85, v182
    v_sub_f32 v117, v117, v182
    v_sub_f32 v69, v69, v182
    v_sub_f32 v86, v86, v182
    v_sub_f32 v118, v118, v182
    v_sub_f32 v70, v70, v182
    v_sub_f32 v87, v87, v182
    v_sub_f32 v119, v119, v182
    v_sub_f32 v71, v71, v182
    v_sub_f32 v88, v88, v182
    v_sub_f32 v120, v120, v182
    v_sub_f32 v72, v72, v182
    v_sub_f32 v89, v89, v182
    v_sub_f32 v121, v121, v182
    v_sub_f32 v73, v73, v182
    v_sub_f32 v90, v90, v182
    v_sub_f32 v122, v122, v182
    v_sub_f32 v74, v74, v182
    v_sub_f32 v91, v91, v182
    v_sub_f32 v123, v123, v182
    v_sub_f32 v75, v75, v182
    v_sub_f32 v92, v92, v182
    v_sub_f32 v124, v124, v182
    v_sub_f32 v76, v76, v182
    v_sub_f32 v93, v93, v182
    v_sub_f32 v125, v125, v182
    v_sub_f32 v77, v77, v182
    v_sub_f32 v94, v94, v182
    v_sub_f32 v126, v126, v182
    v_sub_f32 v78, v78, v182
    v_sub_f32 v95, v95, v182
    v_sub_f32 v127, v127, v182
    v_sub_f32 v79, v79, v182
    v_exp_f32 v96, v80
    v_exp_f32 v97, v81
    v_exp_f32 v98, v82
    v_exp_f32 v99, v83
    v_exp_f32 v100, v84
    v_exp_f32 v101, v85
    v_exp_f32 v102, v86
    v_exp_f32 v103, v87
    v_exp_f32 v104, v88
    v_exp_f32 v105, v89
    v_exp_f32 v106, v90
    v_exp_f32 v107, v91
    v_exp_f32 v108, v92
    v_exp_f32 v109, v93
    v_exp_f32 v110, v94
    v_exp_f32 v111, v95
    s_nop 3
    v_add_f32 v178, v176, v96
    v_add_f32 v179, v177, v97
    v_add_f32 v178, v178, v98
    v_add_f32 v179, v179, v99
    v_add_f32 v178, v178, v100
    v_add_f32 v179, v179, v101
    v_add_f32 v178, v178, v102
    v_add_f32 v179, v179, v103
    v_add_f32 v178, v178, v104
    v_add_f32 v179, v179, v105
    v_add_f32 v178, v178, v106
    v_add_f32 v179, v179, v107
    v_add_f32 v178, v178, v108
    v_add_f32 v179, v179, v109
    v_add_f32 v178, v178, v110
    v_add_f32 v179, v179, v111
    s_nop 7
    s_branch L_back11
L_rare12:
    s_nop 15
    s_nop 15
    v_max3_f32 v182, v64, v65, v66
    v_max3_f32 v182, v67, v68, v182
    v_max3_f32 v182, v69, v70, v182
    v_max3_f32 v182, v71, v72, v182
    v_max3_f32 v182, v73, v74, v182
    v_max3_f32 v182, v75, v76, v182
    v_max3_f32 v182, v77, v78, v182
    v_max_f32 v182, v182, v79
    v_mov_b32 v183, v182
    s_nop 3
    v_permlane32_swap_b32 v182, v183
    s_nop 3
    v_max3_f32 v182, v182, v183, 0
    v_sub_f32 v183, 0, v182
    v_exp_f32 v183, v183
    s_nop 3
    v_mul_f32 v0, v0, v183
    v_mul_f32 v1, v1, v183
    v_mul_f32 v2, v2, v183
    v_mul_f32 v3, v3, v183
    v_mul_f32 v4, v4, v183
    v_mul_f32 v5, v5, v183
    v_mul_f32 v6, v6, v183
    v_mul_f32 v7, v7, v183
    v_mul_f32 v8, v8, v183
    v_mul_f32 v9, v9, v183
    v_mul_f32 v10, v10, v183
    v_mul_f32 v11, v11, v183
    v_mul_f32 v12, v12, v183
    v_mul_f32 v13, v13, v183
    v_mul_f32 v14, v14, v183
    v_mul_f32 v15, v15, v183
    v_mul_f32 v16, v16, v183
    v_mul_f32 v17, v17, v183
    v_mul_f32 v18, v18, v183
    v_mul_f32 v19, v19, v183
    v_mul_f32 v20, v20, v183
    v_mul_f32 v21, v21, v183
    v_mul_f32 v22, v22, v183
    v_mul_f32 v23, v23, v183
    v_mul_f32 v24, v24, v183
    v_mul_f32 v25, v25, v183
    v_mul_f32 v26, v26, v183
    v_mul_f32 v27, v27, v183
    v_mul_f32 v28, v28, v183
    v_mul_f32 v29, v29, v183
    v_mul_f32 v30, v30, v183
    v_mul_f32 v31, v31, v183
    v_mul_f32 v32, v32, v183
    v_mul_f32 v33, v33, v183
    v_mul_f32 v34, v34, v183
    v_mul_f32 v35, v35, v183
    v_mul_f32 v36, v36, v183
    v_mul_f32 v37, v37, v183
    v_mul_f32 v38, v38, v183
    v_mul_f32 v39, v39, v183
    v_mul_f32 v40, v40, v183
    v_mul_f32 v41, v41, v183
    v_mul_f32 v42, v42, v183
    v_mul_f32 v43, v43, v183
    v_mul_f32 v44, v44, v183
    v_mul_f32 v45, v45, v183
    v_mul_f32 v46, v46, v183
    v_mul_f32 v47, v47, v183
    v_mul_f32 v48, v48, v183
    v_mul_f32 v49, v49, v183
    v_mul_f32 v50, v50, v183
    v_mul_f32 v51, v51, v183
    v_mul_f32 v52, v52, v183
    v_mul_f32 v53, v53, v183
    v_mul_f32 v54, v54, v183
    v_mul_f32 v55, v55, v183
    v_mul_f32 v56, v56, v183
    v_mul_f32 v57, v57, v183
    v_mul_f32 v58, v58, v183
    v_mul_f32 v59, v59, v183
    v_mul_f32 v60, v60, v183
    v_mul_f32 v61, v61, v183
    v_mul_f32 v62, v62, v183
    v_mul_f32 v63, v63, v183
    v_mul_f32 v178, v178, v183
    v_mul_f32 v179, v179, v183
    v_sub_f32 v64, v64, v182
    v_sub_f32 v112, v112, v182
    v_sub_f32 v80, v80, v182
    v_sub_f32 v65, v65, v182
    v_sub_f32 v113, v113, v182
    v_sub_f32 v81, v81, v182
    v_sub_f32 v66, v66, v182
    v_sub_f32 v114, v114, v182
    v_sub_f32 v82, v82, v182
    v_sub_f32 v67, v67, v182
    v_sub_f32 v115, v115, v182
    v_sub_f32 v83, v83, v182
    v_sub_f32 v68, v68, v182
    v_sub_f32 v116, v116, v182
    v_sub_f32 v84, v84, v182
    v_sub_f32 v69, v69, v182
    v_sub_f32 v117, v117, v182
    v_sub_f32 v85, v85, v182
    v_sub_f32 v70, v70, v182
    v_sub_f32 v118, v118, v182
    v_sub_f32 v86, v86, v182
    v_sub_f32 v71, v71, v182
    v_sub_f32 v119, v119, v182
    v_sub_f32 v87, v87, v182
    v_sub_f32 v72, v72, v182
    v_sub_f32 v120, v120, v182
    v_sub_f32 v88, v88, v182
    v_sub_f32 v73, v73, v182
    v_sub_f32 v121, v121, v182
    v_sub_f32 v89, v89, v182
    v_sub_f32 v74, v74, v182
    v_sub_f32 v122, v122, v182
    v_sub_f32 v90, v90, v182
    v_sub_f32 v75, v75, v182
    v_sub_f32 v123, v123, v182
    v_sub_f32 v91, v91, v182
    v_sub_f32 v76, v76, v182
    v_sub_f32 v124, v124, v182
    v_sub_f32 v92, v92, v182
    v_sub_f32 v77, v77, v182
    v_sub_f32 v125, v125, v182
    v_sub_f32 v93, v93, v182
    v_sub_f32 v78, v78, v182
    v_sub_f32 v126, v126, v182
    v_sub_f32 v94, v94, v182
    v_sub_f32 v79, v79, v182
    v_sub_f32 v127, v127, v182
    v_sub_f32 v95, v95, v182
    v_exp_f32 v96, v64
    v_exp_f32 v97, v65
    v_exp_f32 v98, v66
    v_exp_f32 v99, v67
    v_exp_f32 v100, v68
    v_exp_f32 v101, v69
    v_exp_f32 v102, v70
    v_exp_f32 v103, v71
    v_exp_f32 v104, v72
    v_exp_f32 v105, v73
    v_exp_f32 v106, v74
    v_exp_f32 v107, v75
    v_exp_f32 v108, v76
    v_exp_f32 v109, v77
    v_exp_f32 v110, v78
    v_exp_f32 v111, v79
    s_nop 3
    v_add_f32 v176, v178, v96
    v_add_f32 v177, v179, v97
    v_add_f32 v176, v176, v98
    v_add_f32 v177, v177, v99
    v_add_f32 v176, v176, v100
    v_add_f32 v177, v177, v101
    v_add_f32 v176, v176, v102
    v_add_f32 v177, v177, v103
    v_add_f32 v176, v176, v104
    v_add_f32 v177, v177, v105
    v_add_f32 v176, v176, v106
    v_add_f32 v177, v177, v107
    v_add_f32 v176, v176, v108
    v_add_f32 v177, v177, v109
    v_add_f32 v176, v176, v110
    v_add_f32 v177, v177, v111
    s_nop 7
    s_branch L_back12
L_rare13:
    s_nop 15
    s_nop 15
    v_max3_f32 v182, v80, v81, v82
    v_max3_f32 v182, v83, v84, v182
    v_max3_f32 v182, v85, v86, v182
    v_max3_f32 v182, v87, v88, v182
    v_max3_f32 v182, v89, v90, v182
    v_max3_f32 v182, v91, v92, v182
    v_max3_f32 v182, v93, v94, v182
    v_max_f32 v182, v182, v95
    v_mov_b32 v183, v182
    s_nop 3
    v_permlane32_swap_b32 v182, v183
    s_nop 3
    v_max3_f32 v182, v182, v183, 0
    v_sub_f32 v183, 0, v182
    v_exp_f32 v183, v183
    s_nop 3
    v_mul_f32 v0, v0, v183
    v_mul_f32 v1, v1, v183
    v_mul_f32 v2, v2, v183
    v_mul_f32 v3, v3, v183
    v_mul_f32 v4, v4, v183
    v_mul_f32 v5, v5, v183
    v_mul_f32 v6, v6, v183
    v_mul_f32 v7, v7, v183
    v_mul_f32 v8, v8, v183
    v_mul_f32 v9, v9, v183
    v_mul_f32 v10, v10, v183
    v_mul_f32 v11, v11, v183
    v_mul_f32 v12, v12, v183
    v_mul_f32 v13, v13, v183
    v_mul_f32 v14, v14, v183
    v_mul_f32 v15, v15, v183
    v_mul_f32 v16, v16, v183
    v_mul_f32 v17, v17, v183
    v_mul_f32 v18, v18, v183
    v_mul_f32 v19, v19, v183
    v_mul_f32 v20, v20, v183
    v_mul_f32 v21, v21, v183
    v_mul_f32 v22, v22, v183
    v_mul_f32 v23, v23, v183
    v_mul_f32 v24, v24, v183
    v_mul_f32 v25, v25, v183
    v_mul_f32 v26, v26, v183
    v_mul_f32 v27, v27, v183
    v_mul_f32 v28, v28, v183
    v_mul_f32 v29, v29, v183
    v_mul_f32 v30, v30, v183
    v_mul_f32 v31, v31, v183
    v_mul_f32 v32, v32, v183
    v_mul_f32 v33, v33, v183
    v_mul_f32 v34, v34, v183
    v_mul_f32 v35, v35, v183
    v_mul_f32 v36, v36, v183
    v_mul_f32 v37, v37, v183
    v_mul_f32 v38, v38, v183
    v_mul_f32 v39, v39, v183
    v_mul_f32 v40, v40, v183
    v_mul_f32 v41, v41, v183
    v_mul_f32 v42, v42, v183
    v_mul_f32 v43, v43, v183
    v_mul_f32 v44, v44, v183
    v_mul_f32 v45, v45, v183
    v_mul_f32 v46, v46, v183
    v_mul_f32 v47, v47, v183
    v_mul_f32 v48, v48, v183
    v_mul_f32 v49, v49, v183
    v_mul_f32 v50, v50, v183
    v_mul_f32 v51, v51, v183
    v_mul_f32 v52, v52, v183
    v_mul_f32 v53, v53, v183
    v_mul_f32 v54, v54, v183
    v_mul_f32 v55, v55, v183
    v_mul_f32 v56, v56, v183
    v_mul_f32 v57, v57, v183
    v_mul_f32 v58, v58, v183
    v_mul_f32 v59, v59, v183
    v_mul_f32 v60, v60, v183
    v_mul_f32 v61, v61, v183
    v_mul_f32 v62, v62, v183
    v_mul_f32 v63, v63, v183
    v_mul_f32 v176, v176, v183
    v_mul_f32 v177, v177, v183
    v_sub_f32 v80, v80, v182
    v_sub_f32 v112, v112, v182
    v_sub_f32 v64, v64, v182
    v_sub_f32 v81, v81, v182
    v_sub_f32 v113, v113, v182
    v_sub_f32 v65, v65, v182
    v_sub_f32 v82, v82, v182
    v_sub_f32 v114, v114, v182
    v_sub_f32 v66, v66, v182
    v_sub_f32 v83, v83, v182
    v_sub_f32 v115, v115, v182
    v_sub_f32 v67, v67, v182
    v_sub_f32 v84, v84, v182
    v_sub_f32 v116, v116, v182
    v_sub_f32 v68, v68, v182
    v_sub_f32 v85, v85, v182
    v_sub_f32 v117, v117, v182
    v_sub_f32 v69, v69, v182
    v_sub_f32 v86, v86, v182
    v_sub_f32 v118, v118, v182
    v_sub_f32 v70, v70, v182
    v_sub_f32 v87, v87, v182
    v_sub_f32 v119, v119, v182
    v_sub_f32 v71, v71, v182
    v_sub_f32 v88, v88, v182
    v_sub_f32 v120, v120, v182
    v_sub_f32 v72, v72, v182
    v_sub_f32 v89, v89, v182
    v_sub_f32 v121, v121, v182
    v_sub_f32 v73, v73, v182
    v_sub_f32 v90, v90, v182
    v_sub_f32 v122, v122, v182
    v_sub_f32 v74, v74, v182
    v_sub_f32 v91, v91, v182
    v_sub_f32 v123, v123, v182
    v_sub_f32 v75, v75, v182
    v_sub_f32 v92, v92, v182
    v_sub_f32 v124, v124, v182
    v_sub_f32 v76, v76, v182
    v_sub_f32 v93, v93, v182
    v_sub_f32 v125, v125, v182
    v_sub_f32 v77, v77, v182
    v_sub_f32 v94, v94, v182
    v_sub_f32 v126, v126, v182
    v_sub_f32 v78, v78, v182
    v_sub_f32 v95, v95, v182
    v_sub_f32 v127, v127, v182
    v_sub_f32 v79, v79, v182
    v_exp_f32 v96, v80
    v_exp_f32 v97, v81
    v_exp_f32 v98, v82
    v_exp_f32 v99, v83
    v_exp_f32 v100, v84
    v_exp_f32 v101, v85
    v_exp_f32 v102, v86
    v_exp_f32 v103, v87
    v_exp_f32 v104, v88
    v_exp_f32 v105, v89
    v_exp_f32 v106, v90
    v_exp_f32 v107, v91
    v_exp_f32 v108, v92
    v_exp_f32 v109, v93
    v_exp_f32 v110, v94
    v_exp_f32 v111, v95
    s_nop 3
    v_add_f32 v178, v176, v96
    v_add_f32 v179, v177, v97
    v_add_f32 v178, v178, v98
    v_add_f32 v179, v179, v99
    v_add_f32 v178, v178, v100
    v_add_f32 v179, v179, v101
    v_add_f32 v178, v178, v102
    v_add_f32 v179, v179, v103
    v_add_f32 v178, v178, v104
    v_add_f32 v179, v179, v105
    v_add_f32 v178, v178, v106
    v_add_f32 v179, v179, v107
    v_add_f32 v178, v178, v108
    v_add_f32 v179, v179, v109
    v_add_f32 v178, v178, v110
    v_add_f32 v179, v179, v111
    s_nop 7
    s_branch L_back13
L_rare14:
    s_nop 15
    s_nop 15
    v_max3_f32 v182, v64, v65, v66
    v_max3_f32 v182, v67, v68, v182
    v_max3_f32 v182, v69, v70, v182
    v_max3_f32 v182, v71, v72, v182
    v_max3_f32 v182, v73, v74, v182
    v_max3_f32 v182, v75, v76, v182
    v_max3_f32 v182, v77, v78, v182
    v_max_f32 v182, v182, v79
    v_mov_b32 v183, v182
    s_nop 3
    v_permlane32_swap_b32 v182, v183
    s_nop 3
    v_max3_f32 v182, v182, v183, 0
    v_sub_f32 v183, 0, v182
    v_exp_f32 v183, v183
    s_nop 3
    v_mul_f32 v0, v0, v183
    v_mul_f32 v1, v1, v183
    v_mul_f32 v2, v2, v183
    v_mul_f32 v3, v3, v183
    v_mul_f32 v4, v4, v183
    v_mul_f32 v5, v5, v183
    v_mul_f32 v6, v6, v183
    v_mul_f32 v7, v7, v183
    v_mul_f32 v8, v8, v183
    v_mul_f32 v9, v9, v183
    v_mul_f32 v10, v10, v183
    v_mul_f32 v11, v11, v183
    v_mul_f32 v12, v12, v183
    v_mul_f32 v13, v13, v183
    v_mul_f32 v14, v14, v183
    v_mul_f32 v15, v15, v183
    v_mul_f32 v16, v16, v183
    v_mul_f32 v17, v17, v183
    v_mul_f32 v18, v18, v183
    v_mul_f32 v19, v19, v183
    v_mul_f32 v20, v20, v183
    v_mul_f32 v21, v21, v183
    v_mul_f32 v22, v22, v183
    v_mul_f32 v23, v23, v183
    v_mul_f32 v24, v24, v183
    v_mul_f32 v25, v25, v183
    v_mul_f32 v26, v26, v183
    v_mul_f32 v27, v27, v183
    v_mul_f32 v28, v28, v183
    v_mul_f32 v29, v29, v183
    v_mul_f32 v30, v30, v183
    v_mul_f32 v31, v31, v183
    v_mul_f32 v32, v32, v183
    v_mul_f32 v33, v33, v183
    v_mul_f32 v34, v34, v183
    v_mul_f32 v35, v35, v183
    v_mul_f32 v36, v36, v183
    v_mul_f32 v37, v37, v183
    v_mul_f32 v38, v38, v183
    v_mul_f32 v39, v39, v183
    v_mul_f32 v40, v40, v183
    v_mul_f32 v41, v41, v183
    v_mul_f32 v42, v42, v183
    v_mul_f32 v43, v43, v183
    v_mul_f32 v44, v44, v183
    v_mul_f32 v45, v45, v183
    v_mul_f32 v46, v46, v183
    v_mul_f32 v47, v47, v183
    v_mul_f32 v48, v48, v183
    v_mul_f32 v49, v49, v183
    v_mul_f32 v50, v50, v183
    v_mul_f32 v51, v51, v183
    v_mul_f32 v52, v52, v183
    v_mul_f32 v53, v53, v183
    v_mul_f32 v54, v54, v183
    v_mul_f32 v55, v55, v183
    v_mul_f32 v56, v56, v183
    v_mul_f32 v57, v57, v183
    v_mul_f32 v58, v58, v183
    v_mul_f32 v59, v59, v183
    v_mul_f32 v60, v60, v183
    v_mul_f32 v61, v61, v183
    v_mul_f32 v62, v62, v183
    v_mul_f32 v63, v63, v183
    v_mul_f32 v178, v178, v183
    v_mul_f32 v179, v179, v183
    v_sub_f32 v64, v64, v182
    v_sub_f32 v112, v112, v182
    v_sub_f32 v80, v80, v182
    v_sub_f32 v65, v65, v182
    v_sub_f32 v113, v113, v182
    v_sub_f32 v81, v81, v182
    v_sub_f32 v66, v66, v182
    v_sub_f32 v114, v114, v182
    v_sub_f32 v82, v82, v182
    v_sub_f32 v67, v67, v182
    v_sub_f32 v115, v115, v182
    v_sub_f32 v83, v83, v182
    v_sub_f32 v68, v68, v182
    v_sub_f32 v116, v116, v182
    v_sub_f32 v84, v84, v182
    v_sub_f32 v69, v69, v182
    v_sub_f32 v117, v117, v182
    v_sub_f32 v85, v85, v182
    v_sub_f32 v70, v70, v182
    v_sub_f32 v118, v118, v182
    v_sub_f32 v86, v86, v182
    v_sub_f32 v71, v71, v182
    v_sub_f32 v119, v119, v182
    v_sub_f32 v87, v87, v182
    v_sub_f32 v72, v72, v182
    v_sub_f32 v120, v120, v182
    v_sub_f32 v88, v88, v182
    v_sub_f32 v73, v73, v182
    v_sub_f32 v121, v121, v182
    v_sub_f32 v89, v89, v182
    v_sub_f32 v74, v74, v182
    v_sub_f32 v122, v122, v182
    v_sub_f32 v90, v90, v182
    v_sub_f32 v75, v75, v182
    v_sub_f32 v123, v123, v182
    v_sub_f32 v91, v91, v182
    v_sub_f32 v76, v76, v182
    v_sub_f32 v124, v124, v182
    v_sub_f32 v92, v92, v182
    v_sub_f32 v77, v77, v182
    v_sub_f32 v125, v125, v182
    v_sub_f32 v93, v93, v182
    v_sub_f32 v78, v78, v182
    v_sub_f32 v126, v126, v182
    v_sub_f32 v94, v94, v182
    v_sub_f32 v79, v79, v182
    v_sub_f32 v127, v127, v182
    v_sub_f32 v95, v95, v182
    v_exp_f32 v96, v64
    v_exp_f32 v97, v65
    v_exp_f32 v98, v66
    v_exp_f32 v99, v67
    v_exp_f32 v100, v68
    v_exp_f32 v101, v69
    v_exp_f32 v102, v70
    v_exp_f32 v103, v71
    v_exp_f32 v104, v72
    v_exp_f32 v105, v73
    v_exp_f32 v106, v74
    v_exp_f32 v107, v75
    v_exp_f32 v108, v76
    v_exp_f32 v109, v77
    v_exp_f32 v110, v78
    v_exp_f32 v111, v79
    s_nop 3
    v_add_f32 v176, v178, v96
    v_add_f32 v177, v179, v97
    v_add_f32 v176, v176, v98
    v_add_f32 v177, v177, v99
    v_add_f32 v176, v176, v100
    v_add_f32 v177, v177, v101
    v_add_f32 v176, v176, v102
    v_add_f32 v177, v177, v103
    v_add_f32 v176, v176, v104
    v_add_f32 v177, v177, v105
    v_add_f32 v176, v176, v106
    v_add_f32 v177, v177, v107
    v_add_f32 v176, v176, v108
    v_add_f32 v177, v177, v109
    v_add_f32 v176, v176, v110
    v_add_f32 v177, v177, v111
    s_nop 7
    s_branch L_back14
L_rare15:
    s_nop 15
    s_nop 15
    v_max3_f32 v182, v80, v81, v82
    v_max3_f32 v182, v83, v84, v182
    v_max3_f32 v182, v85, v86, v182
    v_max3_f32 v182, v87, v88, v182
    v_max3_f32 v182, v89, v90, v182
    v_max3_f32 v182, v91, v92, v182
    v_max3_f32 v182, v93, v94, v182
    v_max_f32 v182, v182, v95
    v_mov_b32 v183, v182
    s_nop 3
    v_permlane32_swap_b32 v182, v183
    s_nop 3
    v_max3_f32 v182, v182, v183, 0
    v_sub_f32 v183, 0, v182
    v_exp_f32 v183, v183
    s_nop 3
    v_mul_f32 v0, v0, v183
    v_mul_f32 v1, v1, v183
    v_mul_f32 v2, v2, v183
    v_mul_f32 v3, v3, v183
    v_mul_f32 v4, v4, v183
    v_mul_f32 v5, v5, v183
    v_mul_f32 v6, v6, v183
    v_mul_f32 v7, v7, v183
    v_mul_f32 v8, v8, v183
    v_mul_f32 v9, v9, v183
    v_mul_f32 v10, v10, v183
    v_mul_f32 v11, v11, v183
    v_mul_f32 v12, v12, v183
    v_mul_f32 v13, v13, v183
    v_mul_f32 v14, v14, v183
    v_mul_f32 v15, v15, v183
    v_mul_f32 v16, v16, v183
    v_mul_f32 v17, v17, v183
    v_mul_f32 v18, v18, v183
    v_mul_f32 v19, v19, v183
    v_mul_f32 v20, v20, v183
    v_mul_f32 v21, v21, v183
    v_mul_f32 v22, v22, v183
    v_mul_f32 v23, v23, v183
    v_mul_f32 v24, v24, v183
    v_mul_f32 v25, v25, v183
    v_mul_f32 v26, v26, v183
    v_mul_f32 v27, v27, v183
    v_mul_f32 v28, v28, v183
    v_mul_f32 v29, v29, v183
    v_mul_f32 v30, v30, v183
    v_mul_f32 v31, v31, v183
    v_mul_f32 v32, v32, v183
    v_mul_f32 v33, v33, v183
    v_mul_f32 v34, v34, v183
    v_mul_f32 v35, v35, v183
    v_mul_f32 v36, v36, v183
    v_mul_f32 v37, v37, v183
    v_mul_f32 v38, v38, v183
    v_mul_f32 v39, v39, v183
    v_mul_f32 v40, v40, v183
    v_mul_f32 v41, v41, v183
    v_mul_f32 v42, v42, v183
    v_mul_f32 v43, v43, v183
    v_mul_f32 v44, v44, v183
    v_mul_f32 v45, v45, v183
    v_mul_f32 v46, v46, v183
    v_mul_f32 v47, v47, v183
    v_mul_f32 v48, v48, v183
    v_mul_f32 v49, v49, v183
    v_mul_f32 v50, v50, v183
    v_mul_f32 v51, v51, v183
    v_mul_f32 v52, v52, v183
    v_mul_f32 v53, v53, v183
    v_mul_f32 v54, v54, v183
    v_mul_f32 v55, v55, v183
    v_mul_f32 v56, v56, v183
    v_mul_f32 v57, v57, v183
    v_mul_f32 v58, v58, v183
    v_mul_f32 v59, v59, v183
    v_mul_f32 v60, v60, v183
    v_mul_f32 v61, v61, v183
    v_mul_f32 v62, v62, v183
    v_mul_f32 v63, v63, v183
    v_mul_f32 v176, v176, v183
    v_mul_f32 v177, v177, v183
    v_sub_f32 v80, v80, v182
    v_sub_f32 v112, v112, v182
    v_sub_f32 v81, v81, v182
    v_sub_f32 v113, v113, v182
    v_sub_f32 v82, v82, v182
    v_sub_f32 v114, v114, v182
    v_sub_f32 v83, v83, v182
    v_sub_f32 v115, v115, v182
    v_sub_f32 v84, v84, v182
    v_sub_f32 v116, v116, v182
    v_sub_f32 v85, v85, v182
    v_sub_f32 v117, v117, v182
    v_sub_f32 v86, v86, v182
    v_sub_f32 v118, v118, v182
    v_sub_f32 v87, v87, v182
    v_sub_f32 v119, v119, v182
    v_sub_f32 v88, v88, v182
    v_sub_f32 v120, v120, v182
    v_sub_f32 v89, v89, v182
    v_sub_f32 v121, v121, v182
    v_sub_f32 v90, v90, v182
    v_sub_f32 v122, v122, v182
    v_sub_f32 v91, v91, v182
    v_sub_f32 v123, v123, v182
    v_sub_f32 v92, v92, v182
    v_sub_f32 v124, v124, v182
    v_sub_f32 v93, v93, v182
    v_sub_f32 v125, v125, v182
    v_sub_f32 v94, v94, v182
    v_sub_f32 v126, v126, v182
    v_sub_f32 v95, v95, v182
    v_sub_f32 v127, v127, v182
    v_exp_f32 v96, v80
    v_exp_f32 v97, v81
    v_exp_f32 v98, v82
    v_exp_f32 v99, v83
    v_exp_f32 v100, v84
    v_exp_f32 v101, v85
    v_exp_f32 v102, v86
    v_exp_f32 v103, v87
    v_exp_f32 v104, v88
    v_exp_f32 v105, v89
    v_exp_f32 v106, v90
    v_exp_f32 v107, v91
    v_exp_f32 v108, v92
    v_exp_f32 v109, v93
    v_exp_f32 v110, v94
    v_exp_f32 v111, v95
    s_nop 3
    v_add_f32 v178, v176, v96
    v_add_f32 v179, v177, v97
    v_add_f32 v178, v178, v98
    v_add_f32 v179, v179, v99
    v_add_f32 v178, v178, v100
    v_add_f32 v179, v179, v101
    v_add_f32 v178, v178, v102
    v_add_f32 v179, v179, v103
    v_add_f32 v178, v178, v104
    v_add_f32 v179, v179, v105
    v_add_f32 v178, v178, v106
    v_add_f32 v179, v179, v107
    v_add_f32 v178, v178, v108
    v_add_f32 v179, v179, v109
    v_add_f32 v178, v178, v110
    v_add_f32 v179, v179, v111
    s_nop 7
    s_branch L_back15
.globl final_kernel
.p2align 8
.type final_kernel,@function
final_kernel:
    s_cmp_ge_u32 s2, 256
    s_cbranch_scc1 L_fin_end
    s_load_dwordx2 s[16:17], s[0:1], 0
    s_load_dwordx2 s[18:19], s[0:1], 72
    s_load_dwordx2 s[20:21], s[0:1], 88
    v_and_b32 v240, 63, v0
    v_lshrrev_b32 v242, 6, v0
    s_nop 0
    v_readfirstlane_b32 s4, v242
    v_mov_b32 v244, v0
    v_lshlrev_b32 v241, 4, v240
    s_and_b32 s7, s2, 7
    s_lshr_b32 s8, s2, 3
    s_and_b32 s5, s7, 3
    s_lshl_b32 s5, s5, 3
    s_and_b32 s6, s8, 7
    s_add_u32 s5, s5, s6
    s_lshr_b32 s6, s7, 2
    s_lshl_b32 s6, s6, 2
    s_lshr_b32 s8, s8, 3
    s_add_u32 s6, s6, s8
    s_mul_i32 s7, s4, 43
    s_cmp_ge_u32 s4, 5
    s_cselect_b32 s8, 1, 0
    s_sub_u32 s7, s7, s8
    s_cmp_ge_u32 s4, 6
    s_cselect_b32 s8, 1, 0
    s_sub_u32 s7, s7, s8
    s_lshl_b32 s7, s7, 10
    s_mul_i32 s9, s5, 704512
    s_add_u32 s9, s9, s7
    s_add_u32 s10, s9, 352256
    s_mul_i32 s11, s6, 700416
    s_add_u32 s11, s11, s7
    s_add_u32 s11, s11, 33554432
    s_add_u32 s12, s11, 350208
    s_sub_u32 s7, s4, 4
    s_cmp_lt_u32 s7, 2
    s_cselect_b32 s13, 1073741824, 0
    s_waitcnt lgkmcnt(0)
    s_mov_b32 s44, s16
    s_and_b32 s45, s17, 65535
    s_mov_b32 s46, 2097152
    s_mov_b32 s47, 131072
    s_mov_b32 s48, s18
    s_and_b32 s49, s19, 65535
    s_mov_b32 s50, 2097152
    s_mov_b32 s51, 131072
    s_mov_b32 s40, s20
    s_and_b32 s41, s21, 65535
    s_mov_b32 s42, 268435456
    s_mov_b32 s43, 131072
    buffer_load_dwordx4 v[64:67], v241, s[40:43], s9 offen
    buffer_load_dwordx4 v[68:71], v241, s[40:43], s10 offen
    buffer_load_dwordx4 v[72:75], v241, s[40:43], s11 offen
    buffer_load_dwordx4 v[76:79], v241, s[40:43], s12 offen
    buffer_load_dwordx4 v[80:83], v241, s[40:43], s9 offen offset:1024
    buffer_load_dwordx4 v[84:87], v241, s[40:43], s10 offen offset:1024
    buffer_load_dwordx4 v[88:91], v241, s[40:43], s11 offen offset:1024
    buffer_load_dwordx4 v[92:95], v241, s[40:43], s12 offen offset:1024
    buffer_load_dwordx4 v[96:99], v241, s[40:43], s9 offen offset:2048
    buffer_load_dwordx4 v[100:103], v241, s[40:43], s10 offen offset:2048
    buffer_load_dwordx4 v[104:107], v241, s[40:43], s11 offen offset:2048
    buffer_load_dwordx4 v[108:111], v241, s[40:43], s12 offen offset:2048
    buffer_load_dwordx4 v[112:115], v241, s[40:43], s9 offen offset:3072
    buffer_load_dwordx4 v[116:119], v241, s[40:43], s10 offen offset:3072
    buffer_load_dwordx4 v[120:123], v241, s[40:43], s11 offen offset:3072
    buffer_load_dwordx4 v[124:127], v241, s[40:43], s12 offen offset:3072
    s_add_u32 s9, s9, 4096
    s_add_u32 s10, s10, 4096
    s_add_u32 s11, s11, 4096
    s_add_u32 s12, s12, 4096
    buffer_load_dwordx4 v[128:131], v241, s[40:43], s9 offen
    buffer_load_dwordx4 v[132:135], v241, s[40:43], s10 offen
    buffer_load_dwordx4 v[136:139], v241, s[40:43], s11 offen
    buffer_load_dwordx4 v[140:143], v241, s[40:43], s12 offen
    buffer_load_dwordx4 v[144:147], v241, s[40:43], s9 offen offset:1024
    buffer_load_dwordx4 v[148:151], v241, s[40:43], s10 offen offset:1024
    buffer_load_dwordx4 v[152:155], v241, s[40:43], s11 offen offset:1024
    buffer_load_dwordx4 v[156:159], v241, s[40:43], s12 offen offset:1024
    buffer_load_dwordx4 v[160:163], v241, s[40:43], s9 offen offset:2048
    buffer_load_dwordx4 v[164:167], v241, s[40:43], s10 offen offset:2048
    buffer_load_dwordx4 v[168:171], v241, s[40:43], s11 offen offset:2048
    buffer_load_dwordx4 v[172:175], v241, s[40:43], s12 offen offset:2048
    buffer_load_dwordx4 v[176:179], v241, s[40:43], s9 offen offset:3072
    buffer_load_dwordx4 v[180:183], v241, s[40:43], s10 offen offset:3072
    buffer_load_dwordx4 v[184:187], v241, s[40:43], s11 offen offset:3072
    buffer_load_dwordx4 v[188:191], v241, s[40:43], s12 offen offset:3072
    v_lshrrev_b32 v242, 3, v244
    v_and_b32 v243, 7, v244
    s_lshl_b32 s7, s5, 16
    s_lshl_b32 s8, s6, 7
    s_add_u32 s7, s7, s8
    v_lshlrev_b32 v245, 10, v242
    v_lshl_add_u32 v245, v243, 4, v245
    v_add_u32 v245, s7, v245
    buffer_load_dwordx4 v[232:235], v245, s[44:47], 0 offen
    s_waitcnt vmcnt(30)
    v_mfma_f32_32x32x16_bf16 v[0:15], v[72:75], v[64:67], 0
    v_mfma_f32_32x32x16_bf16 v[16:31], v[72:75], v[68:71], 0
    s_waitcnt vmcnt(29)
    v_mfma_f32_32x32x16_bf16 v[32:47], v[76:79], v[64:67], 0
    v_mfma_f32_32x32x16_bf16 v[48:63], v[76:79], v[68:71], 0
    s_add_u32 s9, s9, 4096
    s_add_u32 s10, s10, 4096
    s_add_u32 s11, s11, 4096
    s_add_u32 s12, s12, 4096
    buffer_load_dwordx4 v[64:67], v241, s[40:43], s9 offen
    buffer_load_dwordx4 v[68:71], v241, s[40:43], s10 offen
    buffer_load_dwordx4 v[72:75], v241, s[40:43], s11 offen
    buffer_load_dwordx4 v[76:79], v241, s[40:43], s12 offen
    s_waitcnt vmcnt(30)
    v_mfma_f32_32x32x16_bf16 v[0:15], v[88:91], v[80:83], v[0:15]
    v_mfma_f32_32x32x16_bf16 v[16:31], v[88:91], v[84:87], v[16:31]
    s_waitcnt vmcnt(29)
    v_mfma_f32_32x32x16_bf16 v[32:47], v[92:95], v[80:83], v[32:47]
    v_mfma_f32_32x32x16_bf16 v[48:63], v[92:95], v[84:87], v[48:63]
    buffer_load_dwordx4 v[80:83], v241, s[40:43], s9 offen offset:1024
    buffer_load_dwordx4 v[84:87], v241, s[40:43], s10 offen offset:1024
    buffer_load_dwordx4 v[88:91], v241, s[40:43], s11 offen offset:1024
    buffer_load_dwordx4 v[92:95], v241, s[40:43], s12 offen offset:1024
    s_waitcnt vmcnt(30)
    v_mfma_f32_32x32x16_bf16 v[0:15], v[104:107], v[96:99], v[0:15]
    v_mfma_f32_32x32x16_bf16 v[16:31], v[104:107], v[100:103], v[16:31]
    s_waitcnt vmcnt(29)
    v_mfma_f32_32x32x16_bf16 v[32:47], v[108:111], v[96:99], v[32:47]
    v_mfma_f32_32x32x16_bf16 v[48:63], v[108:111], v[100:103], v[48:63]
    buffer_load_dwordx4 v[96:99], v241, s[40:43], s9 offen offset:2048
    buffer_load_dwordx4 v[100:103], v241, s[40:43], s10 offen offset:2048
    buffer_load_dwordx4 v[104:107], v241, s[40:43], s11 offen offset:2048
    buffer_load_dwordx4 v[108:111], v241, s[40:43], s12 offen offset:2048
    s_waitcnt vmcnt(30)
    v_mfma_f32_32x32x16_bf16 v[0:15], v[120:123], v[112:115], v[0:15]
    v_mfma_f32_32x32x16_bf16 v[16:31], v[120:123], v[116:119], v[16:31]
    s_waitcnt vmcnt(29)
    v_mfma_f32_32x32x16_bf16 v[32:47], v[124:127], v[112:115], v[32:47]
    v_mfma_f32_32x32x16_bf16 v[48:63], v[124:127], v[116:119], v[48:63]
    buffer_load_dwordx4 v[112:115], v241, s[40:43], s9 offen offset:3072
    buffer_load_dwordx4 v[116:119], v241, s[40:43], s10 offen offset:3072
    buffer_load_dwordx4 v[120:123], v241, s[40:43], s11 offen offset:3072
    buffer_load_dwordx4 v[124:127], v241, s[40:43], s12 offen offset:3072
    s_waitcnt vmcnt(30)
    v_mfma_f32_32x32x16_bf16 v[0:15], v[136:139], v[128:131], v[0:15]
    v_mfma_f32_32x32x16_bf16 v[16:31], v[136:139], v[132:135], v[16:31]
    s_waitcnt vmcnt(29)
    v_mfma_f32_32x32x16_bf16 v[32:47], v[140:143], v[128:131], v[32:47]
    v_mfma_f32_32x32x16_bf16 v[48:63], v[140:143], v[132:135], v[48:63]
    s_add_u32 s9, s9, 4096
    s_add_u32 s10, s10, 4096
    s_add_u32 s11, s11, 4096
    s_add_u32 s12, s12, 4096
    buffer_load_dwordx4 v[128:131], v241, s[40:43], s9 offen
    buffer_load_dwordx4 v[132:135], v241, s[40:43], s10 offen
    buffer_load_dwordx4 v[136:139], v241, s[40:43], s11 offen
    buffer_load_dwordx4 v[140:143], v241, s[40:43], s12 offen
    s_waitcnt vmcnt(30)
    v_mfma_f32_32x32x16_bf16 v[0:15], v[152:155], v[144:147], v[0:15]
    v_mfma_f32_32x32x16_bf16 v[16:31], v[152:155], v[148:151], v[16:31]
    s_waitcnt vmcnt(29)
    v_mfma_f32_32x32x16_bf16 v[32:47], v[156:159], v[144:147], v[32:47]
    v_mfma_f32_32x32x16_bf16 v[48:63], v[156:159], v[148:151], v[48:63]
    buffer_load_dwordx4 v[144:147], v241, s[40:43], s9 offen offset:1024
    buffer_load_dwordx4 v[148:151], v241, s[40:43], s10 offen offset:1024
    buffer_load_dwordx4 v[152:155], v241, s[40:43], s11 offen offset:1024
    buffer_load_dwordx4 v[156:159], v241, s[40:43], s12 offen offset:1024
    s_waitcnt vmcnt(30)
    v_mfma_f32_32x32x16_bf16 v[0:15], v[168:171], v[160:163], v[0:15]
    v_mfma_f32_32x32x16_bf16 v[16:31], v[168:171], v[164:167], v[16:31]
    s_waitcnt vmcnt(29)
    v_mfma_f32_32x32x16_bf16 v[32:47], v[172:175], v[160:163], v[32:47]
    v_mfma_f32_32x32x16_bf16 v[48:63], v[172:175], v[164:167], v[48:63]
    buffer_load_dwordx4 v[160:163], v241, s[40:43], s9 offen offset:2048
    buffer_load_dwordx4 v[164:167], v241, s[40:43], s10 offen offset:2048
    buffer_load_dwordx4 v[168:171], v241, s[40:43], s11 offen offset:2048
    buffer_load_dwordx4 v[172:175], v241, s[40:43], s12 offen offset:2048
    s_waitcnt vmcnt(30)
    v_mfma_f32_32x32x16_bf16 v[0:15], v[184:187], v[176:179], v[0:15]
    v_mfma_f32_32x32x16_bf16 v[16:31], v[184:187], v[180:183], v[16:31]
    s_waitcnt vmcnt(29)
    v_mfma_f32_32x32x16_bf16 v[32:47], v[188:191], v[176:179], v[32:47]
    v_mfma_f32_32x32x16_bf16 v[48:63], v[188:191], v[180:183], v[48:63]
    buffer_load_dwordx4 v[176:179], v241, s[40:43], s9 offen offset:3072
    buffer_load_dwordx4 v[180:183], v241, s[40:43], s10 offen offset:3072
    buffer_load_dwordx4 v[184:187], v241, s[40:43], s11 offen offset:3072
    buffer_load_dwordx4 v[188:191], v241, s[40:43], s12 offen offset:3072
    s_waitcnt vmcnt(29)
    v_mfma_f32_32x32x16_bf16 v[0:15], v[72:75], v[64:67], v[0:15]
    v_mfma_f32_32x32x16_bf16 v[16:31], v[72:75], v[68:71], v[16:31]
    s_waitcnt vmcnt(28)
    v_mfma_f32_32x32x16_bf16 v[32:47], v[76:79], v[64:67], v[32:47]
    v_mfma_f32_32x32x16_bf16 v[48:63], v[76:79], v[68:71], v[48:63]
    s_add_u32 s9, s9, 4096
    s_add_u32 s10, s10, 4096
    s_add_u32 s11, s11, 4096
    s_add_u32 s12, s12, 4096
    buffer_load_dwordx4 v[64:67], v241, s[40:43], s9 offen
    buffer_load_dwordx4 v[68:71], v241, s[40:43], s10 offen
    buffer_load_dwordx4 v[72:75], v241, s[40:43], s11 offen
    buffer_load_dwordx4 v[76:79], v241, s[40:43], s12 offen
    s_waitcnt vmcnt(29)
    v_mfma_f32_32x32x16_bf16 v[0:15], v[88:91], v[80:83], v[0:15]
    v_mfma_f32_32x32x16_bf16 v[16:31], v[88:91], v[84:87], v[16:31]
    s_waitcnt vmcnt(28)
    v_mfma_f32_32x32x16_bf16 v[32:47], v[92:95], v[80:83], v[32:47]
    v_mfma_f32_32x32x16_bf16 v[48:63], v[92:95], v[84:87], v[48:63]
    buffer_load_dwordx4 v[80:83], v241, s[40:43], s9 offen offset:1024
    buffer_load_dwordx4 v[84:87], v241, s[40:43], s10 offen offset:1024
    buffer_load_dwordx4 v[88:91], v241, s[40:43], s11 offen offset:1024
    buffer_load_dwordx4 v[92:95], v241, s[40:43], s12 offen offset:1024
    s_waitcnt vmcnt(29)
    v_mfma_f32_32x32x16_bf16 v[0:15], v[104:107], v[96:99], v[0:15]
    v_mfma_f32_32x32x16_bf16 v[16:31], v[104:107], v[100:103], v[16:31]
    s_waitcnt vmcnt(28)
    v_mfma_f32_32x32x16_bf16 v[32:47], v[108:111], v[96:99], v[32:47]
    v_mfma_f32_32x32x16_bf16 v[48:63], v[108:111], v[100:103], v[48:63]
    buffer_load_dwordx4 v[96:99], v241, s[40:43], s9 offen offset:2048
    buffer_load_dwordx4 v[100:103], v241, s[40:43], s10 offen offset:2048
    buffer_load_dwordx4 v[104:107], v241, s[40:43], s11 offen offset:2048
    buffer_load_dwordx4 v[108:111], v241, s[40:43], s12 offen offset:2048
    s_waitcnt vmcnt(29)
    v_mfma_f32_32x32x16_bf16 v[0:15], v[120:123], v[112:115], v[0:15]
    v_mfma_f32_32x32x16_bf16 v[16:31], v[120:123], v[116:119], v[16:31]
    s_waitcnt vmcnt(28)
    v_mfma_f32_32x32x16_bf16 v[32:47], v[124:127], v[112:115], v[32:47]
    v_mfma_f32_32x32x16_bf16 v[48:63], v[124:127], v[116:119], v[48:63]
    buffer_load_dwordx4 v[112:115], v241, s[40:43], s9 offen offset:3072
    buffer_load_dwordx4 v[116:119], v241, s[40:43], s10 offen offset:3072
    buffer_load_dwordx4 v[120:123], v241, s[40:43], s11 offen offset:3072
    buffer_load_dwordx4 v[124:127], v241, s[40:43], s12 offen offset:3072
    s_waitcnt vmcnt(29)
    v_mfma_f32_32x32x16_bf16 v[0:15], v[136:139], v[128:131], v[0:15]
    v_mfma_f32_32x32x16_bf16 v[16:31], v[136:139], v[132:135], v[16:31]
    s_waitcnt vmcnt(28)
    v_mfma_f32_32x32x16_bf16 v[32:47], v[140:143], v[128:131], v[32:47]
    v_mfma_f32_32x32x16_bf16 v[48:63], v[140:143], v[132:135], v[48:63]
    s_add_u32 s9, s9, 4096
    s_add_u32 s10, s10, 4096
    s_add_u32 s11, s11, 4096
    s_add_u32 s12, s12, 4096
    buffer_load_dwordx4 v[128:131], v241, s[40:43], s9 offen
    buffer_load_dwordx4 v[132:135], v241, s[40:43], s10 offen
    buffer_load_dwordx4 v[136:139], v241, s[40:43], s11 offen
    buffer_load_dwordx4 v[140:143], v241, s[40:43], s12 offen
    s_waitcnt vmcnt(29)
    v_mfma_f32_32x32x16_bf16 v[0:15], v[152:155], v[144:147], v[0:15]
    v_mfma_f32_32x32x16_bf16 v[16:31], v[152:155], v[148:151], v[16:31]
    s_waitcnt vmcnt(28)
    v_mfma_f32_32x32x16_bf16 v[32:47], v[156:159], v[144:147], v[32:47]
    v_mfma_f32_32x32x16_bf16 v[48:63], v[156:159], v[148:151], v[48:63]
    buffer_load_dwordx4 v[144:147], v241, s[40:43], s9 offen offset:1024
    buffer_load_dwordx4 v[148:151], v241, s[40:43], s10 offen offset:1024
    buffer_load_dwordx4 v[152:155], v241, s[40:43], s11 offen offset:1024
    buffer_load_dwordx4 v[156:159], v241, s[40:43], s12 offen offset:1024
    s_waitcnt vmcnt(29)
    v_mfma_f32_32x32x16_bf16 v[0:15], v[168:171], v[160:163], v[0:15]
    v_mfma_f32_32x32x16_bf16 v[16:31], v[168:171], v[164:167], v[16:31]
    s_waitcnt vmcnt(28)
    v_mfma_f32_32x32x16_bf16 v[32:47], v[172:175], v[160:163], v[32:47]
    v_mfma_f32_32x32x16_bf16 v[48:63], v[172:175], v[164:167], v[48:63]
    buffer_load_dwordx4 v[160:163], v241, s[40:43], s9 offen offset:2048
    buffer_load_dwordx4 v[164:167], v241, s[40:43], s10 offen offset:2048
    buffer_load_dwordx4 v[168:171], v241, s[40:43], s11 offen offset:2048
    buffer_load_dwordx4 v[172:175], v241, s[40:43], s12 offen offset:2048
    s_waitcnt vmcnt(29)
    v_mfma_f32_32x32x16_bf16 v[0:15], v[184:187], v[176:179], v[0:15]
    v_mfma_f32_32x32x16_bf16 v[16:31], v[184:187], v[180:183], v[16:31]
    s_waitcnt vmcnt(28)
    v_mfma_f32_32x32x16_bf16 v[32:47], v[188:191], v[176:179], v[32:47]
    v_mfma_f32_32x32x16_bf16 v[48:63], v[188:191], v[180:183], v[48:63]
    buffer_load_dwordx4 v[176:179], v241, s[40:43], s9 offen offset:3072
    buffer_load_dwordx4 v[180:183], v241, s[40:43], s10 offen offset:3072
    buffer_load_dwordx4 v[184:187], v241, s[40:43], s11 offen offset:3072
    buffer_load_dwordx4 v[188:191], v241, s[40:43], s12 offen offset:3072
    s_waitcnt vmcnt(29)
    v_mfma_f32_32x32x16_bf16 v[0:15], v[72:75], v[64:67], v[0:15]
    v_mfma_f32_32x32x16_bf16 v[16:31], v[72:75], v[68:71], v[16:31]
    s_waitcnt vmcnt(28)
    v_mfma_f32_32x32x16_bf16 v[32:47], v[76:79], v[64:67], v[32:47]
    v_mfma_f32_32x32x16_bf16 v[48:63], v[76:79], v[68:71], v[48:63]
    s_add_u32 s9, s9, 4096
    s_add_u32 s10, s10, 4096
    s_add_u32 s11, s11, 4096
    s_add_u32 s12, s12, 4096
    buffer_load_dwordx4 v[64:67], v241, s[40:43], s9 offen
    buffer_load_dwordx4 v[68:71], v241, s[40:43], s10 offen
    buffer_load_dwordx4 v[72:75], v241, s[40:43], s11 offen
    buffer_load_dwordx4 v[76:79], v241, s[40:43], s12 offen
    s_waitcnt vmcnt(29)
    v_mfma_f32_32x32x16_bf16 v[0:15], v[88:91], v[80:83], v[0:15]
    v_mfma_f32_32x32x16_bf16 v[16:31], v[88:91], v[84:87], v[16:31]
    s_waitcnt vmcnt(28)
    v_mfma_f32_32x32x16_bf16 v[32:47], v[92:95], v[80:83], v[32:47]
    v_mfma_f32_32x32x16_bf16 v[48:63], v[92:95], v[84:87], v[48:63]
    buffer_load_dwordx4 v[80:83], v241, s[40:43], s9 offen offset:1024
    buffer_load_dwordx4 v[84:87], v241, s[40:43], s10 offen offset:1024
    buffer_load_dwordx4 v[88:91], v241, s[40:43], s11 offen offset:1024
    buffer_load_dwordx4 v[92:95], v241, s[40:43], s12 offen offset:1024
    s_waitcnt vmcnt(29)
    v_mfma_f32_32x32x16_bf16 v[0:15], v[104:107], v[96:99], v[0:15]
    v_mfma_f32_32x32x16_bf16 v[16:31], v[104:107], v[100:103], v[16:31]
    s_waitcnt vmcnt(28)
    v_mfma_f32_32x32x16_bf16 v[32:47], v[108:111], v[96:99], v[32:47]
    v_mfma_f32_32x32x16_bf16 v[48:63], v[108:111], v[100:103], v[48:63]
    buffer_load_dwordx4 v[96:99], v241, s[40:43], s9 offen offset:2048
    buffer_load_dwordx4 v[100:103], v241, s[40:43], s10 offen offset:2048
    buffer_load_dwordx4 v[104:107], v241, s[40:43], s11 offen offset:2048
    buffer_load_dwordx4 v[108:111], v241, s[40:43], s12 offen offset:2048
    s_waitcnt vmcnt(29)
    v_mfma_f32_32x32x16_bf16 v[0:15], v[120:123], v[112:115], v[0:15]
    v_mfma_f32_32x32x16_bf16 v[16:31], v[120:123], v[116:119], v[16:31]
    s_waitcnt vmcnt(28)
    v_mfma_f32_32x32x16_bf16 v[32:47], v[124:127], v[112:115], v[32:47]
    v_mfma_f32_32x32x16_bf16 v[48:63], v[124:127], v[116:119], v[48:63]
    buffer_load_dwordx4 v[112:115], v241, s[40:43], s9 offen offset:3072
    buffer_load_dwordx4 v[116:119], v241, s[40:43], s10 offen offset:3072
    buffer_load_dwordx4 v[120:123], v241, s[40:43], s11 offen offset:3072
    buffer_load_dwordx4 v[124:127], v241, s[40:43], s12 offen offset:3072
    s_waitcnt vmcnt(29)
    v_mfma_f32_32x32x16_bf16 v[0:15], v[136:139], v[128:131], v[0:15]
    v_mfma_f32_32x32x16_bf16 v[16:31], v[136:139], v[132:135], v[16:31]
    s_waitcnt vmcnt(28)
    v_mfma_f32_32x32x16_bf16 v[32:47], v[140:143], v[128:131], v[32:47]
    v_mfma_f32_32x32x16_bf16 v[48:63], v[140:143], v[132:135], v[48:63]
    s_add_u32 s9, s9, 4096
    s_add_u32 s10, s10, 4096
    s_add_u32 s11, s11, 4096
    s_add_u32 s12, s12, 4096
    buffer_load_dwordx4 v[128:131], v241, s[40:43], s9 offen
    buffer_load_dwordx4 v[132:135], v241, s[40:43], s10 offen
    buffer_load_dwordx4 v[136:139], v241, s[40:43], s11 offen
    buffer_load_dwordx4 v[140:143], v241, s[40:43], s12 offen
    s_waitcnt vmcnt(29)
    v_mfma_f32_32x32x16_bf16 v[0:15], v[152:155], v[144:147], v[0:15]
    v_mfma_f32_32x32x16_bf16 v[16:31], v[152:155], v[148:151], v[16:31]
    s_waitcnt vmcnt(28)
    v_mfma_f32_32x32x16_bf16 v[32:47], v[156:159], v[144:147], v[32:47]
    v_mfma_f32_32x32x16_bf16 v[48:63], v[156:159], v[148:151], v[48:63]
    buffer_load_dwordx4 v[144:147], v241, s[40:43], s9 offen offset:1024
    buffer_load_dwordx4 v[148:151], v241, s[40:43], s10 offen offset:1024
    buffer_load_dwordx4 v[152:155], v241, s[40:43], s11 offen offset:1024
    buffer_load_dwordx4 v[156:159], v241, s[40:43], s12 offen offset:1024
    s_waitcnt vmcnt(29)
    v_mfma_f32_32x32x16_bf16 v[0:15], v[168:171], v[160:163], v[0:15]
    v_mfma_f32_32x32x16_bf16 v[16:31], v[168:171], v[164:167], v[16:31]
    s_waitcnt vmcnt(28)
    v_mfma_f32_32x32x16_bf16 v[32:47], v[172:175], v[160:163], v[32:47]
    v_mfma_f32_32x32x16_bf16 v[48:63], v[172:175], v[164:167], v[48:63]
    buffer_load_dwordx4 v[160:163], v241, s[40:43], s9 offen offset:2048
    buffer_load_dwordx4 v[164:167], v241, s[40:43], s10 offen offset:2048
    buffer_load_dwordx4 v[168:171], v241, s[40:43], s11 offen offset:2048
    buffer_load_dwordx4 v[172:175], v241, s[40:43], s12 offen offset:2048
    s_waitcnt vmcnt(29)
    v_mfma_f32_32x32x16_bf16 v[0:15], v[184:187], v[176:179], v[0:15]
    v_mfma_f32_32x32x16_bf16 v[16:31], v[184:187], v[180:183], v[16:31]
    s_waitcnt vmcnt(28)
    v_mfma_f32_32x32x16_bf16 v[32:47], v[188:191], v[176:179], v[32:47]
    v_mfma_f32_32x32x16_bf16 v[48:63], v[188:191], v[180:183], v[48:63]
    buffer_load_dwordx4 v[176:179], v241, s[40:43], s9 offen offset:3072
    buffer_load_dwordx4 v[180:183], v241, s[40:43], s10 offen offset:3072
    buffer_load_dwordx4 v[184:187], v241, s[40:43], s11 offen offset:3072
    buffer_load_dwordx4 v[188:191], v241, s[40:43], s12 offen offset:3072
    s_waitcnt vmcnt(29)
    v_mfma_f32_32x32x16_bf16 v[0:15], v[72:75], v[64:67], v[0:15]
    v_mfma_f32_32x32x16_bf16 v[16:31], v[72:75], v[68:71], v[16:31]
    s_waitcnt vmcnt(28)
    v_mfma_f32_32x32x16_bf16 v[32:47], v[76:79], v[64:67], v[32:47]
    v_mfma_f32_32x32x16_bf16 v[48:63], v[76:79], v[68:71], v[48:63]
    s_add_u32 s9, s9, 4096
    s_add_u32 s10, s10, 4096
    s_add_u32 s11, s11, 4096
    s_add_u32 s12, s12, 4096
    buffer_load_dwordx4 v[64:67], v241, s[40:43], s9 offen
    buffer_load_dwordx4 v[68:71], v241, s[40:43], s10 offen
    buffer_load_dwordx4 v[72:75], v241, s[40:43], s11 offen
    buffer_load_dwordx4 v[76:79], v241, s[40:43], s12 offen
    s_waitcnt vmcnt(29)
    v_mfma_f32_32x32x16_bf16 v[0:15], v[88:91], v[80:83], v[0:15]
    v_mfma_f32_32x32x16_bf16 v[16:31], v[88:91], v[84:87], v[16:31]
    s_waitcnt vmcnt(28)
    v_mfma_f32_32x32x16_bf16 v[32:47], v[92:95], v[80:83], v[32:47]
    v_mfma_f32_32x32x16_bf16 v[48:63], v[92:95], v[84:87], v[48:63]
    buffer_load_dwordx4 v[80:83], v241, s[40:43], s9 offen offset:1024
    buffer_load_dwordx4 v[84:87], v241, s[40:43], s10 offen offset:1024
    buffer_load_dwordx4 v[88:91], v241, s[40:43], s11 offen offset:1024
    buffer_load_dwordx4 v[92:95], v241, s[40:43], s12 offen offset:1024
    s_waitcnt vmcnt(29)
    v_mfma_f32_32x32x16_bf16 v[0:15], v[104:107], v[96:99], v[0:15]
    v_mfma_f32_32x32x16_bf16 v[16:31], v[104:107], v[100:103], v[16:31]
    s_waitcnt vmcnt(28)
    v_mfma_f32_32x32x16_bf16 v[32:47], v[108:111], v[96:99], v[32:47]
    v_mfma_f32_32x32x16_bf16 v[48:63], v[108:111], v[100:103], v[48:63]
    buffer_load_dwordx4 v[96:99], v241, s[40:43], s9 offen offset:2048
    buffer_load_dwordx4 v[100:103], v241, s[40:43], s10 offen offset:2048
    buffer_load_dwordx4 v[104:107], v241, s[40:43], s11 offen offset:2048
    buffer_load_dwordx4 v[108:111], v241, s[40:43], s12 offen offset:2048
    s_waitcnt vmcnt(29)
    v_mfma_f32_32x32x16_bf16 v[0:15], v[120:123], v[112:115], v[0:15]
    v_mfma_f32_32x32x16_bf16 v[16:31], v[120:123], v[116:119], v[16:31]
    s_waitcnt vmcnt(28)
    v_mfma_f32_32x32x16_bf16 v[32:47], v[124:127], v[112:115], v[32:47]
    v_mfma_f32_32x32x16_bf16 v[48:63], v[124:127], v[116:119], v[48:63]
    buffer_load_dwordx4 v[112:115], v241, s[40:43], s9 offen offset:3072
    buffer_load_dwordx4 v[116:119], v241, s[40:43], s10 offen offset:3072
    buffer_load_dwordx4 v[120:123], v241, s[40:43], s11 offen offset:3072
    buffer_load_dwordx4 v[124:127], v241, s[40:43], s12 offen offset:3072
    s_waitcnt vmcnt(29)
    v_mfma_f32_32x32x16_bf16 v[0:15], v[136:139], v[128:131], v[0:15]
    v_mfma_f32_32x32x16_bf16 v[16:31], v[136:139], v[132:135], v[16:31]
    s_waitcnt vmcnt(28)
    v_mfma_f32_32x32x16_bf16 v[32:47], v[140:143], v[128:131], v[32:47]
    v_mfma_f32_32x32x16_bf16 v[48:63], v[140:143], v[132:135], v[48:63]
    s_add_u32 s9, s9, 4096
    s_add_u32 s10, s10, 4096
    s_add_u32 s11, s11, 4096
    s_add_u32 s12, s12, 4096
    buffer_load_dwordx4 v[128:131], v241, s[40:43], s9 offen
    buffer_load_dwordx4 v[132:135], v241, s[40:43], s10 offen
    buffer_load_dwordx4 v[136:139], v241, s[40:43], s11 offen
    buffer_load_dwordx4 v[140:143], v241, s[40:43], s12 offen
    s_waitcnt vmcnt(29)
    v_mfma_f32_32x32x16_bf16 v[0:15], v[152:155], v[144:147], v[0:15]
    v_mfma_f32_32x32x16_bf16 v[16:31], v[152:155], v[148:151], v[16:31]
    s_waitcnt vmcnt(28)
    v_mfma_f32_32x32x16_bf16 v[32:47], v[156:159], v[144:147], v[32:47]
    v_mfma_f32_32x32x16_bf16 v[48:63], v[156:159], v[148:151], v[48:63]
    buffer_load_dwordx4 v[144:147], v241, s[40:43], s9 offen offset:1024
    buffer_load_dwordx4 v[148:151], v241, s[40:43], s10 offen offset:1024
    buffer_load_dwordx4 v[152:155], v241, s[40:43], s11 offen offset:1024
    buffer_load_dwordx4 v[156:159], v241, s[40:43], s12 offen offset:1024
    s_waitcnt vmcnt(29)
    v_mfma_f32_32x32x16_bf16 v[0:15], v[168:171], v[160:163], v[0:15]
    v_mfma_f32_32x32x16_bf16 v[16:31], v[168:171], v[164:167], v[16:31]
    s_waitcnt vmcnt(28)
    v_mfma_f32_32x32x16_bf16 v[32:47], v[172:175], v[160:163], v[32:47]
    v_mfma_f32_32x32x16_bf16 v[48:63], v[172:175], v[164:167], v[48:63]
    buffer_load_dwordx4 v[160:163], v241, s[40:43], s9 offen offset:2048
    buffer_load_dwordx4 v[164:167], v241, s[40:43], s10 offen offset:2048
    buffer_load_dwordx4 v[168:171], v241, s[40:43], s11 offen offset:2048
    buffer_load_dwordx4 v[172:175], v241, s[40:43], s12 offen offset:2048
    s_waitcnt vmcnt(29)
    v_mfma_f32_32x32x16_bf16 v[0:15], v[184:187], v[176:179], v[0:15]
    v_mfma_f32_32x32x16_bf16 v[16:31], v[184:187], v[180:183], v[16:31]
    s_waitcnt vmcnt(28)
    v_mfma_f32_32x32x16_bf16 v[32:47], v[188:191], v[176:179], v[32:47]
    v_mfma_f32_32x32x16_bf16 v[48:63], v[188:191], v[180:183], v[48:63]
    buffer_load_dwordx4 v[176:179], v241, s[40:43], s9 offen offset:3072
    buffer_load_dwordx4 v[180:183], v241, s[40:43], s10 offen offset:3072
    buffer_load_dwordx4 v[184:187], v241, s[40:43], s11 offen offset:3072
    buffer_load_dwordx4 v[188:191], v241, s[40:43], s12 offen offset:3072
    s_waitcnt vmcnt(29)
    v_mfma_f32_32x32x16_bf16 v[0:15], v[72:75], v[64:67], v[0:15]
    v_mfma_f32_32x32x16_bf16 v[16:31], v[72:75], v[68:71], v[16:31]
    s_waitcnt vmcnt(28)
    v_mfma_f32_32x32x16_bf16 v[32:47], v[76:79], v[64:67], v[32:47]
    v_mfma_f32_32x32x16_bf16 v[48:63], v[76:79], v[68:71], v[48:63]
    s_add_u32 s9, s9, 4096
    s_add_u32 s10, s10, 4096
    s_add_u32 s11, s11, 4096
    s_add_u32 s12, s12, 4096
    buffer_load_dwordx4 v[64:67], v241, s[40:43], s9 offen
    buffer_load_dwordx4 v[68:71], v241, s[40:43], s10 offen
    buffer_load_dwordx4 v[72:75], v241, s[40:43], s11 offen
    buffer_load_dwordx4 v[76:79], v241, s[40:43], s12 offen
    s_waitcnt vmcnt(29)
    v_mfma_f32_32x32x16_bf16 v[0:15], v[88:91], v[80:83], v[0:15]
    v_mfma_f32_32x32x16_bf16 v[16:31], v[88:91], v[84:87], v[16:31]
    s_waitcnt vmcnt(28)
    v_mfma_f32_32x32x16_bf16 v[32:47], v[92:95], v[80:83], v[32:47]
    v_mfma_f32_32x32x16_bf16 v[48:63], v[92:95], v[84:87], v[48:63]
    buffer_load_dwordx4 v[80:83], v241, s[40:43], s9 offen offset:1024
    buffer_load_dwordx4 v[84:87], v241, s[40:43], s10 offen offset:1024
    buffer_load_dwordx4 v[88:91], v241, s[40:43], s11 offen offset:1024
    buffer_load_dwordx4 v[92:95], v241, s[40:43], s12 offen offset:1024
    s_waitcnt vmcnt(29)
    v_mfma_f32_32x32x16_bf16 v[0:15], v[104:107], v[96:99], v[0:15]
    v_mfma_f32_32x32x16_bf16 v[16:31], v[104:107], v[100:103], v[16:31]
    s_waitcnt vmcnt(28)
    v_mfma_f32_32x32x16_bf16 v[32:47], v[108:111], v[96:99], v[32:47]
    v_mfma_f32_32x32x16_bf16 v[48:63], v[108:111], v[100:103], v[48:63]
    s_add_u32 s11, s11, s13
    s_add_u32 s12, s12, s13
    buffer_load_dwordx4 v[96:99], v241, s[40:43], s9 offen offset:2048
    buffer_load_dwordx4 v[100:103], v241, s[40:43], s10 offen offset:2048
    buffer_load_dwordx4 v[104:107], v241, s[40:43], s11 offen offset:2048
    buffer_load_dwordx4 v[108:111], v241, s[40:43], s12 offen offset:2048
    s_waitcnt vmcnt(29)
    v_mfma_f32_32x32x16_bf16 v[0:15], v[120:123], v[112:115], v[0:15]
    v_mfma_f32_32x32x16_bf16 v[16:31], v[120:123], v[116:119], v[16:31]
    s_waitcnt vmcnt(28)
    v_mfma_f32_32x32x16_bf16 v[32:47], v[124:127], v[112:115], v[32:47]
    v_mfma_f32_32x32x16_bf16 v[48:63], v[124:127], v[116:119], v[48:63]
    s_waitcnt vmcnt(25)
    v_mfma_f32_32x32x16_bf16 v[0:15], v[136:139], v[128:131], v[0:15]
    v_mfma_f32_32x32x16_bf16 v[16:31], v[136:139], v[132:135], v[16:31]
    s_waitcnt vmcnt(24)
    v_mfma_f32_32x32x16_bf16 v[32:47], v[140:143], v[128:131], v[32:47]
    v_mfma_f32_32x32x16_bf16 v[48:63], v[140:143], v[132:135], v[48:63]
    s_waitcnt vmcnt(21)
    v_mfma_f32_32x32x16_bf16 v[0:15], v[152:155], v[144:147], v[0:15]
    v_mfma_f32_32x32x16_bf16 v[16:31], v[152:155], v[148:151], v[16:31]
    s_waitcnt vmcnt(20)
    v_mfma_f32_32x32x16_bf16 v[32:47], v[156:159], v[144:147], v[32:47]
    v_mfma_f32_32x32x16_bf16 v[48:63], v[156:159], v[148:151], v[48:63]
    s_waitcnt vmcnt(17)
    v_mfma_f32_32x32x16_bf16 v[0:15], v[168:171], v[160:163], v[0:15]
    v_mfma_f32_32x32x16_bf16 v[16:31], v[168:171], v[164:167], v[16:31]
    s_waitcnt vmcnt(16)
    v_mfma_f32_32x32x16_bf16 v[32:47], v[172:175], v[160:163], v[32:47]
    v_mfma_f32_32x32x16_bf16 v[48:63], v[172:175], v[164:167], v[48:63]
    s_waitcnt vmcnt(13)
    v_mfma_f32_32x32x16_bf16 v[0:15], v[184:187], v[176:179], v[0:15]
    v_mfma_f32_32x32x16_bf16 v[16:31], v[184:187], v[180:183], v[16:31]
    s_waitcnt vmcnt(12)
    v_mfma_f32_32x32x16_bf16 v[32:47], v[188:191], v[176:179], v[32:47]
    v_mfma_f32_32x32x16_bf16 v[48:63], v[188:191], v[180:183], v[48:63]
    s_waitcnt vmcnt(9)
    v_mfma_f32_32x32x16_bf16 v[0:15], v[72:75], v[64:67], v[0:15]
    v_mfma_f32_32x32x16_bf16 v[16:31], v[72:75], v[68:71], v[16:31]
    s_waitcnt vmcnt(8)
    v_mfma_f32_32x32x16_bf16 v[32:47], v[76:79], v[64:67], v[32:47]
    v_mfma_f32_32x32x16_bf16 v[48:63], v[76:79], v[68:71], v[48:63]
    s_waitcnt vmcnt(5)
    v_mfma_f32_32x32x16_bf16 v[0:15], v[88:91], v[80:83], v[0:15]
    v_mfma_f32_32x32x16_bf16 v[16:31], v[88:91], v[84:87], v[16:31]
    s_waitcnt vmcnt(4)
    v_mfma_f32_32x32x16_bf16 v[32:47], v[92:95], v[80:83], v[32:47]
    v_mfma_f32_32x32x16_bf16 v[48:63], v[92:95], v[84:87], v[48:63]
    s_waitcnt vmcnt(1)
    v_mfma_f32_32x32x16_bf16 v[0:15], v[104:107], v[96:99], v[0:15]
    v_mfma_f32_32x32x16_bf16 v[16:31], v[104:107], v[100:103], v[16:31]
    s_waitcnt vmcnt(0)
    v_mfma_f32_32x32x16_bf16 v[32:47], v[108:111], v[96:99], v[32:47]
    v_mfma_f32_32x32x16_bf16 v[48:63], v[108:111], v[100:103], v[48:63]
    s_mul_i32 s7, s4, 16640
    v_add_u32 v242, s7, v241
    s_nop 5
    ds_write_b128 v242, v[0:3]
    ds_write_b128 v242, v[4:7] offset:1040
    ds_write_b128 v242, v[8:11] offset:2080
    ds_write_b128 v242, v[12:15] offset:3120
    ds_write_b128 v242, v[16:19] offset:4160
    ds_write_b128 v242, v[20:23] offset:5200
    ds_write_b128 v242, v[24:27] offset:6240
    ds_write_b128 v242, v[28:31] offset:7280
    ds_write_b128 v242, v[32:35] offset:8320
    ds_write_b128 v242, v[36:39] offset:9360
    ds_write_b128 v242, v[40:43] offset:10400
    ds_write_b128 v242, v[44:47] offset:11440
    ds_write_b128 v242, v[48:51] offset:12480
    ds_write_b128 v242, v[52:55] offset:13520
    ds_write_b128 v242, v[56:59] offset:14560
    s_waitcnt lgkmcnt(14)
    ds_write_b128 v242, v[60:63] offset:15600
    v_lshrrev_b32 v242, 3, v244
    v_and_b32 v243, 7, v244
    v_lshrrev_b32 v246, 2, v243
    v_lshlrev_b32 v246, 1, v246
    v_lshrrev_b32 v247, 5, v242
    v_add_u32 v246, v246, v247
    v_lshlrev_b32 v246, 2, v246
    v_and_b32 v247, 3, v243
    v_add_u32 v246, v246, v247
    v_mul_u32_u24 v246, 1040, v246
    v_and_b32 v247, 31, v242
    v_lshl_add_u32 v246, v247, 4, v246
    v_add_u32 v247, 65536, v246
    s_waitcnt lgkmcnt(0)
    s_barrier
    ds_read_b128 v[0:3], v246
    ds_read_b128 v[4:7], v246 offset:512
    ds_read_b128 v[8:11], v246 offset:16640
    ds_read_b128 v[12:15], v246 offset:17152
    ds_read_b128 v[16:19], v246 offset:33280
    ds_read_b128 v[20:23], v246 offset:33792
    ds_read_b128 v[24:27], v246 offset:49920
    ds_read_b128 v[28:31], v246 offset:50432
    ds_read_b128 v[32:35], v247 offset:1024
    ds_read_b128 v[36:39], v247 offset:1536
    ds_read_b128 v[40:43], v247 offset:17664
    ds_read_b128 v[44:47], v247 offset:18176
    ds_read_b128 v[48:51], v247 offset:34304
    ds_read_b128 v[52:55], v247 offset:34816
    ds_read_b128 v[56:59], v247 offset:50944
    s_waitcnt lgkmcnt(14)
    ds_read_b128 v[60:63], v247 offset:51456
    s_waitcnt lgkmcnt(13)
    v_add_f32 v0, v0, v8
    s_waitcnt lgkmcnt(9)
    v_add_f32 v16, v16, v24
    s_waitcnt lgkmcnt(5)
    v_add_f32 v32, v32, v40
    s_waitcnt lgkmcnt(1)
    v_add_f32 v48, v48, v56
    v_add_f32 v1, v1, v9
    v_add_f32 v17, v17, v25
    v_add_f32 v33, v33, v41
    v_add_f32 v49, v49, v57
    v_add_f32 v2, v2, v10
    v_add_f32 v18, v18, v26
    v_add_f32 v34, v34, v42
    v_add_f32 v50, v50, v58
    v_add_f32 v3, v3, v11
    v_add_f32 v19, v19, v27
    v_add_f32 v35, v35, v43
    v_add_f32 v51, v51, v59
    v_add_f32 v4, v4, v12
    v_add_f32 v20, v20, v28
    v_add_f32 v36, v36, v44
    s_waitcnt lgkmcnt(0)
    v_add_f32 v52, v52, v60
    v_add_f32 v5, v5, v13
    v_add_f32 v21, v21, v29
    v_add_f32 v37, v37, v45
    v_add_f32 v53, v53, v61
    v_add_f32 v6, v6, v14
    v_add_f32 v22, v22, v30
    v_add_f32 v38, v38, v46
    v_add_f32 v54, v54, v62
    v_add_f32 v7, v7, v15
    v_add_f32 v23, v23, v31
    v_add_f32 v39, v39, v47
    v_add_f32 v55, v55, v63
    v_add_f32 v0, v0, v16
    v_add_f32 v1, v1, v17
    v_add_f32 v2, v2, v18
    v_add_f32 v3, v3, v19
    v_add_f32 v4, v4, v20
    v_add_f32 v5, v5, v21
    v_add_f32 v6, v6, v22
    v_add_f32 v7, v7, v23
    v_add_f32 v0, v0, v32
    v_add_f32 v1, v1, v33
    v_add_f32 v2, v2, v34
    v_add_f32 v3, v3, v35
    v_add_f32 v4, v4, v36
    v_add_f32 v5, v5, v37
    v_add_f32 v6, v6, v38
    v_add_f32 v7, v7, v39
    s_mov_b32 s7, 0xbfb8aa3b
    v_cvt_pk_bf16_f32 v64, v0, v1
    v_cvt_pk_bf16_f32 v68, v2, v3
    v_cvt_pk_bf16_f32 v72, v4, v5
    v_cvt_pk_bf16_f32 v76, v6, v7
    v_cvt_pk_bf16_f32 v65, v48, v49
    v_cvt_pk_bf16_f32 v69, v50, v51
    v_cvt_pk_bf16_f32 v73, v52, v53
    v_cvt_pk_bf16_f32 v77, v54, v55
    v_lshlrev_b32 v0, 16, v64
    v_lshlrev_b32 v2, 16, v68
    v_lshlrev_b32 v4, 16, v72
    v_lshlrev_b32 v6, 16, v76
    v_and_b32 v1, 4294901760, v64
    v_and_b32 v3, 4294901760, v68
    v_and_b32 v5, 4294901760, v72
    v_and_b32 v7, 4294901760, v76
    v_lshlrev_b32 v48, 16, v65
    v_lshlrev_b32 v50, 16, v69
    v_lshlrev_b32 v52, 16, v73
    v_lshlrev_b32 v54, 16, v77
    v_and_b32 v49, 4294901760, v65
    v_and_b32 v51, 4294901760, v69
    v_and_b32 v53, 4294901760, v73
    v_and_b32 v55, 4294901760, v77
    v_mul_f32 v64, s7, v48
    v_mul_f32 v68, s7, v50
    v_mul_f32 v72, s7, v52
    v_mul_f32 v76, s7, v54
    v_mul_f32 v65, s7, v49
    v_mul_f32 v69, s7, v51
    v_mul_f32 v73, s7, v53
    v_mul_f32 v77, s7, v55
    v_exp_f32 v64, v64
    v_exp_f32 v68, v68
    v_exp_f32 v72, v72
    v_exp_f32 v76, v76
    v_exp_f32 v65, v65
    v_exp_f32 v69, v69
    v_exp_f32 v73, v73
    v_exp_f32 v77, v77
    v_add_f32 v64, 1.0, v64
    v_add_f32 v68, 1.0, v68
    v_add_f32 v72, 1.0, v72
    v_add_f32 v76, 1.0, v76
    v_add_f32 v65, 1.0, v65
    v_add_f32 v69, 1.0, v69
    v_add_f32 v73, 1.0, v73
    v_add_f32 v77, 1.0, v77
    v_rcp_f32 v64, v64
    v_rcp_f32 v68, v68
    v_rcp_f32 v72, v72
    v_rcp_f32 v76, v76
    v_rcp_f32 v65, v65
    v_rcp_f32 v69, v69
    v_rcp_f32 v73, v73
    v_rcp_f32 v77, v77
    v_mul_f32 v48, v48, v64
    v_mul_f32 v50, v50, v68
    v_mul_f32 v52, v52, v72
    v_mul_f32 v54, v54, v76
    v_mul_f32 v49, v49, v65
    v_mul_f32 v51, v51, v69
    v_mul_f32 v53, v53, v73
    v_mul_f32 v55, v55, v77
    v_cvt_pk_bf16_f32 v64, v48, v49
    v_cvt_pk_bf16_f32 v68, v50, v51
    v_cvt_pk_bf16_f32 v72, v52, v53
    v_cvt_pk_bf16_f32 v76, v54, v55
    v_lshlrev_b32 v48, 16, v64
    v_lshlrev_b32 v50, 16, v68
    v_lshlrev_b32 v52, 16, v72
    v_lshlrev_b32 v54, 16, v76
    v_and_b32 v49, 4294901760, v64
    v_and_b32 v51, 4294901760, v68
    v_and_b32 v53, 4294901760, v72
    v_and_b32 v55, 4294901760, v76
    v_mul_f32 v0, v0, v48
    v_mul_f32 v2, v2, v50
    v_mul_f32 v4, v4, v52
    v_mul_f32 v6, v6, v54
    v_mul_f32 v1, v1, v49
    v_mul_f32 v3, v3, v51
    v_mul_f32 v5, v5, v53
    v_mul_f32 v7, v7, v55
    v_cvt_pk_bf16_f32 v64, v0, v1
    v_cvt_pk_bf16_f32 v68, v2, v3
    v_cvt_pk_bf16_f32 v72, v4, v5
    v_cvt_pk_bf16_f32 v76, v6, v7
    v_lshlrev_b32 v0, 16, v64
    v_lshlrev_b32 v2, 16, v68
    v_lshlrev_b32 v4, 16, v72
    v_lshlrev_b32 v6, 16, v76
    v_and_b32 v1, 4294901760, v64
    v_and_b32 v3, 4294901760, v68
    v_and_b32 v5, 4294901760, v72
    v_and_b32 v7, 4294901760, v76
    v_lshlrev_b32 v66, 16, v232
    v_lshlrev_b32 v70, 16, v233
    v_lshlrev_b32 v74, 16, v234
    v_lshlrev_b32 v78, 16, v235
    v_and_b32 v67, 4294901760, v232
    v_and_b32 v71, 4294901760, v233
    v_and_b32 v75, 4294901760, v234
    v_and_b32 v79, 4294901760, v235
    v_add_f32 v0, v0, v66
    v_add_f32 v2, v2, v70
    v_add_f32 v4, v4, v74
    v_add_f32 v6, v6, v78
    v_add_f32 v1, v1, v67
    v_add_f32 v3, v3, v71
    v_add_f32 v5, v5, v75
    v_add_f32 v7, v7, v79
    v_cvt_pk_bf16_f32 v96, v0, v1
    v_cvt_pk_bf16_f32 v97, v2, v3
    v_cvt_pk_bf16_f32 v98, v4, v5
    v_cvt_pk_bf16_f32 v99, v6, v7
    buffer_store_dwordx4 v[96:99], v245, s[48:51], 0 offen
L_fin_end:
    s_endpgm
.section .rodata,"a"
.p2align 6
.amdhsa_kernel attn_kernel
  .amdhsa_next_free_vgpr 256
  .amdhsa_next_free_sgpr 102
  .amdhsa_accum_offset 256
  .amdhsa_group_segment_fixed_size 0
  .amdhsa_kernarg_size 96
  .amdhsa_user_sgpr_count 2
  .amdhsa_user_sgpr_kernarg_segment_ptr 1
  .amdhsa_system_sgpr_workgroup_id_x 1
.end_amdhsa_kernel
.section .rodata,"a"
.p2align 6
.amdhsa_kernel final_kernel
  .amdhsa_next_free_vgpr 256
  .amdhsa_next_free_sgpr 102
  .amdhsa_accum_offset 256
  .amdhsa_group_segment_fixed_size 0
  .amdhsa_kernarg_size 96
  .amdhsa_user_sgpr_count 2
  .amdhsa_user_sgpr_kernarg_segment_ptr 1
  .amdhsa_system_sgpr_workgroup_id_x 1
.end_amdhsa_kernel
```
